```python
import torch

def _softmax(x, axis=-1):
    return torch.softmax(x, dim=axis)
def _gelu(x):
    return torch.nn.functional.gelu(x, approximate="tanh")
def _silu(x):
    return torch.nn.functional.silu(x)
def _sigmoid(x):
    return torch.sigmoid(x)
def _layernorm(x, axis=-1, eps=1e-5):
    m = x.mean(dim=axis, keepdim=True)
    v = x.var(dim=axis, keepdim=True, unbiased=False)
    return (x - m) / torch.sqrt(v + eps)
def _scatter_add(tgt, idx, src, axis=0):
    return tgt.clone().index_add_(axis, idx, src)
def _segment_sum(src, seg, n):
    out = torch.zeros((n,) + src.shape[1:], dtype=src.dtype)
    return out.index_add_(0, seg, src)
def _pad(x, pw):
    flat = tuple(v for pair in reversed(pw) for v in pair)
    return torch.nn.functional.pad(x, flat)

kernel_name = 'interleave_layers__linear_attn_block__swiglu_ffn__prompt'

def setup_inputs():

    _w = (lambda a: (lambda t: t.to(torch.bfloat16) if t.is_floating_point() else t)(torch.as_tensor(a)))
    def _A_setup():
        B, S, D = 1, 2048, 1024
        return {
            "x": _w((lambda *s: torch.randn(*s, dtype=torch.bfloat16) * 0.05)(B, S, D)),
            "wqkv": _w((lambda *s: torch.randn(*s, dtype=torch.bfloat16) * 0.05)(D, 3 * D)),
            "wo": _w((lambda *s: torch.randn(*s, dtype=torch.bfloat16) * 0.05)(D, D)),
        }
    _A_in = _A_setup()

    def _B_setup():
        B, S, D, F = 1, 2048, 1024, 3584
        return {
            "x": _w((lambda *s: torch.randn(*s, dtype=torch.bfloat16) * 0.05)(B, S, D)),
            "w_gate": _w((lambda *s: torch.randn(*s, dtype=torch.bfloat16) * 0.05)(D, F)),
            "w_up": _w((lambda *s: torch.randn(*s, dtype=torch.bfloat16) * 0.05)(D, F)),
            "w_down": _w((lambda *s: torch.randn(*s, dtype=torch.bfloat16) * 0.05)(F, D)),
        }
    _B_in = _B_setup()

    return {
        "A_x": _A_in["x"],
        "A_wqkv": _A_in["wqkv"],
        "A_wo": _A_in["wo"],
        "B_x": _B_in["x"],
        "B_w_gate": _B_in["w_gate"],
        "B_w_up": _B_in["w_up"],
        "B_w_down": _B_in["w_down"],
    }

def reference(A_x, A_wqkv, A_wo, B_x, B_w_gate, B_w_up, B_w_down):
    def _A_ref(x, wqkv, wo):
        B, S, D = x.shape
        H = 32; Dh = D // H
        qkv = (lambda x, *d: x.permute(*d))((x @ wqkv).reshape(B, S, 3, H, Dh), 2, 0, 3, 1, 4)
        q, k, v = qkv[0], qkv[1], qkv[2]
        phi = lambda t: torch.where(t > 0, t + 1, torch.exp(t)) + 1e-6
        pq, pk = phi(q), phi(k)
        kv = torch.einsum("bhsd,bhse->bhde", pk, v)
        z = torch.einsum("bhsd->bhd", pk)
        num = torch.einsum("bhqd,bhde->bhqe", pq, kv)
        den = torch.einsum("bhqd,bhd->bhq", pq, z)[..., None] + 1e-6
        o = num / den
        return (lambda x, *d: x.permute(*d))(o, 0, 2, 1, 3).reshape(B, S, D) @ wo

    def _B_ref(x, w_gate, w_up, w_down):
        g = _silu(x @ w_gate)
        u = x @ w_up
        return (g * u) @ w_down

    x = A_x
    x = x + _A_ref(_layernorm(x, axis=-1), A_wqkv, A_wo)
    x = x + _B_ref(_layernorm(x, axis=-1), B_w_gate, B_w_up, B_w_down)
    x = x + _A_ref(_layernorm(x, axis=-1), A_wqkv, A_wo)
    x = x + _B_ref(_layernorm(x, axis=-1), B_w_gate, B_w_up, B_w_down)
    return x
```

```asm
; @launch grid=(256,1,1) block=(256,1,1) lds=163840
.amdgcn_target "amdgcn-amd-amdhsa--gfx950"
.text
  .globl interleave_layers__linear_attn_block__swiglu_ffn__prompt_kernel
  .p2align 8
  .type interleave_layers__linear_attn_block__swiglu_ffn__prompt_kernel,@function
interleave_layers__linear_attn_block__swiglu_ffn__prompt_kernel:
main_kernel:
  s_cmp_ge_u32 s2, 256
  s_cbranch_scc1 main_end
  s_load_dwordx2 s[4:5], s[0:1], 56
  s_load_dwordx2 s[6:7], s[0:1], 72
  s_load_dwordx4 s[32:35], s[0:1], 0
  s_load_dwordx2 s[36:37], s[0:1], 16
  s_load_dwordx4 s[40:43], s[0:1], 32
  s_load_dwordx2 s[44:45], s[0:1], 48
  s_load_dwordx2 s[46:47], s[0:1], 64
  v_mov_b32 v199, v0
  v_lshrrev_b32 v2, 6, v0
  v_and_b32 v0, 63, v0
  v_readfirstlane_b32 s30, v2
  v_lshlrev_b32 v1, 4, v0
  v_bfe_u32 v12, v0, 2, 2
  v_and_b32 v13, 1, v0
  v_lshlrev_b32 v13, 1, v13
  v_bfe_u32 v14, v0, 1, 1
  v_or_b32 v13, v13, v14
  v_bfe_u32 v14, v0, 4, 1
  v_lshrrev_b32 v15, 5, v0
  s_getpc_b64 s[84:85]
main_pc:
  s_sub_u32 s84, s84, main_pc-main_kernel
  s_subb_u32 s85, s85, 0
  s_mov_b32 s86, main_code_end-main_kernel
  s_mov_b32 s87, 0x20000
  s_lshr_b32 s88, s2, 3
  s_lshl_b32 s88, s88, 2
  s_add_u32 s88, s88, s30
  s_and_b32 s88, s88, 63
  s_lshl_b32 s88, s88, 10
  s_waitcnt lgkmcnt(0)
  s_add_u32 s24, s6, 29360128
  s_addc_u32 s25, s7, 0
  s_mov_b32 s26, 35651584
  s_mov_b32 s27, 0x20000
  v_lshrrev_b32 v3, 3, v0
  v_and_b32 v4, 7, v0
  s_mov_b32 s20, s32
  s_mov_b32 s21, s33
  s_mov_b32 s22, 4194304
  s_mov_b32 s23, 0x20000
  s_lshl_b32 s3, s2, 3
  v_add_u32 v5, s3, v4
  s_lshl_b32 s39, s30, 5
  v_add_u32 v6, s39, v3
  v_lshlrev_b32 v7, 11, v5
  v_lshl_add_u32 v7, v6, 4, v7
  buffer_load_dwordx4 v[16:19], v7, s[20:23], 0 offen offset:0
  buffer_load_dwordx4 v[20:23], v7, s[20:23], 0 offen offset:128
  buffer_load_dwordx4 v[24:27], v7, s[20:23], 0 offen offset:256
  buffer_load_dwordx4 v[28:31], v7, s[20:23], 0 offen offset:384
  s_mov_b32 s89, 0x7f000000
  s_mul_i32 s101, s30, 8192
  v_lshlrev_b32 v8, 11, v15
  v_lshl_add_u32 v8, v13, 3, v8
  v_add_u32 v8, s101, v8
  s_mul_i32 s33, s30, 2
  s_mov_b32 s31, 0
  s_cmp_lt_u32 s2, 192
  s_cbranch_scc0 cv0_wo
  s_lshr_b32 s28, s2, 3
  s_xor_b32 s28, s28, 2
  s_and_b32 s29, s2, 7
  s_and_b32 s89, s29, 3
  s_mul_i32 s89, s89, 53248
  s_lshr_b32 s39, s29, 2
  s_mul_i32 s39, s39, 12288
  s_add_u32 s89, s89, s39
  s_lshl_b32 s39, s28, 9
  s_add_u32 s89, s89, s39
  s_add_u32 s89, s89, 2621440
  s_mov_b64 s[8:9], s[34:35]
  s_movk_i32 s38, 6144
  s_mov_b32 s10, 6291456
  s_movk_i32 s91, 3072
  s_lshl_b32 s39, s28, 2
  s_lshr_b32 s49, s39, 5
  s_and_b32 s39, s39, 31
  s_mul_i32 s39, s39, 192
  s_add_u32 s39, s39, s49
  s_lshl_b32 s48, s39, 10
  s_add_u32 s49, s48, 196608
  s_add_u32 s50, s48, 393216
  s_add_u32 s51, s48, 589824
  s_branch cv0_pl2
cv0_wo:
  s_sub_u32 s39, s2, 192
  s_lshr_b32 s28, s39, 3
  s_xor_b32 s28, s28, 2
  s_and_b32 s29, s39, 7
  s_mov_b64 s[8:9], s[36:37]
  s_movk_i32 s38, 2048
  s_mov_b32 s10, 2097152
  s_movk_i32 s91, 2048
  s_mul_i32 s39, s28, 262144
  s_add_u32 s48, s39, 6291456
  s_add_u32 s49, s48, 1024
  s_add_u32 s50, s48, 131072
  s_add_u32 s51, s50, 1024
cv0_pl2:
  s_lshl_b32 s29, s29, 3
  s_add_u32 s29, s29, s33
  s_mov_b64 s[12:13], s[8:9]
  s_lshl_b32 s100, s28, 8
  v_lshrrev_b32 v9, 4, v0
  v_mul_lo_u32 v32, v9, s38
  v_xor_b32 v9, v9, v12
  v_lshl_add_u32 v32, v9, 6, v32
  v_and_b32 v10, 3, v0
  v_lshl_add_u32 v32, v10, 4, v32
  s_lshl_b32 s39, s38, 2
  v_add_u32 v33, s39, v32
  v_lshl_add_u32 v8, v14, 5, v8
  v_lshl_add_u32 v8, v12, 8, v8
  v_xor_b32 v10, 0, v12
  v_lshl_add_u32 v112, v10, 6, v8
  v_add_u32 v113, 1024, v112
  v_xor_b32 v10, 1, v12
  v_lshl_add_u32 v114, v10, 6, v8
  v_add_u32 v115, 1024, v114
  v_xor_b32 v10, 2, v12
  v_lshl_add_u32 v116, v10, 6, v8
  v_add_u32 v117, 1024, v116
  v_xor_b32 v10, 3, v12
  v_lshl_add_u32 v118, v10, 6, v8
  v_add_u32 v119, 1024, v118
  s_mov_b32 s11, 0x20000
  s_mov_b32 s14, s10
  s_mov_b32 s15, 0x20000
  s_lshl_b32 s39, s29, 4
  s_mul_i32 s39, s39, s38
  s_add_u32 s100, s39, s100
  s_lshl_b32 s38, s38, 3
  s_add_u32 m0, s101, 0
  s_nop 0
  buffer_load_dwordx4 v32, s[8:11], s100 offen nt lds
  s_add_u32 m0, s101, 1024
  s_nop 0
  buffer_load_dwordx4 v33, s[12:15], s100 offen nt lds
  s_add_u32 s100, s100, s38
  s_add_u32 m0, s101, 2048
  s_nop 0
  buffer_load_dwordx4 v32, s[8:11], s100 offen nt lds
  s_add_u32 m0, s101, 3072
  s_nop 0
  buffer_load_dwordx4 v33, s[12:15], s100 offen nt lds
  s_add_u32 s100, s100, s38
  s_add_u32 m0, s101, 4096
  s_nop 0
  buffer_load_dwordx4 v32, s[8:11], s100 offen nt lds
  s_add_u32 m0, s101, 5120
  s_nop 0
  buffer_load_dwordx4 v33, s[12:15], s100 offen nt lds
  s_add_u32 s100, s100, s38
  s_add_u32 m0, s101, 6144
  s_nop 0
  buffer_load_dwordx4 v32, s[8:11], s100 offen nt lds
  s_add_u32 m0, s101, 7168
  s_nop 0
  buffer_load_dwordx4 v33, s[12:15], s100 offen nt lds
  s_add_u32 s100, s100, s38
  s_add_u32 s28, s29, 0
  s_mul_i32 s92, s28, s91
  s_add_u32 s92, s92, 4194304
  s_add_u32 s28, s29, 1
  s_mul_i32 s93, s28, s91
  s_add_u32 s93, s93, 4194304
  buffer_load_dwordx4 a[252:255], v1, s[84:87], s88 offen
  s_add_u32 s56, s6, 0
  s_addc_u32 s57, s7, 0
  s_mov_b32 s58, 4194304
  s_mov_b32 s59, 0x20000
  s_mov_b32 s20, s46
  s_mov_b32 s21, s47
  s_mov_b32 s22, 256
  s_mov_b32 s23, 0x20000
  v_mov_b32 v208, -1
  v_mov_b32 v209, -1
  v_mov_b32 v210, -1
  v_mov_b32 v211, -1
  v_mov_b32 v212, 0
  v_lshlrev_b32 v9, 4, v199
  s_lshl_b32 s39, s2, 13
  s_add_u32 s39, s39, 524288
  buffer_store_dwordx4 v[208:211], v9, s[24:27], s39 offen sc1
  s_add_u32 s39, s39, 0x1000
  buffer_store_dwordx4 v[208:211], v9, s[24:27], s39 offen sc1
  v_lshlrev_b32 v9, 2, v0
  s_lshl_b32 s39, s2, 8
  s_add_u32 s39, s39, 262144
  s_cmp_eq_u32 s30, 1
  s_cselect_b32 s39, s39, 0x7f000000
  buffer_store_dword v208, v9, s[24:27], s39 offen sc1
  s_mul_i32 s39, s2, 192
  s_add_u32 s39, s39, 16384
  s_cmp_eq_u32 s30, 3
  s_cselect_b32 s39, s39, 0x7f000000
  s_mov_b32 exec_hi, 0xffff
  buffer_store_dword v212, v9, s[24:27], s39 offen sc1
  v_lshlrev_b32 v9, 8, v0
  s_lshl_b32 s39, s2, 9
  s_add_u32 s39, s39, 393216
  s_cmp_eq_u32 s30, 0
  s_cselect_b32 s39, s39, 0x7f000000
  s_mov_b64 exec, 3
  buffer_store_dword v212, v9, s[24:27], s39 offen sc1
  s_mov_b64 exec, -1
  s_mov_b32 s90, 0x7f000000
  s_mul_i32 s101, s30, 16384
  s_add_u32 s101, s101, 32768
  v_lshlrev_b32 v8, 11, v15
  v_lshl_add_u32 v8, v13, 3, v8
  v_add_u32 v8, s101, v8
  s_mul_i32 s33, s30, 4
  s_mov_b32 s31, 0
  s_cmp_lt_u32 s2, 224
  s_cbranch_scc0 cv1_plain
  s_lshr_b32 s28, s2, 2
  s_and_b32 s29, s2, 3
  s_mul_i32 s90, s29, 53248
  s_lshl_b32 s29, s29, 4
  s_add_u32 s29, s29, s33
  s_mov_b64 s[8:9], s[40:41]
  s_mov_b64 s[12:13], s[42:43]
  s_movk_i32 s38, 7168
  s_mov_b32 s10, 7340032
  s_movk_i32 s91, 7168
  s_lshl_b32 s100, s28, 7
  s_lshl_b32 s28, s28, 2
  s_add_u32 s39, s28, 0
  s_mul_i32 s76, s39, 9363
  s_lshr_b32 s76, s76, 16
  s_mul_i32 s76, s76, 441
  s_add_u32 s76, s76, s39
  s_lshl_b32 s76, s76, 10
  s_add_u32 s76, s76, 8388608
  s_add_u32 s39, s28, 1
  s_mul_i32 s77, s39, 9363
  s_lshr_b32 s77, s77, 16
  s_mul_i32 s77, s77, 441
  s_add_u32 s77, s77, s39
  s_lshl_b32 s77, s77, 10
  s_add_u32 s77, s77, 8388608
  s_add_u32 s39, s28, 2
  s_mul_i32 s78, s39, 9363
  s_lshr_b32 s78, s78, 16
  s_mul_i32 s78, s78, 441
  s_add_u32 s78, s78, s39
  s_lshl_b32 s78, s78, 10
  s_add_u32 s78, s78, 8388608
  s_add_u32 s39, s28, 3
  s_mul_i32 s79, s39, 9363
  s_lshr_b32 s79, s79, 16
  s_mul_i32 s79, s79, 441
  s_add_u32 s79, s79, s39
  s_lshl_b32 s79, s79, 10
  s_add_u32 s79, s79, 8388608
  s_lshl_b32 s39, s28, 7
  s_add_u32 s90, s90, s39
  s_add_u32 s90, s90, 2646016
  v_mul_lo_u32 v32, v3, s38
  v_bfe_u32 v9, v0, 1, 2
  v_xor_b32 v9, v9, v14
  v_and_b32 v10, 1, v0
  v_lshl_add_u32 v32, v10, 4, v32
  v_xor_b32 v10, 2, v9
  v_lshl_add_u32 v33, v10, 5, v32
  v_lshl_add_u32 v32, v9, 5, v32
  v_lshl_add_u32 v8, v14, 10, v8
  v_lshl_add_u32 v8, v12, 7, v8
  v_lshrrev_b32 v9, 1, v12
  v_lshl_add_u32 v9, v14, 1, v9
  v_xor_b32 v10, 0, v9
  v_lshl_add_u32 v248, v10, 5, v8
  v_add_u32 v249, 512, v248
  v_xor_b32 v10, 1, v9
  v_lshl_add_u32 v250, v10, 5, v8
  v_add_u32 v251, 512, v250
  v_xor_b32 v10, 2, v9
  v_lshl_add_u32 v252, v10, 5, v8
  v_add_u32 v253, 512, v252
  v_xor_b32 v10, 3, v9
  v_lshl_add_u32 v254, v10, 5, v8
  v_add_u32 v255, 512, v254
  s_branch cv1_dma
cv1_plain:
  s_sub_u32 s39, s2, 224
  s_and_b32 s28, s39, 7
  s_lshr_b32 s29, s39, 3
  s_lshl_b32 s29, s29, 4
  s_add_u32 s29, s29, s33
  s_mov_b32 s31, 1
  s_mov_b64 s[8:9], s[44:45]
  s_movk_i32 s38, 2048
  s_mov_b32 s10, 7340032
  s_movk_i32 s91, 4096
  s_mul_i32 s39, s28, 917504
  s_add_u32 s39, s39, 23068672
  s_cmp_ge_u32 s29, 0
  s_cselect_b32 s39, 0x7f000000, s39
  s_mov_b32 s10, 0
  s_cmp_ge_u32 s29, 112
  s_cselect_b32 s79, 2048, 0
  s_add_u32 s76, s39, s79
  s_add_u32 s77, s76, 1024
  s_sub_u32 s78, s39, s79
  s_add_u32 s78, s78, 2048
  s_add_u32 s79, s78, 1024
  s_mov_b64 s[12:13], s[8:9]
  s_lshl_b32 s100, s28, 8
  v_lshrrev_b32 v9, 4, v0
  v_mul_lo_u32 v32, v9, s38
  v_xor_b32 v9, v9, v12
  v_lshl_add_u32 v32, v9, 6, v32
  v_and_b32 v10, 3, v0
  v_lshl_add_u32 v32, v10, 4, v32
  s_lshl_b32 s39, s38, 2
  v_add_u32 v33, s39, v32
  v_lshl_add_u32 v8, v14, 5, v8
  v_lshl_add_u32 v8, v12, 8, v8
  v_xor_b32 v10, 0, v12
  v_lshl_add_u32 v248, v10, 6, v8
  v_add_u32 v249, 1024, v248
  v_xor_b32 v10, 1, v12
  v_lshl_add_u32 v250, v10, 6, v8
  v_add_u32 v251, 1024, v250
  v_xor_b32 v10, 2, v12
  v_lshl_add_u32 v252, v10, 6, v8
  v_add_u32 v253, 1024, v252
  v_xor_b32 v10, 3, v12
  v_lshl_add_u32 v254, v10, 6, v8
  v_add_u32 v255, 1024, v254
cv1_dma:
  s_mov_b32 s11, 0x20000
  s_mov_b32 s14, s10
  s_mov_b32 s15, 0x20000
  s_lshl_b32 s39, s29, 4
  s_mul_i32 s39, s39, s38
  s_add_u32 s100, s39, s100
  s_lshl_b32 s38, s38, 3
  s_add_u32 m0, s101, 0
  s_nop 0
  buffer_load_dwordx4 v32, s[8:11], s100 offen nt lds
  s_add_u32 m0, s101, 1024
  s_nop 0
  buffer_load_dwordx4 v33, s[12:15], s100 offen nt lds
  s_add_u32 s100, s100, s38
  s_add_u32 m0, s101, 2048
  s_nop 0
  buffer_load_dwordx4 v32, s[8:11], s100 offen nt lds
  s_add_u32 m0, s101, 3072
  s_nop 0
  buffer_load_dwordx4 v33, s[12:15], s100 offen nt lds
  s_add_u32 s100, s100, s38
  v_mov_b32 v198, 0x3f803f80
  v_lshrrev_b32 v8, 5, v5
  v_lshlrev_b32 v8, 16, v8
  v_and_b32 v9, 31, v5
  v_lshl_add_u32 v8, v9, 4, v8
  v_lshl_add_u32 v8, v6, 9, v8
  v_mov_b32 v44, 0
  v_mov_b32 v45, 0
  s_waitcnt vmcnt(18)
  s_movk_i32 s39, 0
  buffer_store_dwordx4 v[16:19], v8, s[56:59], s39 offen sc1
  s_movk_i32 s39, 4096
  buffer_store_dwordx4 v[20:23], v8, s[56:59], s39 offen sc1
  s_movk_i32 s39, 8192
  buffer_store_dwordx4 v[24:27], v8, s[56:59], s39 offen sc1
  s_movk_i32 s39, 12288
  buffer_store_dwordx4 v[28:31], v8, s[56:59], s39 offen sc1
  v_dot2_f32_bf16 v44, v16, v198, v44
  v_dot2_f32_bf16 v45, v16, v16, v45
  v_dot2_f32_bf16 v44, v17, v198, v44
  v_dot2_f32_bf16 v45, v17, v17, v45
  v_dot2_f32_bf16 v44, v18, v198, v44
  v_dot2_f32_bf16 v45, v18, v18, v45
  v_dot2_f32_bf16 v44, v19, v198, v44
  v_dot2_f32_bf16 v45, v19, v19, v45
  v_dot2_f32_bf16 v44, v20, v198, v44
  v_dot2_f32_bf16 v45, v20, v20, v45
  v_dot2_f32_bf16 v44, v21, v198, v44
  v_dot2_f32_bf16 v45, v21, v21, v45
  v_dot2_f32_bf16 v44, v22, v198, v44
  v_dot2_f32_bf16 v45, v22, v22, v45
  v_dot2_f32_bf16 v44, v23, v198, v44
  v_dot2_f32_bf16 v45, v23, v23, v45
  v_dot2_f32_bf16 v44, v24, v198, v44
  v_dot2_f32_bf16 v45, v24, v24, v45
  v_dot2_f32_bf16 v44, v25, v198, v44
  v_dot2_f32_bf16 v45, v25, v25, v45
  v_dot2_f32_bf16 v44, v26, v198, v44
  v_dot2_f32_bf16 v45, v26, v26, v45
  v_dot2_f32_bf16 v44, v27, v198, v44
  v_dot2_f32_bf16 v45, v27, v27, v45
  v_dot2_f32_bf16 v44, v28, v198, v44
  v_dot2_f32_bf16 v45, v28, v28, v45
  v_dot2_f32_bf16 v44, v29, v198, v44
  v_dot2_f32_bf16 v45, v29, v29, v45
  v_dot2_f32_bf16 v44, v30, v198, v44
  v_dot2_f32_bf16 v45, v30, v30, v45
  v_dot2_f32_bf16 v44, v31, v198, v44
  v_dot2_f32_bf16 v45, v31, v31, v45
  v_lshlrev_b32 v9, 7, v4
  s_lshl_b32 s39, s30, 5
  s_add_u32 s39, s39, 131072
  v_add_u32 v9, s39, v9
  v_lshl_add_u32 v9, v3, 2, v9
  ds_write_b32 v9, v44
  ds_write_b32 v9, v45 offset:1024
  v_mov_b32 v40, 0
  v_mov_b32 v41, 0
  v_mov_b32 v42, 0
  v_mov_b32 v43, 0
  s_waitcnt vmcnt(18)
  ds_read_b64_tr_b16 v[48:49], v112 offset:0
  ds_read_b64_tr_b16 v[50:51], v113 offset:0
  ds_read_b64_tr_b16 v[52:53], v114 offset:0
  ds_read_b64_tr_b16 v[54:55], v115 offset:0
  ds_read_b64_tr_b16 v[56:57], v116 offset:0
  ds_read_b64_tr_b16 v[58:59], v117 offset:0
  ds_read_b64_tr_b16 v[60:61], v118 offset:0
  ds_read_b64_tr_b16 v[62:63], v119 offset:0
  s_waitcnt lgkmcnt(0)
  s_add_u32 s39, s48, s92
  buffer_store_dwordx4 v[48:51], v1, s[24:27], s39 offen sc1
  s_add_u32 s39, s49, s92
  buffer_store_dwordx4 v[52:55], v1, s[24:27], s39 offen sc1
  s_add_u32 s39, s50, s92
  buffer_store_dwordx4 v[56:59], v1, s[24:27], s39 offen sc1
  s_add_u32 s39, s51, s92
  buffer_store_dwordx4 v[60:63], v1, s[24:27], s39 offen sc1
  v_dot2_f32_bf16 v40, v48, v198, v40
  v_dot2_f32_bf16 v41, v52, v198, v41
  v_dot2_f32_bf16 v42, v56, v198, v42
  v_dot2_f32_bf16 v43, v60, v198, v43
  v_dot2_f32_bf16 v40, v49, v198, v40
  v_dot2_f32_bf16 v41, v53, v198, v41
  v_dot2_f32_bf16 v42, v57, v198, v42
  v_dot2_f32_bf16 v43, v61, v198, v43
  v_dot2_f32_bf16 v40, v50, v198, v40
  v_dot2_f32_bf16 v41, v54, v198, v41
  v_dot2_f32_bf16 v42, v58, v198, v42
  v_dot2_f32_bf16 v43, v62, v198, v43
  v_dot2_f32_bf16 v40, v51, v198, v40
  v_dot2_f32_bf16 v41, v55, v198, v41
  v_dot2_f32_bf16 v42, v59, v198, v42
  v_dot2_f32_bf16 v43, v63, v198, v43
  s_waitcnt vmcnt(18)
  ds_read_b64_tr_b16 v[64:65], v112 offset:4096
  ds_read_b64_tr_b16 v[66:67], v113 offset:4096
  ds_read_b64_tr_b16 v[68:69], v114 offset:4096
  ds_read_b64_tr_b16 v[70:71], v115 offset:4096
  ds_read_b64_tr_b16 v[72:73], v116 offset:4096
  ds_read_b64_tr_b16 v[74:75], v117 offset:4096
  ds_read_b64_tr_b16 v[76:77], v118 offset:4096
  ds_read_b64_tr_b16 v[78:79], v119 offset:4096
  s_waitcnt lgkmcnt(0)
  s_add_u32 s39, s48, s93
  buffer_store_dwordx4 v[64:67], v1, s[24:27], s39 offen sc1
  s_add_u32 s39, s49, s93
  buffer_store_dwordx4 v[68:71], v1, s[24:27], s39 offen sc1
  s_add_u32 s39, s50, s93
  buffer_store_dwordx4 v[72:75], v1, s[24:27], s39 offen sc1
  s_add_u32 s39, s51, s93
  buffer_store_dwordx4 v[76:79], v1, s[24:27], s39 offen sc1
  v_dot2_f32_bf16 v40, v64, v198, v40
  v_dot2_f32_bf16 v41, v68, v198, v41
  v_dot2_f32_bf16 v42, v72, v198, v42
  v_dot2_f32_bf16 v43, v76, v198, v43
  v_dot2_f32_bf16 v40, v65, v198, v40
  v_dot2_f32_bf16 v41, v69, v198, v41
  v_dot2_f32_bf16 v42, v73, v198, v42
  v_dot2_f32_bf16 v43, v77, v198, v43
  v_dot2_f32_bf16 v40, v66, v198, v40
  v_dot2_f32_bf16 v41, v70, v198, v41
  v_dot2_f32_bf16 v42, v74, v198, v42
  v_dot2_f32_bf16 v43, v78, v198, v43
  v_dot2_f32_bf16 v40, v67, v198, v40
  v_dot2_f32_bf16 v41, v71, v198, v41
  v_dot2_f32_bf16 v42, v75, v198, v42
  v_dot2_f32_bf16 v43, v79, v198, v43
  v_lshlrev_b32 v9, 2, v0
  s_lshl_b32 s39, s30, 10
  s_add_u32 s39, s39, 133120
  v_add_u32 v9, s39, v9
  ds_write_b32 v9, v40 offset:0
  ds_write_b32 v9, v41 offset:256
  ds_write_b32 v9, v42 offset:512
  ds_write_b32 v9, v43 offset:768
  s_waitcnt lgkmcnt(0)
  s_barrier
  v_bfe_u32 v9, v199, 5, 2
  v_lshlrev_b32 v9, 8, v9
  v_and_b32 v197, 31, v199
  v_lshl_add_u32 v9, v197, 2, v9
  v_add_u32 v9, 133120, v9
  ds_read_b32 v200, v9 offset:0
  ds_read_b32 v201, v9 offset:128
  ds_read_b32 v202, v9 offset:1024
  ds_read_b32 v203, v9 offset:1152
  ds_read_b32 v204, v9 offset:2048
  ds_read_b32 v205, v9 offset:2176
  ds_read_b32 v206, v9 offset:3072
  ds_read_b32 v207, v9 offset:3200
  s_cmp_lt_u32 s30, 2
  s_cselect_b32 s39, s89, 0x7f000000
  v_lshlrev_b32 v9, 2, v199
  s_waitcnt lgkmcnt(0)
  v_add_f32 v200, v200, v201
  v_add_f32 v200, v200, v202
  v_add_f32 v200, v200, v203
  v_add_f32 v200, v200, v204
  v_add_f32 v200, v200, v205
  v_add_f32 v200, v200, v206
  v_add_f32 v200, v200, v207
  buffer_store_dword v200, v9, s[24:27], s39 offen sc1
  v_and_b32 v9, 15, v0
  v_lshlrev_b32 v9, 7, v9
  v_add_u32 v9, 131072, v9
  ds_read_b128 v[216:219], v9 offset:0
  ds_read_b128 v[220:223], v9 offset:16
  ds_read_b128 v[224:227], v9 offset:32
  ds_read_b128 v[228:231], v9 offset:48
  ds_read_b128 v[232:235], v9 offset:64
  ds_read_b128 v[236:239], v9 offset:80
  ds_read_b128 v[240:243], v9 offset:96
  ds_read_b128 v[244:247], v9 offset:112
  v_lshlrev_b32 v9, 13, v3
  v_add_u32 v10, s3, v4
  v_lshl_add_u32 v9, v10, 2, v9
  s_cmp_eq_u32 s30, 2
  s_cselect_b32 s39, 0, 0x7f000000
  s_waitcnt lgkmcnt(0)
  v_pk_add_f32 v[216:217], v[216:217], v[232:233]
  v_pk_add_f32 v[218:219], v[218:219], v[234:235]
  v_pk_add_f32 v[220:221], v[220:221], v[236:237]
  v_pk_add_f32 v[222:223], v[222:223], v[238:239]
  v_pk_add_f32 v[224:225], v[224:225], v[240:241]
  v_pk_add_f32 v[226:227], v[226:227], v[242:243]
  v_pk_add_f32 v[228:229], v[228:229], v[244:245]
  v_pk_add_f32 v[230:231], v[230:231], v[246:247]
  v_pk_add_f32 v[216:217], v[216:217], v[224:225]
  v_pk_add_f32 v[218:219], v[218:219], v[226:227]
  v_pk_add_f32 v[220:221], v[220:221], v[228:229]
  v_pk_add_f32 v[222:223], v[222:223], v[230:231]
  v_pk_add_f32 v[216:217], v[216:217], v[220:221]
  v_pk_add_f32 v[218:219], v[218:219], v[222:223]
  v_pk_add_f32 v[216:217], v[216:217], v[218:219]
  v_add_f32 v216, v216, v217
  s_mov_b64 exec, 0xffff
  buffer_store_dword v216, v9, s[24:27], s39 offen sc1
  s_mov_b64 exec, -1
  s_add_u32 m0, s101, 4096
  s_nop 0
  buffer_load_dwordx4 v32, s[8:11], s100 offen nt lds
  s_add_u32 m0, s101, 5120
  s_nop 0
  buffer_load_dwordx4 v33, s[12:15], s100 offen nt lds
  s_add_u32 s100, s100, s38
  s_add_u32 m0, s101, 6144
  s_nop 0
  buffer_load_dwordx4 v32, s[8:11], s100 offen nt lds
  s_add_u32 m0, s101, 7168
  s_nop 0
  buffer_load_dwordx4 v33, s[12:15], s100 offen nt lds
  s_add_u32 s100, s100, s38
  s_waitcnt vmcnt(4)
  s_barrier
  s_mov_b32 s35, 1
  s_cmp_lg_u32 s30, 0
  s_cbranch_scc1 cv_arr
  s_atomic_add s35, s[46:47], 0 glc
cv_arr:
  s_add_u32 m0, s101, 8192
  s_nop 0
  buffer_load_dwordx4 v32, s[8:11], s100 offen nt lds
  s_add_u32 m0, s101, 9216
  s_nop 0
  buffer_load_dwordx4 v33, s[12:15], s100 offen nt lds
  s_add_u32 s100, s100, s38
  s_add_u32 m0, s101, 10240
  s_nop 0
  buffer_load_dwordx4 v32, s[8:11], s100 offen nt lds
  s_add_u32 m0, s101, 11264
  s_nop 0
  buffer_load_dwordx4 v33, s[12:15], s100 offen nt lds
  s_add_u32 s100, s100, s38
  s_waitcnt lgkmcnt(0)
  s_cmp_lg_u32 s35, 255
  s_cbranch_scc1 cv_nogo
  s_atomic_add s35, s[46:47], 128
cv_nogo:
  s_add_u32 m0, s101, 12288
  s_nop 0
  buffer_load_dwordx4 v32, s[8:11], s100 offen nt lds
  s_add_u32 m0, s101, 13312
  s_nop 0
  buffer_load_dwordx4 v33, s[12:15], s100 offen nt lds
  s_add_u32 s100, s100, s38
  s_add_u32 m0, s101, 14336
  s_nop 0
  buffer_load_dwordx4 v32, s[8:11], s100 offen nt lds
  s_add_u32 m0, s101, 15360
  s_nop 0
  buffer_load_dwordx4 v33, s[12:15], s100 offen nt lds
  s_add_u32 s100, s100, s38
  s_add_u32 s28, s29, 0
  s_mul_i32 s32, s28, 9363
  s_lshr_b32 s32, s32, 16
  s_mul_i32 s39, s32, 7
  s_sub_u32 s39, s28, s39
  s_lshr_b32 s33, s32, 4
  s_mul_i32 s33, s33, 112
  s_add_u32 s33, s33, s39
  s_and_b32 s32, s32, 15
  s_mul_i32 s34, s32, 3
  s_mul_i32 s32, s32, 4
  s_add_u32 s32, s32, 45
  s_cmp_lt_u32 s39, 3
  s_cselect_b32 s32, s34, s32
  s_add_u32 s32, s32, s33
  s_cmp_eq_u32 s31, 1
  s_cselect_b32 s28, s32, s28
  s_mul_i32 s96, s28, s91
  s_add_u32 s96, s96, 4194304
  s_add_u32 s28, s29, 1
  s_mul_i32 s32, s28, 9363
  s_lshr_b32 s32, s32, 16
  s_mul_i32 s39, s32, 7
  s_sub_u32 s39, s28, s39
  s_lshr_b32 s33, s32, 4
  s_mul_i32 s33, s33, 112
  s_add_u32 s33, s33, s39
  s_and_b32 s32, s32, 15
  s_mul_i32 s34, s32, 3
  s_mul_i32 s32, s32, 4
  s_add_u32 s32, s32, 45
  s_cmp_lt_u32 s39, 3
  s_cselect_b32 s32, s34, s32
  s_add_u32 s32, s32, s33
  s_cmp_eq_u32 s31, 1
  s_cselect_b32 s28, s32, s28
  s_mul_i32 s97, s28, s91
  s_add_u32 s97, s97, 4194304
  s_add_u32 s28, s29, 2
  s_mul_i32 s32, s28, 9363
  s_lshr_b32 s32, s32, 16
  s_mul_i32 s39, s32, 7
  s_sub_u32 s39, s28, s39
  s_lshr_b32 s33, s32, 4
  s_mul_i32 s33, s33, 112
  s_add_u32 s33, s33, s39
  s_and_b32 s32, s32, 15
  s_mul_i32 s34, s32, 3
  s_mul_i32 s32, s32, 4
  s_add_u32 s32, s32, 45
  s_cmp_lt_u32 s39, 3
  s_cselect_b32 s32, s34, s32
  s_add_u32 s32, s32, s33
  s_cmp_eq_u32 s31, 1
  s_cselect_b32 s28, s32, s28
  s_mul_i32 s98, s28, s91
  s_add_u32 s98, s98, 4194304
  s_add_u32 s28, s29, 3
  s_mul_i32 s32, s28, 9363
  s_lshr_b32 s32, s32, 16
  s_mul_i32 s39, s32, 7
  s_sub_u32 s39, s28, s39
  s_lshr_b32 s33, s32, 4
  s_mul_i32 s33, s33, 112
  s_add_u32 s33, s33, s39
  s_and_b32 s32, s32, 15
  s_mul_i32 s34, s32, 3
  s_mul_i32 s32, s32, 4
  s_add_u32 s32, s32, 45
  s_cmp_lt_u32 s39, 3
  s_cselect_b32 s32, s34, s32
  s_add_u32 s32, s32, s33
  s_cmp_eq_u32 s31, 1
  s_cselect_b32 s28, s32, s28
  s_mul_i32 s99, s28, s91
  s_add_u32 s99, s99, 4194304
  v_mov_b32 v213, 0
  v_mov_b32 v192, 0
  v_mov_b32 v193, 0
  v_mov_b32 v194, 0
  v_mov_b32 v195, 0
  s_waitcnt vmcnt(26)
  ds_read_b64_tr_b16 v[128:129], v248 offset:0
  ds_read_b64_tr_b16 v[130:131], v249 offset:0
  ds_read_b64_tr_b16 v[132:133], v250 offset:0
  ds_read_b64_tr_b16 v[134:135], v251 offset:0
  ds_read_b64_tr_b16 v[136:137], v252 offset:0
  ds_read_b64_tr_b16 v[138:139], v253 offset:0
  ds_read_b64_tr_b16 v[140:141], v254 offset:0
  ds_read_b64_tr_b16 v[142:143], v255 offset:0
  s_waitcnt lgkmcnt(0)
  s_add_u32 s39, s76, s96
  buffer_store_dwordx4 v[128:131], v1, s[24:27], s39 offen sc1
  s_add_u32 s39, s77, s96
  buffer_store_dwordx4 v[132:135], v1, s[24:27], s39 offen sc1
  s_add_u32 s39, s78, s96
  buffer_store_dwordx4 v[136:139], v1, s[24:27], s39 offen sc1
  s_add_u32 s39, s79, s96
  buffer_store_dwordx4 v[140:143], v1, s[24:27], s39 offen sc1
  v_dot2_f32_bf16 v192, v128, v198, v192
  v_dot2_f32_bf16 v193, v132, v198, v193
  v_dot2_f32_bf16 v194, v136, v198, v194
  v_dot2_f32_bf16 v195, v140, v198, v195
  v_dot2_f32_bf16 v192, v129, v198, v192
  v_dot2_f32_bf16 v193, v133, v198, v193
  v_dot2_f32_bf16 v194, v137, v198, v194
  v_dot2_f32_bf16 v195, v141, v198, v195
  v_dot2_f32_bf16 v192, v130, v198, v192
  v_dot2_f32_bf16 v193, v134, v198, v193
  v_dot2_f32_bf16 v194, v138, v198, v194
  v_dot2_f32_bf16 v195, v142, v198, v195
  v_dot2_f32_bf16 v192, v131, v198, v192
  v_dot2_f32_bf16 v193, v135, v198, v193
  v_dot2_f32_bf16 v194, v139, v198, v194
  v_dot2_f32_bf16 v195, v143, v198, v195
  s_waitcnt vmcnt(12)
  ds_read_b64_tr_b16 v[144:145], v248 offset:4096
  ds_read_b64_tr_b16 v[146:147], v249 offset:4096
  ds_read_b64_tr_b16 v[148:149], v250 offset:4096
  ds_read_b64_tr_b16 v[150:151], v251 offset:4096
  ds_read_b64_tr_b16 v[152:153], v252 offset:4096
  ds_read_b64_tr_b16 v[154:155], v253 offset:4096
  ds_read_b64_tr_b16 v[156:157], v254 offset:4096
  ds_read_b64_tr_b16 v[158:159], v255 offset:4096
  s_waitcnt lgkmcnt(0)
  s_add_u32 s39, s76, s97
  buffer_store_dwordx4 v[144:147], v1, s[24:27], s39 offen sc1
  s_add_u32 s39, s77, s97
  buffer_store_dwordx4 v[148:151], v1, s[24:27], s39 offen sc1
  s_add_u32 s39, s78, s97
  buffer_store_dwordx4 v[152:155], v1, s[24:27], s39 offen sc1
  s_add_u32 s39, s79, s97
  buffer_store_dwordx4 v[156:159], v1, s[24:27], s39 offen sc1
  buffer_load_dword v214, v213, s[20:23], 0 offen offset:128 sc1
  v_dot2_f32_bf16 v192, v144, v198, v192
  v_dot2_f32_bf16 v193, v148, v198, v193
  v_dot2_f32_bf16 v194, v152, v198, v194
  v_dot2_f32_bf16 v195, v156, v198, v195
  v_dot2_f32_bf16 v192, v145, v198, v192
  v_dot2_f32_bf16 v193, v149, v198, v193
  v_dot2_f32_bf16 v194, v153, v198, v194
  v_dot2_f32_bf16 v195, v157, v198, v195
  v_dot2_f32_bf16 v192, v146, v198, v192
  v_dot2_f32_bf16 v193, v150, v198, v193
  v_dot2_f32_bf16 v194, v154, v198, v194
  v_dot2_f32_bf16 v195, v158, v198, v195
  v_dot2_f32_bf16 v192, v147, v198, v192
  v_dot2_f32_bf16 v193, v151, v198, v193
  v_dot2_f32_bf16 v194, v155, v198, v194
  v_dot2_f32_bf16 v195, v159, v198, v195
  s_waitcnt vmcnt(9)
  ds_read_b64_tr_b16 v[160:161], v248 offset:8192
  ds_read_b64_tr_b16 v[162:163], v249 offset:8192
  ds_read_b64_tr_b16 v[164:165], v250 offset:8192
  ds_read_b64_tr_b16 v[166:167], v251 offset:8192
  ds_read_b64_tr_b16 v[168:169], v252 offset:8192
  ds_read_b64_tr_b16 v[170:171], v253 offset:8192
  ds_read_b64_tr_b16 v[172:173], v254 offset:8192
  ds_read_b64_tr_b16 v[174:175], v255 offset:8192
  s_waitcnt lgkmcnt(0)
  s_add_u32 s39, s76, s98
  buffer_store_dwordx4 v[160:163], v1, s[24:27], s39 offen sc1
  s_add_u32 s39, s77, s98
  buffer_store_dwordx4 v[164:167], v1, s[24:27], s39 offen sc1
  s_add_u32 s39, s78, s98
  buffer_store_dwordx4 v[168:171], v1, s[24:27], s39 offen sc1
  s_add_u32 s39, s79, s98
  buffer_store_dwordx4 v[172:175], v1, s[24:27], s39 offen sc1
  v_dot2_f32_bf16 v192, v160, v198, v192
  v_dot2_f32_bf16 v193, v164, v198, v193
  v_dot2_f32_bf16 v194, v168, v198, v194
  v_dot2_f32_bf16 v195, v172, v198, v195
  v_dot2_f32_bf16 v192, v161, v198, v192
  v_dot2_f32_bf16 v193, v165, v198, v193
  v_dot2_f32_bf16 v194, v169, v198, v194
  v_dot2_f32_bf16 v195, v173, v198, v195
  v_dot2_f32_bf16 v192, v162, v198, v192
  v_dot2_f32_bf16 v193, v166, v198, v193
  v_dot2_f32_bf16 v194, v170, v198, v194
  v_dot2_f32_bf16 v195, v174, v198, v195
  v_dot2_f32_bf16 v192, v163, v198, v192
  v_dot2_f32_bf16 v193, v167, v198, v193
  v_dot2_f32_bf16 v194, v171, v198, v194
  v_dot2_f32_bf16 v195, v175, v198, v195
  s_waitcnt vmcnt(4)
  s_and_b32 s39, s2, 7
  s_lshr_b32 s40, s2, 3
  s_and_b32 s42, s40, 3
  s_lshr_b32 s43, s40, 2
  s_and_b32 s41, s39, 1
  s_lshl_b32 s41, s41, 2
  s_add_u32 s48, s41, s42
  s_lshr_b32 s41, s39, 1
  s_lshl_b32 s41, s41, 3
  s_add_u32 s49, s41, s43
  s_and_b32 s41, s39, 3
  s_lshl_b32 s41, s41, 2
  s_add_u32 s50, s41, s42
  s_lshr_b32 s41, s39, 2
  s_lshl_b32 s41, s41, 3
  s_add_u32 s51, s41, s43
  s_lshl_b32 s31, s48, 3
  s_lshl_b32 s39, s30, 1
  s_add_u32 s31, s31, s39
  s_lshl_b32 s32, s50, 2
  s_add_u32 s32, s32, s30
  s_and_b32 s39, s49, 1
  s_lshl_b32 s39, s39, 2
  s_lshl_b32 s40, s48, 3
  s_add_u32 s39, s39, s40
  s_add_u32 s100, s39, s30
  s_and_b32 s39, s49, 14
  s_lshr_b32 s40, s49, 4
  s_add_u32 s101, s39, s40
  s_mov_b32 s52, 1069066811
  s_mov_b32 s53, 1069066811
  s_mov_b32 s54, 897988541
  s_mov_b32 s55, 897988541
  s_mov_b32 s91, 0
  v_mov_b32 v8, 0
  s_movk_i32 s29, 4096
  s_mov_b32 s3, 0
  s_mov_b32 s28, 393216
  s_mov_b32 s56, s44
  s_mov_b32 s57, s45
  s_mov_b32 s58, 7340032
  s_mov_b32 s59, 0x20000
  s_mov_b32 s89, 0
  v_cmp_eq_u32 vcc, 0, v214
  s_nop 4
  s_cbranch_vccz cvw_ok
  ds_read_b64_tr_b16 v[176:177], v248 offset:12288
  ds_read_b64_tr_b16 v[178:179], v249 offset:12288
  ds_read_b64_tr_b16 v[180:181], v250 offset:12288
  ds_read_b64_tr_b16 v[182:183], v251 offset:12288
  ds_read_b64_tr_b16 v[184:185], v252 offset:12288
  ds_read_b64_tr_b16 v[186:187], v253 offset:12288
  ds_read_b64_tr_b16 v[188:189], v254 offset:12288
  ds_read_b64_tr_b16 v[190:191], v255 offset:12288
  s_waitcnt lgkmcnt(0)
  s_add_u32 s39, s76, s99
  buffer_store_dwordx4 v[176:179], v1, s[24:27], s39 offen sc1
  s_add_u32 s39, s77, s99
  buffer_store_dwordx4 v[180:183], v1, s[24:27], s39 offen sc1
  s_add_u32 s39, s78, s99
  buffer_store_dwordx4 v[184:187], v1, s[24:27], s39 offen sc1
  s_add_u32 s39, s79, s99
  buffer_store_dwordx4 v[188:191], v1, s[24:27], s39 offen sc1
  v_dot2_f32_bf16 v192, v176, v198, v192
  v_dot2_f32_bf16 v193, v180, v198, v193
  v_dot2_f32_bf16 v194, v184, v198, v194
  v_dot2_f32_bf16 v195, v188, v198, v195
  v_dot2_f32_bf16 v192, v177, v198, v192
  v_dot2_f32_bf16 v193, v181, v198, v193
  v_dot2_f32_bf16 v194, v185, v198, v194
  v_dot2_f32_bf16 v195, v189, v198, v195
  v_dot2_f32_bf16 v192, v178, v198, v192
  v_dot2_f32_bf16 v193, v182, v198, v193
  v_dot2_f32_bf16 v194, v186, v198, v194
  v_dot2_f32_bf16 v195, v190, v198, v195
  v_dot2_f32_bf16 v192, v179, v198, v192
  v_dot2_f32_bf16 v193, v183, v198, v193
  v_dot2_f32_bf16 v194, v187, v198, v194
  v_dot2_f32_bf16 v195, v191, v198, v195
  v_lshlrev_b32 v9, 2, v0
  s_lshl_b32 s39, s30, 10
  s_add_u32 s39, s39, 137216
  v_add_u32 v9, s39, v9
  ds_write_b32 v9, v192 offset:0
  ds_write_b32 v9, v193 offset:256
  ds_write_b32 v9, v194 offset:512
  ds_write_b32 v9, v195 offset:768
  s_waitcnt lgkmcnt(0)
  s_barrier
  v_bfe_u32 v9, v199, 5, 2
  v_lshlrev_b32 v9, 8, v9
  v_and_b32 v197, 31, v199
  v_lshl_add_u32 v9, v197, 2, v9
  v_add_u32 v9, 137216, v9
  ds_read_b32 v200, v9 offset:0
  ds_read_b32 v201, v9 offset:128
  ds_read_b32 v202, v9 offset:1024
  ds_read_b32 v203, v9 offset:1152
  ds_read_b32 v204, v9 offset:2048
  ds_read_b32 v205, v9 offset:2176
  ds_read_b32 v206, v9 offset:3072
  ds_read_b32 v207, v9 offset:3200
  s_cmp_lt_u32 s30, 2
  s_cselect_b32 s39, s90, 0x7f000000
  v_lshlrev_b32 v9, 2, v199
  s_waitcnt lgkmcnt(0)
  v_add_f32 v200, v200, v201
  v_add_f32 v200, v200, v202
  v_add_f32 v200, v200, v203
  v_add_f32 v200, v200, v204
  v_add_f32 v200, v200, v205
  v_add_f32 v200, v200, v206
  v_add_f32 v200, v200, v207
  buffer_store_dword v200, v9, s[24:27], s39 offen sc1
  s_barrier
  s_mov_b32 s89, 1
  s_mov_b32 s40, 200000
cvw_chk:
  v_cmp_eq_u32 vcc, 0, v214
  s_nop 4
  s_cbranch_vccz cvw_ok
  s_sleep 2
  buffer_load_dword v214, v213, s[20:23], 0 offen offset:128 sc1
  s_sub_u32 s40, s40, 1
  s_cmp_lg_u32 s40, 0
  s_waitcnt vmcnt(0)
  s_cbranch_scc1 cvw_chk
cvw_ok:
  s_mul_i32 s39, s49, 196608
  s_add_u32 s39, s39, 33554432
  s_add_u32 s16, s6, s39
  s_addc_u32 s17, s7, 0
  s_mov_b32 s18, 196608
  s_mov_b32 s19, 0x20000
  v_add_u32 v10, 4096, v1
  s_mul_i32 s39, s30, 6144
  v_add_u32 v2, s39, v1
  v_add_u32 v3, 0x1000, v2
  s_add_u32 s35, s39, 4096
  s_add_u32 s36, s39, 53248
  s_mov_b32 s37, 49152
  s_mov_b32 s33, 0
  s_mov_b32 s34, 0
  s_add_u32 m0, s35, 0
  s_nop 0
  buffer_load_dwordx4 v2, s[16:19], s34 offen offset:0 lds
  buffer_load_dwordx4 v2, s[16:19], s34 offen offset:1024 lds
  buffer_load_dwordx4 v2, s[16:19], s34 offen offset:2048 lds
  buffer_load_dwordx4 v2, s[16:19], s34 offen offset:3072 lds
  s_add_u32 m0, s35, 4096
  s_nop 0
  buffer_load_dwordx4 v3, s[16:19], s34 offen offset:0 lds
  buffer_load_dwordx4 v3, s[16:19], s34 offen offset:1024 lds
  s_add_u32 s34, s34, 24576
  v_and_b32 v24, 31, v0
  v_lshlrev_b32 v24, 2, v24
  v_lshl_add_u32 v25, v15, 12, v24
  v_mov_b32 v26, 0x7f000000
  v_cmp_gt_u32 vcc, 96, v199
  s_nop 1
  v_cndmask_b32 v25, v26, v25, vcc
  s_lshl_b32 s39, s49, 7
  s_lshl_b32 s40, s30, 13
  s_add_u32 s39, s39, s40
  s_add_u32 s39, s39, 2621440
  v_add_u32 v31, 12288, v25
  buffer_load_dword v26, v25, s[24:27], s39 offen
  buffer_load_dword v220, v31, s[24:27], s39 offen
  s_add_u32 s39, s39, 53248
  buffer_load_dword v27, v25, s[24:27], s39 offen
  buffer_load_dword v221, v31, s[24:27], s39 offen
  s_add_u32 s39, s39, 53248
  buffer_load_dword v28, v25, s[24:27], s39 offen
  buffer_load_dword v222, v31, s[24:27], s39 offen
  s_add_u32 s39, s39, 53248
  buffer_load_dword v29, v25, s[24:27], s39 offen
  buffer_load_dword v223, v31, s[24:27], s39 offen
ph_g1:
  buffer_load_dwordx4 a[252:255], v1, s[84:87], s88 offen
  s_lshl_b32 s39, s31, 16
  s_lshl_b32 s40, s3, 22
  s_add_u32 s39, s39, s40
  s_add_u32 s8, s6, s39
  s_addc_u32 s9, s7, 0
  s_mov_b32 s10, 65536
  s_mov_b32 s11, 0x20000
  s_add_u32 s39, s39, 0x10000
  s_add_u32 s12, s6, s39
  s_addc_u32 s13, s7, 0
  s_mov_b32 s14, 65536
  s_mov_b32 s15, 0x20000
  v_and_b32 v24, 31, v0
  v_lshlrev_b32 v24, 2, v24
  s_lshl_b32 s46, s31, 7
  s_lshl_b32 s47, s3, 14
  s_add_u32 s46, s46, s47
  s_add_u32 s47, s46, 0x2000
  s_mov_b32 s38, 3
  v_and_b32 v4, 15, v0
  v_lshlrev_b32 v4, 4, v4
  v_bfe_u32 v5, v0, 4, 1
  v_lshl_add_u32 v4, v5, 9, v4
  v_lshl_add_u32 v12, v15, 10, v4
  v_lshl_add_u32 v13, v15, 8, v4
  v_mul_u32_u24 v5, 3072, v15
  v_add_u32 v4, v4, v5
  v_add_u32 v10, 4096, v4
  v_add_u32 v11, 53248, v4
  v_and_b32 v24, 15, v0
  v_lshlrev_b32 v24, 2, v24
  v_lshrrev_b32 v14, 4, v0
  v_lshlrev_b32 v14, 4, v14
  s_cmp_eq_u32 s3, 0
  s_cbranch_scc1 g1_go
  s_add_u32 m0, s35, 24576
  s_nop 0
  buffer_load_dwordx4 v2, s[16:19], s34 offen offset:0 lds
  buffer_load_dwordx4 v2, s[16:19], s34 offen offset:1024 lds
  buffer_load_dwordx4 v2, s[16:19], s34 offen offset:2048 lds
  buffer_load_dwordx4 v2, s[16:19], s34 offen offset:3072 lds
  s_add_u32 m0, s35, 28672
  s_nop 0
  buffer_load_dwordx4 v3, s[16:19], s34 offen offset:0 lds
  buffer_load_dwordx4 v3, s[16:19], s34 offen offset:1024 lds
  s_add_u32 s34, s34, 24576
  s_add_u32 m0, s36, 0
  s_nop 0
  buffer_load_dwordx4 v2, s[16:19], s34 offen offset:0 lds
  buffer_load_dwordx4 v2, s[16:19], s34 offen offset:1024 lds
  buffer_load_dwordx4 v2, s[16:19], s34 offen offset:2048 lds
  buffer_load_dwordx4 v2, s[16:19], s34 offen offset:3072 lds
  s_add_u32 m0, s36, 4096
  s_nop 0
  buffer_load_dwordx4 v3, s[16:19], s34 offen offset:0 lds
  buffer_load_dwordx4 v3, s[16:19], s34 offen offset:1024 lds
  s_add_u32 s34, s34, 24576
  s_lshl_b32 s39, s48, 10
  s_add_u32 s39, s39, 32768
  s_add_u32 s39, s39, s28
  s_cmp_lg_u32 s30, 0
  s_cbranch_scc1 wt1_go
  v_and_b32 v8, 3, v0
  v_lshlrev_b32 v8, 8, v8
  s_mov_b64 exec, 15
  s_mov_b32 s40, 200000
wt1_poll:
  buffer_load_dword v9, v8, s[24:27], s39 offen sc1
  s_waitcnt vmcnt(0)
  v_cmp_gt_u32 vcc, 8, v9
  s_nop 4
  s_cbranch_vccz wt1_ok
  s_sleep 1
  s_sub_u32 s40, s40, 1
  s_cmp_lg_u32 s40, 0
  s_cbranch_scc1 wt1_poll
wt1_ok:
  s_mov_b64 exec, -1
wt1_go:
  s_waitcnt vmcnt(0) lgkmcnt(0)
  s_barrier
  s_add_u32 s28, s28, 65536
g1_go:
  buffer_load_dwordx4 a[0:3], v12, s[8:11], s33 offen offset:0
  buffer_load_dwordx4 a[4:7], v12, s[8:11], s33 offen offset:256
  buffer_load_dwordx4 a[8:11], v12, s[12:15], s33 offen offset:0
  buffer_load_dwordx4 a[12:15], v12, s[12:15], s33 offen offset:256
  buffer_load_dwordx4 a[16:19], v12, s[8:11], s33 offen offset:2048
  buffer_load_dwordx4 a[20:23], v12, s[8:11], s33 offen offset:2304
  buffer_load_dwordx4 a[24:27], v12, s[12:15], s33 offen offset:2048
  buffer_load_dwordx4 a[28:31], v12, s[12:15], s33 offen offset:2304
  s_add_u32 s33, s33, 0x1000
  buffer_load_dwordx4 a[32:35], v12, s[8:11], s33 offen offset:0
  buffer_load_dwordx4 a[36:39], v12, s[8:11], s33 offen offset:256
  buffer_load_dwordx4 a[40:43], v12, s[12:15], s33 offen offset:0
  buffer_load_dwordx4 a[44:47], v12, s[12:15], s33 offen offset:256
  buffer_load_dwordx4 a[48:51], v12, s[8:11], s33 offen offset:2048
  buffer_load_dwordx4 a[52:55], v12, s[8:11], s33 offen offset:2304
  buffer_load_dwordx4 a[56:59], v12, s[12:15], s33 offen offset:2048
  buffer_load_dwordx4 a[60:63], v12, s[12:15], s33 offen offset:2304
  s_cmp_lg_u32 s3, 0
  s_cbranch_scc1 g1_w_done
  s_cmp_eq_u32 s89, 1
  s_cbranch_scc1 g1_cv_done
  ds_read_b64_tr_b16 v[176:177], v248 offset:12288
  ds_read_b64_tr_b16 v[178:179], v249 offset:12288
  ds_read_b64_tr_b16 v[180:181], v250 offset:12288
  ds_read_b64_tr_b16 v[182:183], v251 offset:12288
  ds_read_b64_tr_b16 v[184:185], v252 offset:12288
  ds_read_b64_tr_b16 v[186:187], v253 offset:12288
  ds_read_b64_tr_b16 v[188:189], v254 offset:12288
  ds_read_b64_tr_b16 v[190:191], v255 offset:12288
  s_waitcnt lgkmcnt(0)
  s_add_u32 s39, s76, s99
  buffer_store_dwordx4 v[176:179], v1, s[24:27], s39 offen sc1
  s_add_u32 s39, s77, s99
  buffer_store_dwordx4 v[180:183], v1, s[24:27], s39 offen sc1
  s_add_u32 s39, s78, s99
  buffer_store_dwordx4 v[184:187], v1, s[24:27], s39 offen sc1
  s_add_u32 s39, s79, s99
  buffer_store_dwordx4 v[188:191], v1, s[24:27], s39 offen sc1
  v_dot2_f32_bf16 v192, v176, v198, v192
  v_dot2_f32_bf16 v193, v180, v198, v193
  v_dot2_f32_bf16 v194, v184, v198, v194
  v_dot2_f32_bf16 v195, v188, v198, v195
  v_dot2_f32_bf16 v192, v177, v198, v192
  v_dot2_f32_bf16 v193, v181, v198, v193
  v_dot2_f32_bf16 v194, v185, v198, v194
  v_dot2_f32_bf16 v195, v189, v198, v195
  v_dot2_f32_bf16 v192, v178, v198, v192
  v_dot2_f32_bf16 v193, v182, v198, v193
  v_dot2_f32_bf16 v194, v186, v198, v194
  v_dot2_f32_bf16 v195, v190, v198, v195
  v_dot2_f32_bf16 v192, v179, v198, v192
  v_dot2_f32_bf16 v193, v183, v198, v193
  v_dot2_f32_bf16 v194, v187, v198, v194
  v_dot2_f32_bf16 v195, v191, v198, v195
  v_lshlrev_b32 v9, 2, v0
  s_lshl_b32 s39, s30, 10
  s_add_u32 s39, s39, 137216
  v_add_u32 v9, s39, v9
  ds_write_b32 v9, v192 offset:0
  ds_write_b32 v9, v193 offset:256
  ds_write_b32 v9, v194 offset:512
  ds_write_b32 v9, v195 offset:768
  s_waitcnt lgkmcnt(0)
  s_barrier
  v_bfe_u32 v9, v199, 5, 2
  v_lshlrev_b32 v9, 8, v9
  v_and_b32 v197, 31, v199
  v_lshl_add_u32 v9, v197, 2, v9
  v_add_u32 v9, 137216, v9
  ds_read_b32 v200, v9 offset:0
  ds_read_b32 v201, v9 offset:128
  ds_read_b32 v202, v9 offset:1024
  ds_read_b32 v203, v9 offset:1152
  ds_read_b32 v204, v9 offset:2048
  ds_read_b32 v205, v9 offset:2176
  ds_read_b32 v206, v9 offset:3072
  ds_read_b32 v207, v9 offset:3200
  s_cmp_lt_u32 s30, 2
  s_cselect_b32 s39, s90, 0x7f000000
  v_lshlrev_b32 v9, 2, v199
  s_waitcnt lgkmcnt(0)
  v_add_f32 v200, v200, v201
  v_add_f32 v200, v200, v202
  v_add_f32 v200, v200, v203
  v_add_f32 v200, v200, v204
  v_add_f32 v200, v200, v205
  v_add_f32 v200, v200, v206
  v_add_f32 v200, v200, v207
  buffer_store_dword v200, v9, s[24:27], s39 offen sc1
  s_barrier
g1_cv_done:
  s_add_u32 m0, s35, 24576
  s_nop 0
  buffer_load_dwordx4 v2, s[16:19], s34 offen offset:0 lds
  buffer_load_dwordx4 v2, s[16:19], s34 offen offset:1024 lds
  buffer_load_dwordx4 v2, s[16:19], s34 offen offset:2048 lds
  buffer_load_dwordx4 v2, s[16:19], s34 offen offset:3072 lds
  s_add_u32 m0, s35, 28672
  s_nop 0
  buffer_load_dwordx4 v3, s[16:19], s34 offen offset:0 lds
  buffer_load_dwordx4 v3, s[16:19], s34 offen offset:1024 lds
  s_add_u32 s34, s34, 24576
  s_add_u32 m0, s36, 0
  s_nop 0
  buffer_load_dwordx4 v2, s[16:19], s34 offen offset:0 lds
  buffer_load_dwordx4 v2, s[16:19], s34 offen offset:1024 lds
  buffer_load_dwordx4 v2, s[16:19], s34 offen offset:2048 lds
  buffer_load_dwordx4 v2, s[16:19], s34 offen offset:3072 lds
  s_add_u32 m0, s36, 4096
  s_nop 0
  buffer_load_dwordx4 v3, s[16:19], s34 offen offset:0 lds
  buffer_load_dwordx4 v3, s[16:19], s34 offen offset:1024 lds
  s_add_u32 s34, s34, 24576
  v_mov_b32 v32, 0
  v_mov_b32 v33, 0
  v_mov_b32 v34, 0
  v_mov_b32 v35, 0
  v_mov_b32 v36, 0
  v_mov_b32 v37, 0
  v_mov_b32 v38, 0
  v_mov_b32 v39, 0
  v_mov_b32 v40, 0
  v_mov_b32 v41, 0
  v_mov_b32 v42, 0
  v_mov_b32 v43, 0
  v_mov_b32 v44, 0
  v_mov_b32 v45, 0
  v_mov_b32 v46, 0
  v_mov_b32 v47, 0
  v_mov_b32 v48, 0
  v_mov_b32 v49, 0
  v_mov_b32 v50, 0
  v_mov_b32 v51, 0
  v_mov_b32 v52, 0
  v_mov_b32 v53, 0
  v_mov_b32 v54, 0
  v_mov_b32 v55, 0
  v_mov_b32 v56, 0
  v_mov_b32 v57, 0
  v_mov_b32 v58, 0
  v_mov_b32 v59, 0
  v_mov_b32 v60, 0
  v_mov_b32 v61, 0
  v_mov_b32 v62, 0
  v_mov_b32 v63, 0
  v_mov_b32 v64, 0
  v_mov_b32 v65, 0
  v_mov_b32 v66, 0
  v_mov_b32 v67, 0
  v_mov_b32 v68, 0
  v_mov_b32 v69, 0
  v_mov_b32 v70, 0
  v_mov_b32 v71, 0
  v_mov_b32 v72, 0
  v_mov_b32 v73, 0
  v_mov_b32 v74, 0
  v_mov_b32 v75, 0
  v_mov_b32 v76, 0
  v_mov_b32 v77, 0
  v_mov_b32 v78, 0
  v_mov_b32 v79, 0
  v_mov_b32 v80, 0
  v_mov_b32 v81, 0
  v_mov_b32 v82, 0
  v_mov_b32 v83, 0
  v_mov_b32 v84, 0
  v_mov_b32 v85, 0
  v_mov_b32 v86, 0
  v_mov_b32 v87, 0
  v_mov_b32 v88, 0
  v_mov_b32 v89, 0
  v_mov_b32 v90, 0
  v_mov_b32 v91, 0
  v_mov_b32 v92, 0
  v_mov_b32 v93, 0
  v_mov_b32 v94, 0
  v_mov_b32 v95, 0
  v_mov_b32 v96, 0
  v_mov_b32 v97, 0
  v_mov_b32 v98, 0
  v_mov_b32 v99, 0
  v_mov_b32 v100, 0
  v_mov_b32 v101, 0
  v_mov_b32 v102, 0
  v_mov_b32 v103, 0
  v_mov_b32 v104, 0
  v_mov_b32 v105, 0
  v_mov_b32 v106, 0
  v_mov_b32 v107, 0
  v_mov_b32 v108, 0
  v_mov_b32 v109, 0
  v_mov_b32 v110, 0
  v_mov_b32 v111, 0
  v_mov_b32 v112, 0
  v_mov_b32 v113, 0
  v_mov_b32 v114, 0
  v_mov_b32 v115, 0
  v_mov_b32 v116, 0
  v_mov_b32 v117, 0
  v_mov_b32 v118, 0
  v_mov_b32 v119, 0
  v_mov_b32 v120, 0
  v_mov_b32 v121, 0
  v_mov_b32 v122, 0
  v_mov_b32 v123, 0
  v_mov_b32 v124, 0
  v_mov_b32 v125, 0
  v_mov_b32 v126, 0
  v_mov_b32 v127, 0
  s_waitcnt vmcnt(28)
  s_barrier
  v_add_f32 v26, v26, v220
  v_add_f32 v27, v27, v221
  v_add_f32 v28, v28, v222
  v_add_f32 v29, v29, v223
  v_add_f32 v26, v26, v27
  v_add_f32 v28, v28, v29
  v_add_f32 v26, v26, v28
  v_lshlrev_b32 v27, 2, v0
  s_lshl_b32 s39, s30, 8
  v_add_u32 v27, s39, v27
  ds_write_b32 v27, v26 offset:0
g1_w_done:
  buffer_load_dword v16, v24, s[24:27], s46 offen offset:0
  buffer_load_dword v20, v24, s[24:27], s47 offen offset:0
  buffer_load_dword v17, v24, s[24:27], s46 offen offset:64
  buffer_load_dword v21, v24, s[24:27], s47 offen offset:64
  buffer_load_dword v18, v24, s[24:27], s46 offen offset:128
  buffer_load_dword v22, v24, s[24:27], s47 offen offset:128
  buffer_load_dword v19, v24, s[24:27], s46 offen offset:192
  buffer_load_dword v23, v24, s[24:27], s47 offen offset:192
  s_lshl_b32 s39, s30, 9
  v_add_u32 v25, s39, v24
  v_add_u32 v30, s39, v14
  ds_read_b128 a[192:195], v10 offset:1024
  ds_read_b128 a[196:199], v10 offset:7168
  ds_read_b128 a[200:203], v10 offset:1280
  ds_read_b128 a[204:207], v10 offset:7424
  ds_read_b128 a[208:211], v10 offset:2048
  ds_read_b128 a[212:215], v10 offset:8192
  .p2align 3
g1_loop:
  s_waitcnt vmcnt(10) lgkmcnt(4)
  v_mfma_f32_16x16x32_bf16 v[64:67], a[0:3], a[192:195], v[64:67]
  ds_read_b128 a[216:219], v10 offset:2304
  v_mfma_f32_16x16x32_bf16 v[64:67], a[16:19], a[196:199], v[64:67]
  ds_read_b128 a[220:223], v10 offset:8448
  v_mfma_f32_16x16x32_bf16 v[68:71], a[20:23], a[196:199], v[68:71]
  s_add_u32 s33, s33, 0x1000
  buffer_load_dwordx4 a[64:67], v12, s[8:11], s33 offen offset:0
  v_mfma_f32_16x16x32_bf16 v[68:71], a[4:7], a[192:195], v[68:71]
  v_mfma_f32_16x16x32_bf16 v[72:75], a[8:11], a[192:195], v[72:75]
  buffer_load_dwordx4 a[68:71], v12, s[8:11], s33 offen offset:256
  v_mfma_f32_16x16x32_bf16 v[72:75], a[24:27], a[196:199], v[72:75]
  v_mfma_f32_16x16x32_bf16 v[76:79], a[28:31], a[196:199], v[76:79]
  s_add_u32 m0, s36, 24576
  s_nop 0
  buffer_load_dwordx4 v2, s[16:19], s34 offen offset:0 lds
  v_mfma_f32_16x16x32_bf16 v[76:79], a[12:15], a[192:195], v[76:79]
  s_waitcnt lgkmcnt(4)
  v_mfma_f32_16x16x32_bf16 v[80:83], a[0:3], a[200:203], v[80:83]
  ds_read_b128 a[192:195], v10 offset:0
  v_mfma_f32_16x16x32_bf16 v[80:83], a[16:19], a[204:207], v[80:83]
  ds_read_b128 a[196:199], v10 offset:6144
  v_mfma_f32_16x16x32_bf16 v[84:87], a[20:23], a[204:207], v[84:87]
  buffer_load_dwordx4 a[72:75], v12, s[12:15], s33 offen offset:0
  v_mfma_f32_16x16x32_bf16 v[84:87], a[4:7], a[200:203], v[84:87]
  v_mfma_f32_16x16x32_bf16 v[88:91], a[8:11], a[200:203], v[88:91]
  v_mfma_f32_16x16x32_bf16 v[88:91], a[24:27], a[204:207], v[88:91]
  buffer_load_dwordx4 v2, s[16:19], s34 offen offset:1024 lds
  v_mfma_f32_16x16x32_bf16 v[92:95], a[28:31], a[204:207], v[92:95]
  v_mfma_f32_16x16x32_bf16 v[92:95], a[12:15], a[200:203], v[92:95]
  s_waitcnt lgkmcnt(4)
  v_mfma_f32_16x16x32_bf16 v[96:99], a[0:3], a[208:211], v[96:99]
  ds_read_b128 a[200:203], v10 offset:256
  v_mfma_f32_16x16x32_bf16 v[96:99], a[16:19], a[212:215], v[96:99]
  ds_read_b128 a[204:207], v10 offset:6400
  v_mfma_f32_16x16x32_bf16 v[100:103], a[20:23], a[212:215], v[100:103]
  buffer_load_dwordx4 a[76:79], v12, s[12:15], s33 offen offset:256
  v_mfma_f32_16x16x32_bf16 v[100:103], a[4:7], a[208:211], v[100:103]
  v_mfma_f32_16x16x32_bf16 v[104:107], a[8:11], a[208:211], v[104:107]
  v_mfma_f32_16x16x32_bf16 v[104:107], a[24:27], a[212:215], v[104:107]
  v_mfma_f32_16x16x32_bf16 v[108:111], a[28:31], a[212:215], v[108:111]
  v_mfma_f32_16x16x32_bf16 v[108:111], a[12:15], a[208:211], v[108:111]
  s_waitcnt lgkmcnt(4)
  v_mfma_f32_16x16x32_bf16 v[112:115], a[0:3], a[216:219], v[112:115]
  ds_read_b128 a[208:211], v10 offset:13312
  v_mfma_f32_16x16x32_bf16 v[112:115], a[16:19], a[220:223], v[112:115]
  ds_read_b128 a[212:215], v10 offset:19456
  v_mfma_f32_16x16x32_bf16 v[116:119], a[20:23], a[220:223], v[116:119]
  buffer_load_dwordx4 a[80:83], v12, s[8:11], s33 offen offset:2048
  v_mfma_f32_16x16x32_bf16 v[116:119], a[4:7], a[216:219], v[116:119]
  v_mfma_f32_16x16x32_bf16 v[120:123], a[8:11], a[216:219], v[120:123]
  buffer_load_dwordx4 a[84:87], v12, s[8:11], s33 offen offset:2304
  v_mfma_f32_16x16x32_bf16 v[120:123], a[24:27], a[220:223], v[120:123]
  v_mfma_f32_16x16x32_bf16 v[124:127], a[28:31], a[220:223], v[124:127]
  buffer_load_dwordx4 v2, s[16:19], s34 offen offset:2048 lds
  v_mfma_f32_16x16x32_bf16 v[124:127], a[12:15], a[216:219], v[124:127]
  s_waitcnt lgkmcnt(4)
  v_mfma_f32_16x16x32_bf16 v[32:35], a[192:195], a[0:3], v[32:35]
  ds_read_b128 a[216:219], v10 offset:13568
  v_mfma_f32_16x16x32_bf16 v[32:35], a[196:199], a[16:19], v[32:35]
  ds_read_b128 a[220:223], v10 offset:19712
  v_mfma_f32_16x16x32_bf16 v[36:39], a[196:199], a[20:23], v[36:39]
  buffer_load_dwordx4 a[88:91], v12, s[12:15], s33 offen offset:2048
  v_mfma_f32_16x16x32_bf16 v[36:39], a[192:195], a[4:7], v[36:39]
  v_mfma_f32_16x16x32_bf16 v[40:43], a[192:195], a[8:11], v[40:43]
  v_mfma_f32_16x16x32_bf16 v[40:43], a[196:199], a[24:27], v[40:43]
  buffer_load_dwordx4 v2, s[16:19], s34 offen offset:3072 lds
  v_mfma_f32_16x16x32_bf16 v[44:47], a[196:199], a[28:31], v[44:47]
  v_mfma_f32_16x16x32_bf16 v[44:47], a[192:195], a[12:15], v[44:47]
  s_waitcnt lgkmcnt(4)
  v_mfma_f32_16x16x32_bf16 v[48:51], a[200:203], a[0:3], v[48:51]
  ds_read_b128 a[192:195], v10 offset:14336
  v_mfma_f32_16x16x32_bf16 v[48:51], a[204:207], a[16:19], v[48:51]
  ds_read_b128 a[196:199], v10 offset:20480
  v_mfma_f32_16x16x32_bf16 v[52:55], a[204:207], a[20:23], v[52:55]
  buffer_load_dwordx4 a[92:95], v12, s[12:15], s33 offen offset:2304
  v_mfma_f32_16x16x32_bf16 v[52:55], a[200:203], a[4:7], v[52:55]
  v_mfma_f32_16x16x32_bf16 v[56:59], a[200:203], a[8:11], v[56:59]
  v_mfma_f32_16x16x32_bf16 v[56:59], a[204:207], a[24:27], v[56:59]
  v_mfma_f32_16x16x32_bf16 v[60:63], a[204:207], a[28:31], v[60:63]
  v_mfma_f32_16x16x32_bf16 v[60:63], a[200:203], a[12:15], v[60:63]
  s_waitcnt vmcnt(12) lgkmcnt(4)
  v_mfma_f32_16x16x32_bf16 v[64:67], a[32:35], a[208:211], v[64:67]
  ds_read_b128 a[200:203], v10 offset:14592
  v_mfma_f32_16x16x32_bf16 v[64:67], a[48:51], a[212:215], v[64:67]
  ds_read_b128 a[204:207], v10 offset:20736
  v_mfma_f32_16x16x32_bf16 v[68:71], a[52:55], a[212:215], v[68:71]
  s_add_u32 s33, s33, 0x1000
  buffer_load_dwordx4 a[96:99], v12, s[8:11], s33 offen offset:0
  v_mfma_f32_16x16x32_bf16 v[68:71], a[36:39], a[208:211], v[68:71]
  v_mfma_f32_16x16x32_bf16 v[72:75], a[40:43], a[208:211], v[72:75]
  buffer_load_dwordx4 a[100:103], v12, s[8:11], s33 offen offset:256
  v_mfma_f32_16x16x32_bf16 v[72:75], a[56:59], a[212:215], v[72:75]
  v_mfma_f32_16x16x32_bf16 v[76:79], a[60:63], a[212:215], v[76:79]
  s_add_u32 m0, s36, 28672
  s_nop 0
  buffer_load_dwordx4 v3, s[16:19], s34 offen offset:0 lds
  v_mfma_f32_16x16x32_bf16 v[76:79], a[44:47], a[208:211], v[76:79]
  s_waitcnt lgkmcnt(4)
  v_mfma_f32_16x16x32_bf16 v[80:83], a[32:35], a[216:219], v[80:83]
  ds_read_b128 a[208:211], v10 offset:12288
  v_mfma_f32_16x16x32_bf16 v[80:83], a[48:51], a[220:223], v[80:83]
  ds_read_b128 a[212:215], v10 offset:18432
  v_mfma_f32_16x16x32_bf16 v[84:87], a[52:55], a[220:223], v[84:87]
  buffer_load_dwordx4 a[104:107], v12, s[12:15], s33 offen offset:0
  v_mfma_f32_16x16x32_bf16 v[84:87], a[36:39], a[216:219], v[84:87]
  v_mfma_f32_16x16x32_bf16 v[88:91], a[40:43], a[216:219], v[88:91]
  v_mfma_f32_16x16x32_bf16 v[88:91], a[56:59], a[220:223], v[88:91]
  buffer_load_dwordx4 v3, s[16:19], s34 offen offset:1024 lds
  s_add_u32 s34, s34, 24576
  v_mfma_f32_16x16x32_bf16 v[92:95], a[60:63], a[220:223], v[92:95]
  v_mfma_f32_16x16x32_bf16 v[92:95], a[44:47], a[216:219], v[92:95]
  s_waitcnt lgkmcnt(4)
  v_mfma_f32_16x16x32_bf16 v[96:99], a[32:35], a[192:195], v[96:99]
  ds_read_b128 a[216:219], v10 offset:12544
  v_mfma_f32_16x16x32_bf16 v[96:99], a[48:51], a[196:199], v[96:99]
  ds_read_b128 a[220:223], v10 offset:18688
  v_mfma_f32_16x16x32_bf16 v[100:103], a[52:55], a[196:199], v[100:103]
  buffer_load_dwordx4 a[108:111], v12, s[12:15], s33 offen offset:256
  v_mfma_f32_16x16x32_bf16 v[100:103], a[36:39], a[192:195], v[100:103]
  v_mfma_f32_16x16x32_bf16 v[104:107], a[40:43], a[192:195], v[104:107]
  v_mfma_f32_16x16x32_bf16 v[104:107], a[56:59], a[196:199], v[104:107]
  v_mfma_f32_16x16x32_bf16 v[108:111], a[60:63], a[196:199], v[108:111]
  v_mfma_f32_16x16x32_bf16 v[108:111], a[44:47], a[192:195], v[108:111]
  s_waitcnt vmcnt(32) lgkmcnt(0)
  s_barrier
  v_mfma_f32_16x16x32_bf16 v[112:115], a[32:35], a[200:203], v[112:115]
  ds_read_b128 a[192:195], v10 offset:25600
  v_mfma_f32_16x16x32_bf16 v[112:115], a[48:51], a[204:207], v[112:115]
  ds_read_b128 a[196:199], v10 offset:31744
  v_mfma_f32_16x16x32_bf16 v[116:119], a[52:55], a[204:207], v[116:119]
  buffer_load_dwordx4 a[112:115], v12, s[8:11], s33 offen offset:2048
  v_mfma_f32_16x16x32_bf16 v[116:119], a[36:39], a[200:203], v[116:119]
  v_mfma_f32_16x16x32_bf16 v[120:123], a[40:43], a[200:203], v[120:123]
  v_mfma_f32_16x16x32_bf16 v[120:123], a[56:59], a[204:207], v[120:123]
  buffer_load_dwordx4 a[116:119], v12, s[8:11], s33 offen offset:2304
  v_mfma_f32_16x16x32_bf16 v[124:127], a[60:63], a[204:207], v[124:127]
  v_mfma_f32_16x16x32_bf16 v[124:127], a[44:47], a[200:203], v[124:127]
  s_waitcnt lgkmcnt(4)
  v_mfma_f32_16x16x32_bf16 v[32:35], a[208:211], a[32:35], v[32:35]
  ds_read_b128 a[200:203], v10 offset:25856
  v_mfma_f32_16x16x32_bf16 v[32:35], a[212:215], a[48:51], v[32:35]
  ds_read_b128 a[204:207], v10 offset:32000
  v_mfma_f32_16x16x32_bf16 v[36:39], a[212:215], a[52:55], v[36:39]
  buffer_load_dwordx4 a[120:123], v12, s[12:15], s33 offen offset:2048
  v_mfma_f32_16x16x32_bf16 v[36:39], a[208:211], a[36:39], v[36:39]
  v_mfma_f32_16x16x32_bf16 v[40:43], a[208:211], a[40:43], v[40:43]
  v_mfma_f32_16x16x32_bf16 v[40:43], a[212:215], a[56:59], v[40:43]
  v_mfma_f32_16x16x32_bf16 v[44:47], a[212:215], a[60:63], v[44:47]
  v_mfma_f32_16x16x32_bf16 v[44:47], a[208:211], a[44:47], v[44:47]
  s_waitcnt lgkmcnt(4)
  v_mfma_f32_16x16x32_bf16 v[48:51], a[216:219], a[32:35], v[48:51]
  ds_read_b128 a[208:211], v10 offset:26624
  v_mfma_f32_16x16x32_bf16 v[48:51], a[220:223], a[48:51], v[48:51]
  ds_read_b128 a[212:215], v10 offset:32768
  v_mfma_f32_16x16x32_bf16 v[52:55], a[220:223], a[52:55], v[52:55]
  buffer_load_dwordx4 a[124:127], v12, s[12:15], s33 offen offset:2304
  v_mfma_f32_16x16x32_bf16 v[52:55], a[216:219], a[36:39], v[52:55]
  v_mfma_f32_16x16x32_bf16 v[56:59], a[216:219], a[40:43], v[56:59]
  v_mfma_f32_16x16x32_bf16 v[56:59], a[220:223], a[56:59], v[56:59]
  v_mfma_f32_16x16x32_bf16 v[60:63], a[220:223], a[60:63], v[60:63]
  v_mfma_f32_16x16x32_bf16 v[60:63], a[216:219], a[44:47], v[60:63]
  s_sub_u32 s38, s38, 1
  s_cmp_eq_u32 s38, 0
  s_cbranch_scc1 g1_tail
  s_waitcnt vmcnt(10) lgkmcnt(4)
  v_mfma_f32_16x16x32_bf16 v[64:67], a[64:67], a[192:195], v[64:67]
  ds_read_b128 a[216:219], v10 offset:26880
  v_mfma_f32_16x16x32_bf16 v[64:67], a[80:83], a[196:199], v[64:67]
  ds_read_b128 a[220:223], v10 offset:33024
  v_mfma_f32_16x16x32_bf16 v[68:71], a[84:87], a[196:199], v[68:71]
  s_add_u32 s33, s33, 0x1000
  buffer_load_dwordx4 a[0:3], v12, s[8:11], s33 offen offset:0
  v_mfma_f32_16x16x32_bf16 v[68:71], a[68:71], a[192:195], v[68:71]
  v_mfma_f32_16x16x32_bf16 v[72:75], a[72:75], a[192:195], v[72:75]
  buffer_load_dwordx4 a[4:7], v12, s[8:11], s33 offen offset:256
  v_mfma_f32_16x16x32_bf16 v[72:75], a[88:91], a[196:199], v[72:75]
  v_mfma_f32_16x16x32_bf16 v[76:79], a[92:95], a[196:199], v[76:79]
  s_add_u32 m0, s35, 0
  s_nop 0
  buffer_load_dwordx4 v2, s[16:19], s34 offen offset:0 lds
  v_mfma_f32_16x16x32_bf16 v[76:79], a[76:79], a[192:195], v[76:79]
  s_waitcnt lgkmcnt(4)
  v_mfma_f32_16x16x32_bf16 v[80:83], a[64:67], a[200:203], v[80:83]
  ds_read_b128 a[192:195], v10 offset:24576
  v_mfma_f32_16x16x32_bf16 v[80:83], a[80:83], a[204:207], v[80:83]
  ds_read_b128 a[196:199], v10 offset:30720
  v_mfma_f32_16x16x32_bf16 v[84:87], a[84:87], a[204:207], v[84:87]
  buffer_load_dwordx4 a[8:11], v12, s[12:15], s33 offen offset:0
  v_mfma_f32_16x16x32_bf16 v[84:87], a[68:71], a[200:203], v[84:87]
  v_mfma_f32_16x16x32_bf16 v[88:91], a[72:75], a[200:203], v[88:91]
  v_mfma_f32_16x16x32_bf16 v[88:91], a[88:91], a[204:207], v[88:91]
  buffer_load_dwordx4 v2, s[16:19], s34 offen offset:1024 lds
  v_mfma_f32_16x16x32_bf16 v[92:95], a[92:95], a[204:207], v[92:95]
  v_mfma_f32_16x16x32_bf16 v[92:95], a[76:79], a[200:203], v[92:95]
  s_waitcnt lgkmcnt(4)
  v_mfma_f32_16x16x32_bf16 v[96:99], a[64:67], a[208:211], v[96:99]
  ds_read_b128 a[200:203], v10 offset:24832
  v_mfma_f32_16x16x32_bf16 v[96:99], a[80:83], a[212:215], v[96:99]
  ds_read_b128 a[204:207], v10 offset:30976
  v_mfma_f32_16x16x32_bf16 v[100:103], a[84:87], a[212:215], v[100:103]
  buffer_load_dwordx4 a[12:15], v12, s[12:15], s33 offen offset:256
  v_mfma_f32_16x16x32_bf16 v[100:103], a[68:71], a[208:211], v[100:103]
  v_mfma_f32_16x16x32_bf16 v[104:107], a[72:75], a[208:211], v[104:107]
  v_mfma_f32_16x16x32_bf16 v[104:107], a[88:91], a[212:215], v[104:107]
  v_mfma_f32_16x16x32_bf16 v[108:111], a[92:95], a[212:215], v[108:111]
  v_mfma_f32_16x16x32_bf16 v[108:111], a[76:79], a[208:211], v[108:111]
  s_waitcnt lgkmcnt(4)
  v_mfma_f32_16x16x32_bf16 v[112:115], a[64:67], a[216:219], v[112:115]
  ds_read_b128 a[208:211], v10 offset:37888
  v_mfma_f32_16x16x32_bf16 v[112:115], a[80:83], a[220:223], v[112:115]
  ds_read_b128 a[212:215], v10 offset:44032
  v_mfma_f32_16x16x32_bf16 v[116:119], a[84:87], a[220:223], v[116:119]
  buffer_load_dwordx4 a[16:19], v12, s[8:11], s33 offen offset:2048
  v_mfma_f32_16x16x32_bf16 v[116:119], a[68:71], a[216:219], v[116:119]
  v_mfma_f32_16x16x32_bf16 v[120:123], a[72:75], a[216:219], v[120:123]
  buffer_load_dwordx4 a[20:23], v12, s[8:11], s33 offen offset:2304
  v_mfma_f32_16x16x32_bf16 v[120:123], a[88:91], a[220:223], v[120:123]
  v_mfma_f32_16x16x32_bf16 v[124:127], a[92:95], a[220:223], v[124:127]
  buffer_load_dwordx4 v2, s[16:19], s34 offen offset:2048 lds
  v_mfma_f32_16x16x32_bf16 v[124:127], a[76:79], a[216:219], v[124:127]
  s_waitcnt lgkmcnt(4)
  v_mfma_f32_16x16x32_bf16 v[32:35], a[192:195], a[64:67], v[32:35]
  ds_read_b128 a[216:219], v10 offset:38144
  v_mfma_f32_16x16x32_bf16 v[32:35], a[196:199], a[80:83], v[32:35]
  ds_read_b128 a[220:223], v10 offset:44288
  v_mfma_f32_16x16x32_bf16 v[36:39], a[196:199], a[84:87], v[36:39]
  buffer_load_dwordx4 a[24:27], v12, s[12:15], s33 offen offset:2048
  v_mfma_f32_16x16x32_bf16 v[36:39], a[192:195], a[68:71], v[36:39]
  v_mfma_f32_16x16x32_bf16 v[40:43], a[192:195], a[72:75], v[40:43]
  v_mfma_f32_16x16x32_bf16 v[40:43], a[196:199], a[88:91], v[40:43]
  buffer_load_dwordx4 v2, s[16:19], s34 offen offset:3072 lds
  v_mfma_f32_16x16x32_bf16 v[44:47], a[196:199], a[92:95], v[44:47]
  v_mfma_f32_16x16x32_bf16 v[44:47], a[192:195], a[76:79], v[44:47]
  s_waitcnt lgkmcnt(4)
  v_mfma_f32_16x16x32_bf16 v[48:51], a[200:203], a[64:67], v[48:51]
  ds_read_b128 a[192:195], v10 offset:38912
  v_mfma_f32_16x16x32_bf16 v[48:51], a[204:207], a[80:83], v[48:51]
  ds_read_b128 a[196:199], v10 offset:45056
  v_mfma_f32_16x16x32_bf16 v[52:55], a[204:207], a[84:87], v[52:55]
  buffer_load_dwordx4 a[28:31], v12, s[12:15], s33 offen offset:2304
  v_mfma_f32_16x16x32_bf16 v[52:55], a[200:203], a[68:71], v[52:55]
  v_mfma_f32_16x16x32_bf16 v[56:59], a[200:203], a[72:75], v[56:59]
  v_mfma_f32_16x16x32_bf16 v[56:59], a[204:207], a[88:91], v[56:59]
  v_mfma_f32_16x16x32_bf16 v[60:63], a[204:207], a[92:95], v[60:63]
  v_mfma_f32_16x16x32_bf16 v[60:63], a[200:203], a[76:79], v[60:63]
  s_waitcnt vmcnt(12) lgkmcnt(4)
  v_mfma_f32_16x16x32_bf16 v[64:67], a[96:99], a[208:211], v[64:67]
  ds_read_b128 a[200:203], v10 offset:39168
  v_mfma_f32_16x16x32_bf16 v[64:67], a[112:115], a[212:215], v[64:67]
  ds_read_b128 a[204:207], v10 offset:45312
  v_mfma_f32_16x16x32_bf16 v[68:71], a[116:119], a[212:215], v[68:71]
  s_add_u32 s33, s33, 0x1000
  buffer_load_dwordx4 a[32:35], v12, s[8:11], s33 offen offset:0
  v_mfma_f32_16x16x32_bf16 v[68:71], a[100:103], a[208:211], v[68:71]
  v_mfma_f32_16x16x32_bf16 v[72:75], a[104:107], a[208:211], v[72:75]
  buffer_load_dwordx4 a[36:39], v12, s[8:11], s33 offen offset:256
  v_mfma_f32_16x16x32_bf16 v[72:75], a[120:123], a[212:215], v[72:75]
  v_mfma_f32_16x16x32_bf16 v[76:79], a[124:127], a[212:215], v[76:79]
  s_add_u32 m0, s35, 4096
  s_nop 0
  buffer_load_dwordx4 v3, s[16:19], s34 offen offset:0 lds
  v_mfma_f32_16x16x32_bf16 v[76:79], a[108:111], a[208:211], v[76:79]
  s_waitcnt lgkmcnt(4)
  v_mfma_f32_16x16x32_bf16 v[80:83], a[96:99], a[216:219], v[80:83]
  ds_read_b128 a[208:211], v10 offset:36864
  v_mfma_f32_16x16x32_bf16 v[80:83], a[112:115], a[220:223], v[80:83]
  ds_read_b128 a[212:215], v10 offset:43008
  v_mfma_f32_16x16x32_bf16 v[84:87], a[116:119], a[220:223], v[84:87]
  buffer_load_dwordx4 a[40:43], v12, s[12:15], s33 offen offset:0
  v_mfma_f32_16x16x32_bf16 v[84:87], a[100:103], a[216:219], v[84:87]
  v_mfma_f32_16x16x32_bf16 v[88:91], a[104:107], a[216:219], v[88:91]
  v_mfma_f32_16x16x32_bf16 v[88:91], a[120:123], a[220:223], v[88:91]
  buffer_load_dwordx4 v3, s[16:19], s34 offen offset:1024 lds
  s_add_u32 s34, s34, 24576
  v_mfma_f32_16x16x32_bf16 v[92:95], a[124:127], a[220:223], v[92:95]
  v_mfma_f32_16x16x32_bf16 v[92:95], a[108:111], a[216:219], v[92:95]
  s_waitcnt lgkmcnt(4)
  v_mfma_f32_16x16x32_bf16 v[96:99], a[96:99], a[192:195], v[96:99]
  ds_read_b128 a[216:219], v10 offset:37120
  v_mfma_f32_16x16x32_bf16 v[96:99], a[112:115], a[196:199], v[96:99]
  ds_read_b128 a[220:223], v10 offset:43264
  v_mfma_f32_16x16x32_bf16 v[100:103], a[116:119], a[196:199], v[100:103]
  buffer_load_dwordx4 a[44:47], v12, s[12:15], s33 offen offset:256
  v_mfma_f32_16x16x32_bf16 v[100:103], a[100:103], a[192:195], v[100:103]
  v_mfma_f32_16x16x32_bf16 v[104:107], a[104:107], a[192:195], v[104:107]
  v_mfma_f32_16x16x32_bf16 v[104:107], a[120:123], a[196:199], v[104:107]
  v_mfma_f32_16x16x32_bf16 v[108:111], a[124:127], a[196:199], v[108:111]
  v_mfma_f32_16x16x32_bf16 v[108:111], a[108:111], a[192:195], v[108:111]
  s_waitcnt vmcnt(45) lgkmcnt(0)
  s_barrier
  v_mfma_f32_16x16x32_bf16 v[112:115], a[96:99], a[200:203], v[112:115]
  ds_read_b128 a[192:195], v11 offset:1024
  v_mfma_f32_16x16x32_bf16 v[112:115], a[112:115], a[204:207], v[112:115]
  ds_read_b128 a[196:199], v11 offset:7168
  v_mfma_f32_16x16x32_bf16 v[116:119], a[116:119], a[204:207], v[116:119]
  buffer_load_dwordx4 a[48:51], v12, s[8:11], s33 offen offset:2048
  v_mfma_f32_16x16x32_bf16 v[116:119], a[100:103], a[200:203], v[116:119]
  v_mfma_f32_16x16x32_bf16 v[120:123], a[104:107], a[200:203], v[120:123]
  v_mfma_f32_16x16x32_bf16 v[120:123], a[120:123], a[204:207], v[120:123]
  buffer_load_dwordx4 a[52:55], v12, s[8:11], s33 offen offset:2304
  v_mfma_f32_16x16x32_bf16 v[124:127], a[124:127], a[204:207], v[124:127]
  v_mfma_f32_16x16x32_bf16 v[124:127], a[108:111], a[200:203], v[124:127]
  s_waitcnt lgkmcnt(4)
  v_mfma_f32_16x16x32_bf16 v[32:35], a[208:211], a[96:99], v[32:35]
  ds_read_b128 a[200:203], v11 offset:1280
  v_mfma_f32_16x16x32_bf16 v[32:35], a[212:215], a[112:115], v[32:35]
  ds_read_b128 a[204:207], v11 offset:7424
  v_mfma_f32_16x16x32_bf16 v[36:39], a[212:215], a[116:119], v[36:39]
  buffer_load_dwordx4 a[56:59], v12, s[12:15], s33 offen offset:2048
  v_mfma_f32_16x16x32_bf16 v[36:39], a[208:211], a[100:103], v[36:39]
  v_mfma_f32_16x16x32_bf16 v[40:43], a[208:211], a[104:107], v[40:43]
  v_mfma_f32_16x16x32_bf16 v[40:43], a[212:215], a[120:123], v[40:43]
  v_mfma_f32_16x16x32_bf16 v[44:47], a[212:215], a[124:127], v[44:47]
  v_mfma_f32_16x16x32_bf16 v[44:47], a[208:211], a[108:111], v[44:47]
  s_waitcnt lgkmcnt(4)
  v_mfma_f32_16x16x32_bf16 v[48:51], a[216:219], a[96:99], v[48:51]
  ds_read_b128 a[208:211], v11 offset:2048
  v_mfma_f32_16x16x32_bf16 v[48:51], a[220:223], a[112:115], v[48:51]
  ds_read_b128 a[212:215], v11 offset:8192
  v_mfma_f32_16x16x32_bf16 v[52:55], a[220:223], a[116:119], v[52:55]
  buffer_load_dwordx4 a[60:63], v12, s[12:15], s33 offen offset:2304
  v_mfma_f32_16x16x32_bf16 v[52:55], a[216:219], a[100:103], v[52:55]
  v_mfma_f32_16x16x32_bf16 v[56:59], a[216:219], a[104:107], v[56:59]
  v_mfma_f32_16x16x32_bf16 v[56:59], a[220:223], a[120:123], v[56:59]
  v_mfma_f32_16x16x32_bf16 v[60:63], a[220:223], a[124:127], v[60:63]
  v_mfma_f32_16x16x32_bf16 v[60:63], a[216:219], a[108:111], v[60:63]
  v_swap_b32 v10, v11
  s_mov_b32 s39, s35
  s_mov_b32 s35, s36
  s_mov_b32 s36, s39
  s_branch g1_loop
  .p2align 3
g1_tail:
  s_waitcnt vmcnt(10) lgkmcnt(4)
  v_mfma_f32_16x16x32_bf16 v[64:67], a[64:67], a[192:195], v[64:67]
  ds_read_b128 a[216:219], v10 offset:26880
  v_mul_f32 v16, 981467136, v16
  v_mul_f32 v20, 981467136, v20
  v_fma_f32 v20, -v16, v16, v20
  v_mfma_f32_16x16x32_bf16 v[64:67], a[80:83], a[196:199], v[64:67]
  ds_read_b128 a[220:223], v10 offset:33024
  v_max_f32 v20, 0, v20
  v_cvt_pk_bf16_f32 v4, v16, v20
  v_mfma_f32_16x16x32_bf16 v[68:71], a[84:87], a[196:199], v[68:71]
  s_add_u32 s33, s33, 0x1000
  buffer_load_dwordx4 a[128:131], v12, s[8:11], s33 offen offset:0
  v_lshlrev_b32 v16, 16, v4
  v_and_b32 v20, 0xffff0000, v4
  v_mfma_f32_16x16x32_bf16 v[68:71], a[68:71], a[192:195], v[68:71]
  v_add_f32 v20, 925353388, v20
  v_cvt_pk_bf16_f32 v4, v20, v20
  v_mfma_f32_16x16x32_bf16 v[72:75], a[72:75], a[192:195], v[72:75]
  v_lshlrev_b32 v20, 16, v4
  v_sqrt_f32 v20, v20
  v_mfma_f32_16x16x32_bf16 v[72:75], a[88:91], a[196:199], v[72:75]
  buffer_load_dwordx4 a[132:135], v12, s[8:11], s33 offen offset:256
  v_cvt_pk_bf16_f32 v4, v20, v20
  v_lshlrev_b32 v20, 16, v4
  v_mfma_f32_16x16x32_bf16 v[76:79], a[92:95], a[196:199], v[76:79]
  v_rcp_f32 v176, v20
  v_sub_f32 v16, 0, v16
  v_mfma_f32_16x16x32_bf16 v[76:79], a[76:79], a[192:195], v[76:79]
  ds_write_b32 v25, v16 offset:1024
  ds_write_b32 v25, v176 offset:1280
  s_waitcnt lgkmcnt(6)
  v_mfma_f32_16x16x32_bf16 v[80:83], a[64:67], a[200:203], v[80:83]
  ds_read_b128 a[192:195], v10 offset:37888
  v_mul_f32 v17, 981467136, v17
  v_mul_f32 v21, 981467136, v21
  v_fma_f32 v21, -v17, v17, v21
  v_mfma_f32_16x16x32_bf16 v[80:83], a[80:83], a[204:207], v[80:83]
  ds_read_b128 a[196:199], v10 offset:44032
  v_max_f32 v21, 0, v21
  v_cvt_pk_bf16_f32 v4, v17, v21
  v_mfma_f32_16x16x32_bf16 v[84:87], a[84:87], a[204:207], v[84:87]
  buffer_load_dwordx4 a[136:139], v12, s[12:15], s33 offen offset:0
  v_lshlrev_b32 v17, 16, v4
  v_and_b32 v21, 0xffff0000, v4
  v_mfma_f32_16x16x32_bf16 v[84:87], a[68:71], a[200:203], v[84:87]
  v_add_f32 v21, 925353388, v21
  v_cvt_pk_bf16_f32 v4, v21, v21
  v_mfma_f32_16x16x32_bf16 v[88:91], a[72:75], a[200:203], v[88:91]
  v_lshlrev_b32 v21, 16, v4
  v_sqrt_f32 v21, v21
  v_mfma_f32_16x16x32_bf16 v[88:91], a[88:91], a[204:207], v[88:91]
  buffer_load_dwordx4 a[140:143], v12, s[12:15], s33 offen offset:256
  v_cvt_pk_bf16_f32 v4, v21, v21
  v_lshlrev_b32 v21, 16, v4
  v_mfma_f32_16x16x32_bf16 v[92:95], a[92:95], a[204:207], v[92:95]
  v_rcp_f32 v178, v21
  v_sub_f32 v17, 0, v17
  v_mfma_f32_16x16x32_bf16 v[92:95], a[76:79], a[200:203], v[92:95]
  ds_write_b32 v25, v17 offset:1088
  ds_write_b32 v25, v178 offset:1344
  s_waitcnt lgkmcnt(8)
  v_mfma_f32_16x16x32_bf16 v[96:99], a[64:67], a[208:211], v[96:99]
  ds_read_b128 a[200:203], v10 offset:38144
  v_mul_f32 v18, 981467136, v18
  v_mul_f32 v22, 981467136, v22
  v_fma_f32 v22, -v18, v18, v22
  v_mfma_f32_16x16x32_bf16 v[96:99], a[80:83], a[212:215], v[96:99]
  ds_read_b128 a[204:207], v10 offset:44288
  v_max_f32 v22, 0, v22
  v_cvt_pk_bf16_f32 v4, v18, v22
  v_mfma_f32_16x16x32_bf16 v[100:103], a[84:87], a[212:215], v[100:103]
  buffer_load_dwordx4 a[144:147], v12, s[8:11], s33 offen offset:2048
  v_lshlrev_b32 v18, 16, v4
  v_and_b32 v22, 0xffff0000, v4
  v_mfma_f32_16x16x32_bf16 v[100:103], a[68:71], a[208:211], v[100:103]
  v_add_f32 v22, 925353388, v22
  v_cvt_pk_bf16_f32 v4, v22, v22
  v_mfma_f32_16x16x32_bf16 v[104:107], a[72:75], a[208:211], v[104:107]
  v_lshlrev_b32 v22, 16, v4
  v_sqrt_f32 v22, v22
  v_mfma_f32_16x16x32_bf16 v[104:107], a[88:91], a[212:215], v[104:107]
  buffer_load_dwordx4 a[148:151], v12, s[8:11], s33 offen offset:2304
  v_cvt_pk_bf16_f32 v4, v22, v22
  v_lshlrev_b32 v22, 16, v4
  v_mfma_f32_16x16x32_bf16 v[108:111], a[92:95], a[212:215], v[108:111]
  v_rcp_f32 v180, v22
  v_sub_f32 v18, 0, v18
  v_mfma_f32_16x16x32_bf16 v[108:111], a[76:79], a[208:211], v[108:111]
  ds_write_b32 v25, v18 offset:1152
  ds_write_b32 v25, v180 offset:1408
  s_waitcnt lgkmcnt(10)
  v_mfma_f32_16x16x32_bf16 v[112:115], a[64:67], a[216:219], v[112:115]
  ds_read_b128 a[208:211], v10 offset:38912
  v_mul_f32 v19, 981467136, v19
  v_mul_f32 v23, 981467136, v23
  v_fma_f32 v23, -v19, v19, v23
  v_mfma_f32_16x16x32_bf16 v[112:115], a[80:83], a[220:223], v[112:115]
  ds_read_b128 a[212:215], v10 offset:45056
  v_max_f32 v23, 0, v23
  v_cvt_pk_bf16_f32 v4, v19, v23
  v_mfma_f32_16x16x32_bf16 v[116:119], a[84:87], a[220:223], v[116:119]
  buffer_load_dwordx4 a[152:155], v12, s[12:15], s33 offen offset:2048
  v_lshlrev_b32 v19, 16, v4
  v_and_b32 v23, 0xffff0000, v4
  v_mfma_f32_16x16x32_bf16 v[116:119], a[68:71], a[216:219], v[116:119]
  v_add_f32 v23, 925353388, v23
  v_cvt_pk_bf16_f32 v4, v23, v23
  v_mfma_f32_16x16x32_bf16 v[120:123], a[72:75], a[216:219], v[120:123]
  v_lshlrev_b32 v23, 16, v4
  v_sqrt_f32 v23, v23
  v_mfma_f32_16x16x32_bf16 v[120:123], a[88:91], a[220:223], v[120:123]
  buffer_load_dwordx4 a[156:159], v12, s[12:15], s33 offen offset:2304
  v_cvt_pk_bf16_f32 v4, v23, v23
  v_lshlrev_b32 v23, 16, v4
  v_mfma_f32_16x16x32_bf16 v[124:127], a[92:95], a[220:223], v[124:127]
  v_rcp_f32 v182, v23
  v_sub_f32 v19, 0, v19
  v_mfma_f32_16x16x32_bf16 v[124:127], a[76:79], a[216:219], v[124:127]
  ds_write_b32 v25, v19 offset:1216
  ds_write_b32 v25, v182 offset:1472
  s_waitcnt vmcnt(8) lgkmcnt(10)
  v_mfma_f32_16x16x32_bf16 v[64:67], a[96:99], a[192:195], v[64:67]
  ds_read_b128 a[216:219], v10 offset:39168
  ds_read_b128 v[128:131], v30 offset:1024
  v_mfma_f32_16x16x32_bf16 v[64:67], a[112:115], a[196:199], v[64:67]
  ds_read_b128 a[220:223], v10 offset:45312
  ds_read_b128 v[132:135], v30 offset:1088
  v_mfma_f32_16x16x32_bf16 v[68:71], a[116:119], a[196:199], v[68:71]
  s_add_u32 s33, s33, 0x1000
  buffer_load_dwordx4 a[160:163], v12, s[8:11], s33 offen offset:0
  ds_read_b128 v[136:139], v30 offset:1152
  v_mfma_f32_16x16x32_bf16 v[68:71], a[100:103], a[192:195], v[68:71]
  ds_read_b128 v[140:143], v30 offset:1216
  v_mfma_f32_16x16x32_bf16 v[72:75], a[104:107], a[192:195], v[72:75]
  ds_read_b32 v160, v24 offset:128
  v_mfma_f32_16x16x32_bf16 v[72:75], a[120:123], a[196:199], v[72:75]
  buffer_load_dwordx4 a[164:167], v12, s[8:11], s33 offen offset:256
  ds_read_b32 v162, v24 offset:192
  v_mfma_f32_16x16x32_bf16 v[76:79], a[124:127], a[196:199], v[76:79]
  ds_read_b32 v164, v24 offset:256
  v_mfma_f32_16x16x32_bf16 v[76:79], a[108:111], a[192:195], v[76:79]
  ds_read_b32 v166, v24 offset:320
  s_waitcnt vmcnt(37) lgkmcnt(0)
  s_barrier
  v_mfma_f32_16x16x32_bf16 v[80:83], a[96:99], a[200:203], v[80:83]
  ds_read_b128 a[192:195], v11 offset:1024
  ds_read_b128 v[144:147], v30 offset:1280
  v_mfma_f32_16x16x32_bf16 v[80:83], a[112:115], a[204:207], v[80:83]
  ds_read_b128 a[196:199], v11 offset:7168
  ds_read_b128 v[148:151], v30 offset:1344
  v_mfma_f32_16x16x32_bf16 v[84:87], a[116:119], a[204:207], v[84:87]
  buffer_load_dwordx4 a[168:171], v12, s[12:15], s33 offen offset:0
  ds_read_b128 v[152:155], v30 offset:1408
  v_mfma_f32_16x16x32_bf16 v[84:87], a[100:103], a[200:203], v[84:87]
  v_mfma_f32_16x16x32_bf16 v[88:91], a[104:107], a[200:203], v[88:91]
  ds_read_b128 v[156:159], v30 offset:1472
  v_mfma_f32_16x16x32_bf16 v[88:91], a[120:123], a[204:207], v[88:91]
  buffer_load_dwordx4 a[172:175], v12, s[12:15], s33 offen offset:256
  ds_read_b128 v[168:171], v14 offset:0
  v_mfma_f32_16x16x32_bf16 v[92:95], a[124:127], a[204:207], v[92:95]
  ds_read_b128 v[172:175], v14 offset:64
  v_mfma_f32_16x16x32_bf16 v[92:95], a[108:111], a[200:203], v[92:95]
  v_mfma_f32_16x16x32_bf16 v[96:99], a[96:99], a[208:211], v[96:99]
  ds_read_b128 a[200:203], v11 offset:1280
  v_mov_b32 v216, 0x3f803f80
  v_mfma_f32_16x16x32_bf16 v[96:99], a[112:115], a[212:215], v[96:99]
  ds_read_b128 a[204:207], v11 offset:7424
  v_mfma_f32_16x16x32_bf16 v[100:103], a[116:119], a[212:215], v[100:103]
  buffer_load_dwordx4 a[176:179], v12, s[8:11], s33 offen offset:2048
  v_mov_b32 v217, 0x3f803f80
  v_mfma_f32_16x16x32_bf16 v[100:103], a[100:103], a[208:211], v[100:103]
  v_mfma_f32_16x16x32_bf16 v[104:107], a[104:107], a[208:211], v[104:107]
  v_mov_b32 v218, 0x3f803f80
  v_mfma_f32_16x16x32_bf16 v[104:107], a[120:123], a[212:215], v[104:107]
  buffer_load_dwordx4 a[180:183], v12, s[8:11], s33 offen offset:2304
  v_mfma_f32_16x16x32_bf16 v[108:111], a[124:127], a[212:215], v[108:111]
  v_mov_b32 v219, 0x3f803f80
  v_mfma_f32_16x16x32_bf16 v[108:111], a[108:111], a[208:211], v[108:111]
  v_mfma_f32_16x16x32_bf16 v[112:115], a[96:99], a[216:219], v[112:115]
  ds_read_b128 a[208:211], v11 offset:2048
  v_mfma_f32_16x16x32_bf16 v[112:115], a[112:115], a[220:223], v[112:115]
  ds_read_b128 a[212:215], v11 offset:8192
  v_mfma_f32_16x16x32_bf16 v[116:119], a[116:119], a[220:223], v[116:119]
  buffer_load_dwordx4 a[184:187], v12, s[12:15], s33 offen offset:2048
  v_mfma_f32_16x16x32_bf16 v[116:119], a[100:103], a[216:219], v[116:119]
  v_mfma_f32_16x16x32_bf16 v[120:123], a[104:107], a[216:219], v[120:123]
  v_mfma_f32_16x16x32_bf16 v[120:123], a[120:123], a[220:223], v[120:123]
  buffer_load_dwordx4 a[188:191], v12, s[12:15], s33 offen offset:2304
  v_mfma_f32_16x16x32_bf16 v[124:127], a[124:127], a[220:223], v[124:127]
  v_mfma_f32_16x16x32_bf16 v[124:127], a[108:111], a[216:219], v[124:127]
  s_waitcnt vmcnt(8) lgkmcnt(9)
  v_mfma_f32_16x16x32_bf16 v[64:67], a[128:131], a[192:195], v[64:67]
  ds_read_b128 a[216:219], v11 offset:2304
  s_waitcnt lgkmcnt(5)
  v_fmac_f32 v96, v128, v164
  v_mfma_f32_16x16x32_bf16 v[64:67], a[144:147], a[196:199], v[64:67]
  ds_read_b128 a[220:223], v11 offset:8448
  v_fmac_f32 v97, v129, v164
  v_mfma_f32_16x16x32_bf16 v[68:71], a[148:151], a[196:199], v[68:71]
  s_add_u32 s33, s33, 0x1000
  buffer_load_dwordx4 a[0:3], v12, s[8:11], s33 offen offset:0
  v_fmac_f32 v98, v130, v164
  v_mfma_f32_16x16x32_bf16 v[68:71], a[132:135], a[192:195], v[68:71]
  v_fmac_f32 v99, v131, v164
  v_mfma_f32_16x16x32_bf16 v[72:75], a[136:139], a[192:195], v[72:75]
  v_fmac_f32 v100, v132, v164
  v_mfma_f32_16x16x32_bf16 v[72:75], a[152:155], a[196:199], v[72:75]
  buffer_load_dwordx4 a[4:7], v12, s[8:11], s33 offen offset:256
  v_fmac_f32 v101, v133, v164
  v_mfma_f32_16x16x32_bf16 v[76:79], a[156:159], a[196:199], v[76:79]
  v_fmac_f32 v102, v134, v164
  v_mfma_f32_16x16x32_bf16 v[76:79], a[140:143], a[192:195], v[76:79]
  v_fmac_f32 v103, v135, v164
  s_waitcnt lgkmcnt(4)
  v_mfma_f32_16x16x32_bf16 v[80:83], a[128:131], a[200:203], v[80:83]
  ds_read_b128 a[192:195], v11 offset:13312
  v_fmac_f32 v112, v128, v166
  v_mfma_f32_16x16x32_bf16 v[80:83], a[144:147], a[204:207], v[80:83]
  ds_read_b128 a[196:199], v11 offset:19456
  v_fmac_f32 v113, v129, v166
  v_mfma_f32_16x16x32_bf16 v[84:87], a[148:151], a[204:207], v[84:87]
  buffer_load_dwordx4 a[8:11], v12, s[12:15], s33 offen offset:0
  v_fmac_f32 v114, v130, v166
  v_mfma_f32_16x16x32_bf16 v[84:87], a[132:135], a[200:203], v[84:87]
  v_fmac_f32 v115, v131, v166
  v_mfma_f32_16x16x32_bf16 v[88:91], a[136:139], a[200:203], v[88:91]
  v_fmac_f32 v116, v132, v166
  v_mfma_f32_16x16x32_bf16 v[88:91], a[152:155], a[204:207], v[88:91]
  buffer_load_dwordx4 a[12:15], v12, s[12:15], s33 offen offset:256
  v_fmac_f32 v117, v133, v166
  v_mfma_f32_16x16x32_bf16 v[92:95], a[156:159], a[204:207], v[92:95]
  v_fmac_f32 v118, v134, v166
  v_mfma_f32_16x16x32_bf16 v[92:95], a[140:143], a[200:203], v[92:95]
  v_fmac_f32 v119, v135, v166
  s_waitcnt lgkmcnt(4)
  v_mfma_f32_16x16x32_bf16 v[96:99], a[128:131], a[208:211], v[96:99]
  ds_read_b128 a[200:203], v11 offset:13568
  v_fmac_f32 v64, v128, v160
  v_mfma_f32_16x16x32_bf16 v[96:99], a[144:147], a[212:215], v[96:99]
  ds_read_b128 a[204:207], v11 offset:19712
  v_fmac_f32 v65, v129, v160
  v_mfma_f32_16x16x32_bf16 v[100:103], a[148:151], a[212:215], v[100:103]
  buffer_load_dwordx4 a[16:19], v12, s[8:11], s33 offen offset:2048
  v_fmac_f32 v66, v130, v160
  v_mfma_f32_16x16x32_bf16 v[100:103], a[132:135], a[208:211], v[100:103]
  v_fmac_f32 v67, v131, v160
  v_mfma_f32_16x16x32_bf16 v[104:107], a[136:139], a[208:211], v[104:107]
  v_fmac_f32 v68, v132, v160
  v_mfma_f32_16x16x32_bf16 v[104:107], a[152:155], a[212:215], v[104:107]
  buffer_load_dwordx4 a[20:23], v12, s[8:11], s33 offen offset:2304
  v_fmac_f32 v69, v133, v160
  v_mfma_f32_16x16x32_bf16 v[108:111], a[156:159], a[212:215], v[108:111]
  v_fmac_f32 v70, v134, v160
  v_mfma_f32_16x16x32_bf16 v[108:111], a[140:143], a[208:211], v[108:111]
  v_fmac_f32 v71, v135, v160
  s_waitcnt lgkmcnt(4)
  v_mfma_f32_16x16x32_bf16 v[112:115], a[128:131], a[216:219], v[112:115]
  ds_read_b128 a[208:211], v11 offset:14336
  v_fmac_f32 v80, v128, v162
  v_mfma_f32_16x16x32_bf16 v[112:115], a[144:147], a[220:223], v[112:115]
  ds_read_b128 a[212:215], v11 offset:20480
  v_fmac_f32 v81, v129, v162
  v_mfma_f32_16x16x32_bf16 v[116:119], a[148:151], a[220:223], v[116:119]
  buffer_load_dwordx4 a[24:27], v12, s[12:15], s33 offen offset:2048
  v_fmac_f32 v82, v130, v162
  v_mfma_f32_16x16x32_bf16 v[116:119], a[132:135], a[216:219], v[116:119]
  v_fmac_f32 v83, v131, v162
  v_mfma_f32_16x16x32_bf16 v[120:123], a[136:139], a[216:219], v[120:123]
  v_fmac_f32 v84, v132, v162
  v_mfma_f32_16x16x32_bf16 v[120:123], a[152:155], a[220:223], v[120:123]
  buffer_load_dwordx4 a[28:31], v12, s[12:15], s33 offen offset:2304
  v_fmac_f32 v85, v133, v162
  v_mfma_f32_16x16x32_bf16 v[124:127], a[156:159], a[220:223], v[124:127]
  v_fmac_f32 v86, v134, v162
  v_mfma_f32_16x16x32_bf16 v[124:127], a[140:143], a[216:219], v[124:127]
  v_fmac_f32 v87, v135, v162
  s_waitcnt vmcnt(8) lgkmcnt(4)
  v_mfma_f32_16x16x32_bf16 v[64:67], a[160:163], a[192:195], v[64:67]
  ds_read_b128 a[216:219], v11 offset:14592
  v_fmac_f32 v104, v136, v164
  v_mfma_f32_16x16x32_bf16 v[64:67], a[176:179], a[196:199], v[64:67]
  ds_read_b128 a[220:223], v11 offset:20736
  v_fmac_f32 v105, v137, v164
  v_mfma_f32_16x16x32_bf16 v[68:71], a[180:183], a[196:199], v[68:71]
  s_add_u32 s33, s33, 0x1000
  buffer_load_dwordx4 a[32:35], v12, s[8:11], s33 offen offset:0
  v_fmac_f32 v106, v138, v164
  v_mfma_f32_16x16x32_bf16 v[68:71], a[164:167], a[192:195], v[68:71]
  v_fmac_f32 v107, v139, v164
  v_mfma_f32_16x16x32_bf16 v[72:75], a[168:171], a[192:195], v[72:75]
  v_fmac_f32 v108, v140, v164
  v_mfma_f32_16x16x32_bf16 v[72:75], a[184:187], a[196:199], v[72:75]
  buffer_load_dwordx4 a[36:39], v12, s[8:11], s33 offen offset:256
  v_fmac_f32 v109, v141, v164
  v_mfma_f32_16x16x32_bf16 v[76:79], a[188:191], a[196:199], v[76:79]
  v_fmac_f32 v110, v142, v164
  v_mfma_f32_16x16x32_bf16 v[76:79], a[172:175], a[192:195], v[76:79]
  v_fmac_f32 v111, v143, v164
  s_waitcnt vmcnt(31) lgkmcnt(0)
  s_barrier
  v_mfma_f32_16x16x32_bf16 v[80:83], a[160:163], a[200:203], v[80:83]
  ds_read_b128 a[192:195], v11 offset:25600
  v_fmac_f32 v120, v136, v166
  v_mfma_f32_16x16x32_bf16 v[80:83], a[176:179], a[204:207], v[80:83]
  ds_read_b128 a[196:199], v11 offset:31744
  v_fmac_f32 v121, v137, v166
  v_mfma_f32_16x16x32_bf16 v[84:87], a[180:183], a[204:207], v[84:87]
  buffer_load_dwordx4 a[40:43], v12, s[12:15], s33 offen offset:0
  v_fmac_f32 v122, v138, v166
  v_mfma_f32_16x16x32_bf16 v[84:87], a[164:167], a[200:203], v[84:87]
  v_fmac_f32 v123, v139, v166
  v_mfma_f32_16x16x32_bf16 v[88:91], a[168:171], a[200:203], v[88:91]
  v_fmac_f32 v124, v140, v166
  v_mfma_f32_16x16x32_bf16 v[88:91], a[184:187], a[204:207], v[88:91]
  buffer_load_dwordx4 a[44:47], v12, s[12:15], s33 offen offset:256
  v_fmac_f32 v125, v141, v166
  v_mfma_f32_16x16x32_bf16 v[92:95], a[188:191], a[204:207], v[92:95]
  v_fmac_f32 v126, v142, v166
  v_mfma_f32_16x16x32_bf16 v[92:95], a[172:175], a[200:203], v[92:95]
  v_fmac_f32 v127, v143, v166
  s_waitcnt lgkmcnt(4)
  v_mfma_f32_16x16x32_bf16 v[96:99], a[160:163], a[208:211], v[96:99]
  ds_read_b128 a[200:203], v11 offset:25856
  v_fmac_f32 v72, v136, v160
  v_mfma_f32_16x16x32_bf16 v[96:99], a[176:179], a[212:215], v[96:99]
  ds_read_b128 a[204:207], v11 offset:32000
  v_fmac_f32 v73, v137, v160
  v_mfma_f32_16x16x32_bf16 v[100:103], a[180:183], a[212:215], v[100:103]
  buffer_load_dwordx4 a[48:51], v12, s[8:11], s33 offen offset:2048
  v_fmac_f32 v74, v138, v160
  v_mfma_f32_16x16x32_bf16 v[100:103], a[164:167], a[208:211], v[100:103]
  v_fmac_f32 v75, v139, v160
  v_mfma_f32_16x16x32_bf16 v[104:107], a[168:171], a[208:211], v[104:107]
  v_fmac_f32 v76, v140, v160
  v_mfma_f32_16x16x32_bf16 v[104:107], a[184:187], a[212:215], v[104:107]
  buffer_load_dwordx4 a[52:55], v12, s[8:11], s33 offen offset:2304
  v_fmac_f32 v77, v141, v160
  v_mfma_f32_16x16x32_bf16 v[108:111], a[188:191], a[212:215], v[108:111]
  v_fmac_f32 v78, v142, v160
  v_mfma_f32_16x16x32_bf16 v[108:111], a[172:175], a[208:211], v[108:111]
  v_fmac_f32 v79, v143, v160
  s_waitcnt lgkmcnt(4)
  v_mfma_f32_16x16x32_bf16 v[112:115], a[160:163], a[216:219], v[112:115]
  ds_read_b128 a[208:211], v11 offset:26624
  v_fmac_f32 v88, v136, v162
  v_mfma_f32_16x16x32_bf16 v[112:115], a[176:179], a[220:223], v[112:115]
  ds_read_b128 a[212:215], v11 offset:32768
  v_fmac_f32 v89, v137, v162
  v_mfma_f32_16x16x32_bf16 v[116:119], a[180:183], a[220:223], v[116:119]
  buffer_load_dwordx4 a[56:59], v12, s[12:15], s33 offen offset:2048
  v_fmac_f32 v90, v138, v162
  v_mfma_f32_16x16x32_bf16 v[116:119], a[164:167], a[216:219], v[116:119]
  v_fmac_f32 v91, v139, v162
  v_mfma_f32_16x16x32_bf16 v[120:123], a[168:171], a[216:219], v[120:123]
  v_fmac_f32 v92, v140, v162
  v_mfma_f32_16x16x32_bf16 v[120:123], a[184:187], a[220:223], v[120:123]
  buffer_load_dwordx4 a[60:63], v12, s[12:15], s33 offen offset:2304
  v_fmac_f32 v93, v141, v162
  v_mfma_f32_16x16x32_bf16 v[124:127], a[188:191], a[220:223], v[124:127]
  v_fmac_f32 v94, v142, v162
  v_mfma_f32_16x16x32_bf16 v[124:127], a[172:175], a[216:219], v[124:127]
  v_fmac_f32 v95, v143, v162
  s_waitcnt vmcnt(8) lgkmcnt(4)
  v_mfma_f32_16x16x32_bf16 v[64:67], a[0:3], a[192:195], v[64:67]
  ds_read_b128 a[216:219], v11 offset:26880
  v_fmac_f32 v32, v16, v168
  v_mfma_f32_16x16x32_bf16 v[64:67], a[16:19], a[196:199], v[64:67]
  ds_read_b128 a[220:223], v11 offset:33024
  v_fmac_f32 v33, v16, v169
  v_mfma_f32_16x16x32_bf16 v[68:71], a[20:23], a[196:199], v[68:71]
  v_fmac_f32 v34, v16, v170
  v_mfma_f32_16x16x32_bf16 v[68:71], a[4:7], a[192:195], v[68:71]
  v_fmac_f32 v35, v16, v171
  v_mfma_f32_16x16x32_bf16 v[72:75], a[8:11], a[192:195], v[72:75]
  v_fmac_f32 v36, v17, v168
  v_mfma_f32_16x16x32_bf16 v[72:75], a[24:27], a[196:199], v[72:75]
  v_fmac_f32 v37, v17, v169
  v_mfma_f32_16x16x32_bf16 v[76:79], a[28:31], a[196:199], v[76:79]
  v_fmac_f32 v38, v17, v170
  v_mfma_f32_16x16x32_bf16 v[76:79], a[12:15], a[192:195], v[76:79]
  v_fmac_f32 v39, v17, v171
  s_waitcnt lgkmcnt(4)
  v_mfma_f32_16x16x32_bf16 v[80:83], a[0:3], a[200:203], v[80:83]
  ds_read_b128 a[192:195], v11 offset:37888
  v_fmac_f32 v40, v18, v168
  v_mfma_f32_16x16x32_bf16 v[80:83], a[16:19], a[204:207], v[80:83]
  ds_read_b128 a[196:199], v11 offset:44032
  v_fmac_f32 v41, v18, v169
  v_mfma_f32_16x16x32_bf16 v[84:87], a[20:23], a[204:207], v[84:87]
  v_fmac_f32 v42, v18, v170
  v_mfma_f32_16x16x32_bf16 v[84:87], a[4:7], a[200:203], v[84:87]
  v_fmac_f32 v43, v18, v171
  v_mfma_f32_16x16x32_bf16 v[88:91], a[8:11], a[200:203], v[88:91]
  v_fmac_f32 v44, v19, v168
  v_mfma_f32_16x16x32_bf16 v[88:91], a[24:27], a[204:207], v[88:91]
  v_fmac_f32 v45, v19, v169
  v_mfma_f32_16x16x32_bf16 v[92:95], a[28:31], a[204:207], v[92:95]
  v_fmac_f32 v46, v19, v170
  v_mfma_f32_16x16x32_bf16 v[92:95], a[12:15], a[200:203], v[92:95]
  v_fmac_f32 v47, v19, v171
  s_waitcnt lgkmcnt(4)
  v_mfma_f32_16x16x32_bf16 v[96:99], a[0:3], a[208:211], v[96:99]
  ds_read_b128 a[200:203], v11 offset:38144
  v_fmac_f32 v48, v16, v172
  v_mfma_f32_16x16x32_bf16 v[96:99], a[16:19], a[212:215], v[96:99]
  ds_read_b128 a[204:207], v11 offset:44288
  v_fmac_f32 v49, v16, v173
  v_mfma_f32_16x16x32_bf16 v[100:103], a[20:23], a[212:215], v[100:103]
  v_fmac_f32 v50, v16, v174
  v_mfma_f32_16x16x32_bf16 v[100:103], a[4:7], a[208:211], v[100:103]
  v_fmac_f32 v51, v16, v175
  v_mfma_f32_16x16x32_bf16 v[104:107], a[8:11], a[208:211], v[104:107]
  v_fmac_f32 v52, v17, v172
  v_mfma_f32_16x16x32_bf16 v[104:107], a[24:27], a[212:215], v[104:107]
  v_fmac_f32 v53, v17, v173
  v_mfma_f32_16x16x32_bf16 v[108:111], a[28:31], a[212:215], v[108:111]
  v_fmac_f32 v54, v17, v174
  v_mfma_f32_16x16x32_bf16 v[108:111], a[12:15], a[208:211], v[108:111]
  v_fmac_f32 v55, v17, v175
  s_waitcnt lgkmcnt(4)
  v_mfma_f32_16x16x32_bf16 v[112:115], a[0:3], a[216:219], v[112:115]
  ds_read_b128 a[208:211], v11 offset:38912
  v_fmac_f32 v56, v18, v172
  v_mfma_f32_16x16x32_bf16 v[112:115], a[16:19], a[220:223], v[112:115]
  ds_read_b128 a[212:215], v11 offset:45056
  v_fmac_f32 v57, v18, v173
  v_mfma_f32_16x16x32_bf16 v[116:119], a[20:23], a[220:223], v[116:119]
  v_fmac_f32 v58, v18, v174
  v_mfma_f32_16x16x32_bf16 v[116:119], a[4:7], a[216:219], v[116:119]
  v_fmac_f32 v59, v18, v175
  v_mfma_f32_16x16x32_bf16 v[120:123], a[8:11], a[216:219], v[120:123]
  v_fmac_f32 v60, v19, v172
  v_mfma_f32_16x16x32_bf16 v[120:123], a[24:27], a[220:223], v[120:123]
  v_fmac_f32 v61, v19, v173
  v_mfma_f32_16x16x32_bf16 v[124:127], a[28:31], a[220:223], v[124:127]
  v_fmac_f32 v62, v19, v174
  v_mfma_f32_16x16x32_bf16 v[124:127], a[12:15], a[216:219], v[124:127]
  v_fmac_f32 v63, v19, v175
  s_waitcnt vmcnt(0) lgkmcnt(4)
  v_mfma_f32_16x16x32_bf16 v[64:67], a[32:35], a[192:195], v[64:67]
  ds_read_b128 a[216:219], v11 offset:39168
  v_mfma_f32_16x16x32_bf16 v[64:67], a[48:51], a[196:199], v[64:67]
  ds_read_b128 a[220:223], v11 offset:45312
  v_mfma_f32_16x16x32_bf16 v[68:71], a[52:55], a[196:199], v[68:71]
  v_mfma_f32_16x16x32_bf16 v[68:71], a[36:39], a[192:195], v[68:71]
  v_mfma_f32_16x16x32_bf16 v[72:75], a[40:43], a[192:195], v[72:75]
  v_mfma_f32_16x16x32_bf16 v[72:75], a[56:59], a[196:199], v[72:75]
  v_mfma_f32_16x16x32_bf16 v[76:79], a[60:63], a[196:199], v[76:79]
  v_mfma_f32_16x16x32_bf16 v[76:79], a[44:47], a[192:195], v[76:79]
  s_waitcnt lgkmcnt(4)
  v_mfma_f32_16x16x32_bf16 v[80:83], a[32:35], a[200:203], v[80:83]
  ds_read_b128 a[192:195], v10 offset:24576
  v_mfma_f32_16x16x32_bf16 v[80:83], a[48:51], a[204:207], v[80:83]
  ds_read_b128 a[196:199], v10 offset:30720
  v_mfma_f32_16x16x32_bf16 v[84:87], a[52:55], a[204:207], v[84:87]
  v_mfma_f32_16x16x32_bf16 v[84:87], a[36:39], a[200:203], v[84:87]
  v_mfma_f32_16x16x32_bf16 v[88:91], a[40:43], a[200:203], v[88:91]
  v_mfma_f32_16x16x32_bf16 v[88:91], a[56:59], a[204:207], v[88:91]
  v_mfma_f32_16x16x32_bf16 v[92:95], a[60:63], a[204:207], v[92:95]
  v_mfma_f32_16x16x32_bf16 v[92:95], a[44:47], a[200:203], v[92:95]
  s_waitcnt lgkmcnt(4)
  v_mfma_f32_16x16x32_bf16 v[96:99], a[32:35], a[208:211], v[96:99]
  ds_read_b128 a[200:203], v10 offset:36864
  v_mfma_f32_16x16x32_bf16 v[96:99], a[48:51], a[212:215], v[96:99]
  ds_read_b128 a[204:207], v10 offset:43008
  v_mfma_f32_16x16x32_bf16 v[100:103], a[52:55], a[212:215], v[100:103]
  v_mfma_f32_16x16x32_bf16 v[100:103], a[36:39], a[208:211], v[100:103]
  v_mfma_f32_16x16x32_bf16 v[104:107], a[40:43], a[208:211], v[104:107]
  v_mfma_f32_16x16x32_bf16 v[104:107], a[56:59], a[212:215], v[104:107]
  v_mfma_f32_16x16x32_bf16 v[108:111], a[60:63], a[212:215], v[108:111]
  v_mfma_f32_16x16x32_bf16 v[108:111], a[44:47], a[208:211], v[108:111]
  s_waitcnt lgkmcnt(4)
  v_mfma_f32_16x16x32_bf16 v[112:115], a[32:35], a[216:219], v[112:115]
  ds_read_b128 a[208:211], v11 offset:0
  v_mfma_f32_16x16x32_bf16 v[112:115], a[48:51], a[220:223], v[112:115]
  ds_read_b128 a[212:215], v11 offset:6144
  v_mfma_f32_16x16x32_bf16 v[116:119], a[52:55], a[220:223], v[116:119]
  v_mfma_f32_16x16x32_bf16 v[116:119], a[36:39], a[216:219], v[116:119]
  v_mfma_f32_16x16x32_bf16 v[120:123], a[40:43], a[216:219], v[120:123]
  v_mfma_f32_16x16x32_bf16 v[120:123], a[56:59], a[220:223], v[120:123]
  v_mfma_f32_16x16x32_bf16 v[124:127], a[60:63], a[220:223], v[124:127]
  v_mfma_f32_16x16x32_bf16 v[124:127], a[44:47], a[216:219], v[124:127]
  s_cmp_lg_u32 s3, 0
  s_cbranch_scc1 bgt_skip
  s_lshl_b32 s39, s2, 2
  s_add_u32 s39, s39, s30
  s_mul_i32 s39, s39, 7168
  buffer_load_dwordx4 a[252:255], v1, s[56:59], s39 offen
  s_add_u32 s39, s39, 0x400
  buffer_load_dwordx4 a[252:255], v1, s[56:59], s39 offen
  s_add_u32 s39, s39, 0x400
  buffer_load_dwordx4 a[252:255], v1, s[56:59], s39 offen
  s_add_u32 s39, s39, 0x400
  buffer_load_dwordx4 a[252:255], v1, s[56:59], s39 offen
  s_add_u32 s39, s39, 0x400
  buffer_load_dwordx4 a[252:255], v1, s[56:59], s39 offen
  s_add_u32 s39, s39, 0x400
  buffer_load_dwordx4 a[252:255], v1, s[56:59], s39 offen
  s_add_u32 s39, s39, 0x400
  buffer_load_dwordx4 a[252:255], v1, s[56:59], s39 offen
  s_add_u32 s39, s39, 0x400
bgt_skip:
  v_pk_fma_f32 v[64:65], v[64:65], v[144:145], s[54:55]
  v_pk_fma_f32 v[66:67], v[66:67], v[146:147], s[54:55]
  v_pk_fma_f32 v[68:69], v[68:69], v[148:149], s[54:55]
  v_pk_fma_f32 v[70:71], v[70:71], v[150:151], s[54:55]
  v_pk_fma_f32 v[72:73], v[72:73], v[152:153], s[54:55]
  v_pk_fma_f32 v[74:75], v[74:75], v[154:155], s[54:55]
  v_pk_fma_f32 v[76:77], v[76:77], v[156:157], s[54:55]
  v_pk_fma_f32 v[78:79], v[78:79], v[158:159], s[54:55]
  v_pk_fma_f32 v[80:81], v[80:81], v[144:145], s[54:55]
  v_pk_fma_f32 v[82:83], v[82:83], v[146:147], s[54:55]
  v_pk_fma_f32 v[84:85], v[84:85], v[148:149], s[54:55]
  v_pk_fma_f32 v[86:87], v[86:87], v[150:151], s[54:55]
  v_pk_fma_f32 v[88:89], v[88:89], v[152:153], s[54:55]
  v_pk_fma_f32 v[90:91], v[90:91], v[154:155], s[54:55]
  v_pk_fma_f32 v[92:93], v[92:93], v[156:157], s[54:55]
  v_pk_fma_f32 v[94:95], v[94:95], v[158:159], s[54:55]
  v_pk_mul_f32 v[224:225], v[64:65], s[52:53]
  v_pk_mul_f32 v[226:227], v[66:67], s[52:53]
  v_pk_mul_f32 v[228:229], v[68:69], s[52:53]
  v_pk_mul_f32 v[230:231], v[70:71], s[52:53]
  v_pk_mul_f32 v[232:233], v[72:73], s[52:53]
  v_pk_mul_f32 v[234:235], v[74:75], s[52:53]
  v_pk_mul_f32 v[236:237], v[76:77], s[52:53]
  v_pk_mul_f32 v[238:239], v[78:79], s[52:53]
  v_pk_mul_f32 v[240:241], v[80:81], s[52:53]
  v_pk_mul_f32 v[242:243], v[82:83], s[52:53]
  v_pk_mul_f32 v[244:245], v[84:85], s[52:53]
  v_pk_mul_f32 v[246:247], v[86:87], s[52:53]
  v_pk_mul_f32 v[248:249], v[88:89], s[52:53]
  v_pk_mul_f32 v[250:251], v[90:91], s[52:53]
  v_pk_mul_f32 v[252:253], v[92:93], s[52:53]
  v_pk_mul_f32 v[254:255], v[94:95], s[52:53]
  v_exp_f32 v224, v224 clamp
  v_exp_f32 v225, v225 clamp
  v_exp_f32 v226, v226 clamp
  v_exp_f32 v227, v227 clamp
  v_exp_f32 v228, v228 clamp
  v_exp_f32 v229, v229 clamp
  v_exp_f32 v230, v230 clamp
  v_exp_f32 v231, v231 clamp
  v_exp_f32 v232, v232 clamp
  v_exp_f32 v233, v233 clamp
  v_exp_f32 v234, v234 clamp
  v_exp_f32 v235, v235 clamp
  v_exp_f32 v236, v236 clamp
  v_exp_f32 v237, v237 clamp
  v_exp_f32 v238, v238 clamp
  v_exp_f32 v239, v239 clamp
  v_exp_f32 v240, v240 clamp
  v_exp_f32 v241, v241 clamp
  v_exp_f32 v242, v242 clamp
  v_exp_f32 v243, v243 clamp
  v_exp_f32 v244, v244 clamp
  v_exp_f32 v245, v245 clamp
  v_exp_f32 v246, v246 clamp
  v_exp_f32 v247, v247 clamp
  v_exp_f32 v248, v248 clamp
  v_exp_f32 v249, v249 clamp
  v_exp_f32 v250, v250 clamp
  v_exp_f32 v251, v251 clamp
  v_exp_f32 v252, v252 clamp
  v_exp_f32 v253, v253 clamp
  v_exp_f32 v254, v254 clamp
  v_exp_f32 v255, v255 clamp
  v_max_f32 v64, 897988541, v64
  v_max_f32 v65, 897988541, v65
  v_max_f32 v66, 897988541, v66
  v_max_f32 v67, 897988541, v67
  v_max_f32 v68, 897988541, v68
  v_max_f32 v69, 897988541, v69
  v_max_f32 v70, 897988541, v70
  v_max_f32 v71, 897988541, v71
  v_max_f32 v72, 897988541, v72
  v_max_f32 v73, 897988541, v73
  v_max_f32 v74, 897988541, v74
  v_max_f32 v75, 897988541, v75
  v_max_f32 v76, 897988541, v76
  v_max_f32 v77, 897988541, v77
  v_max_f32 v78, 897988541, v78
  v_max_f32 v79, 897988541, v79
  v_max_f32 v80, 897988541, v80
  v_max_f32 v81, 897988541, v81
  v_max_f32 v82, 897988541, v82
  v_max_f32 v83, 897988541, v83
  v_max_f32 v84, 897988541, v84
  v_max_f32 v85, 897988541, v85
  v_max_f32 v86, 897988541, v86
  v_max_f32 v87, 897988541, v87
  v_max_f32 v88, 897988541, v88
  v_max_f32 v89, 897988541, v89
  v_max_f32 v90, 897988541, v90
  v_max_f32 v91, 897988541, v91
  v_max_f32 v92, 897988541, v92
  v_max_f32 v93, 897988541, v93
  v_max_f32 v94, 897988541, v94
  v_max_f32 v95, 897988541, v95
  v_pk_add_f32 v[64:65], v[64:65], v[224:225]
  v_pk_add_f32 v[66:67], v[66:67], v[226:227]
  v_pk_add_f32 v[68:69], v[68:69], v[228:229]
  v_pk_add_f32 v[70:71], v[70:71], v[230:231]
  v_pk_add_f32 v[72:73], v[72:73], v[232:233]
  v_pk_add_f32 v[74:75], v[74:75], v[234:235]
  v_pk_add_f32 v[76:77], v[76:77], v[236:237]
  v_pk_add_f32 v[78:79], v[78:79], v[238:239]
  v_pk_add_f32 v[80:81], v[80:81], v[240:241]
  v_pk_add_f32 v[82:83], v[82:83], v[242:243]
  v_pk_add_f32 v[84:85], v[84:85], v[244:245]
  v_pk_add_f32 v[86:87], v[86:87], v[246:247]
  v_pk_add_f32 v[88:89], v[88:89], v[248:249]
  v_pk_add_f32 v[90:91], v[90:91], v[250:251]
  v_pk_add_f32 v[92:93], v[92:93], v[252:253]
  v_pk_add_f32 v[94:95], v[94:95], v[254:255]
  v_pk_mul_f32 v[96:97], v[96:97], v[144:145]
  v_pk_mul_f32 v[98:99], v[98:99], v[146:147]
  v_pk_mul_f32 v[100:101], v[100:101], v[148:149]
  v_pk_mul_f32 v[102:103], v[102:103], v[150:151]
  v_pk_mul_f32 v[104:105], v[104:105], v[152:153]
  v_pk_mul_f32 v[106:107], v[106:107], v[154:155]
  v_pk_mul_f32 v[108:109], v[108:109], v[156:157]
  v_pk_mul_f32 v[110:111], v[110:111], v[158:159]
  v_pk_mul_f32 v[112:113], v[112:113], v[144:145]
  v_pk_mul_f32 v[114:115], v[114:115], v[146:147]
  v_pk_mul_f32 v[116:117], v[116:117], v[148:149]
  v_pk_mul_f32 v[118:119], v[118:119], v[150:151]
  v_pk_mul_f32 v[120:121], v[120:121], v[152:153]
  v_pk_mul_f32 v[122:123], v[122:123], v[154:155]
  v_pk_mul_f32 v[124:125], v[124:125], v[156:157]
  v_pk_mul_f32 v[126:127], v[126:127], v[158:159]
  v_cvt_pk_bf16_f32 v64, v64, v65
  v_cvt_pk_bf16_f32 v65, v66, v67
  v_cvt_pk_bf16_f32 v66, v68, v69
  v_cvt_pk_bf16_f32 v67, v70, v71
  v_cvt_pk_bf16_f32 v68, v72, v73
  v_cvt_pk_bf16_f32 v69, v74, v75
  v_cvt_pk_bf16_f32 v70, v76, v77
  v_cvt_pk_bf16_f32 v71, v78, v79
  v_cvt_pk_bf16_f32 v72, v80, v81
  v_cvt_pk_bf16_f32 v73, v82, v83
  v_cvt_pk_bf16_f32 v74, v84, v85
  v_cvt_pk_bf16_f32 v75, v86, v87
  v_cvt_pk_bf16_f32 v76, v88, v89
  v_cvt_pk_bf16_f32 v77, v90, v91
  v_cvt_pk_bf16_f32 v78, v92, v93
  v_cvt_pk_bf16_f32 v79, v94, v95
  v_cvt_pk_bf16_f32 v96, v96, v97
  v_cvt_pk_bf16_f32 v97, v98, v99
  v_cvt_pk_bf16_f32 v98, v100, v101
  v_cvt_pk_bf16_f32 v99, v102, v103
  v_cvt_pk_bf16_f32 v100, v104, v105
  v_cvt_pk_bf16_f32 v101, v106, v107
  v_cvt_pk_bf16_f32 v102, v108, v109
  v_cvt_pk_bf16_f32 v103, v110, v111
  v_cvt_pk_bf16_f32 v104, v112, v113
  v_cvt_pk_bf16_f32 v105, v114, v115
  v_cvt_pk_bf16_f32 v106, v116, v117
  v_cvt_pk_bf16_f32 v107, v118, v119
  v_cvt_pk_bf16_f32 v108, v120, v121
  v_cvt_pk_bf16_f32 v109, v122, v123
  v_cvt_pk_bf16_f32 v110, v124, v125
  v_cvt_pk_bf16_f32 v111, v126, v127
  v_mfma_f32_16x16x32_bf16 v[192:195], v[64:67], v[96:99], 0
  v_mfma_f32_16x16x32_bf16 v[192:195], v[68:71], v[100:103], v[192:195]
  v_mfma_f32_16x16x32_bf16 v[196:199], v[64:67], v[104:107], 0
  v_mfma_f32_16x16x32_bf16 v[196:199], v[68:71], v[108:111], v[196:199]
  v_mfma_f32_16x16x32_bf16 v[200:203], v[72:75], v[96:99], 0
  v_mfma_f32_16x16x32_bf16 v[200:203], v[76:79], v[100:103], v[200:203]
  v_mfma_f32_16x16x32_bf16 v[204:207], v[72:75], v[104:107], 0
  v_mfma_f32_16x16x32_bf16 v[204:207], v[76:79], v[108:111], v[204:207]
  v_mfma_f32_16x16x32_bf16 v[208:211], v[216:219], v[64:67], 0
  v_mfma_f32_16x16x32_bf16 v[208:211], v[216:219], v[68:71], v[208:211]
  v_mfma_f32_16x16x32_bf16 v[212:215], v[216:219], v[72:75], 0
  v_mfma_f32_16x16x32_bf16 v[212:215], v[216:219], v[76:79], v[212:215]
  s_lshl_b32 s39, s30, 12
  s_add_u32 s39, s39, 102400
  v_add_u32 v4, s39, v1
  s_lshl_b32 s39, s30, 9
  s_add_u32 s39, s39, 118784
  v_lshl_add_u32 v5, v0, 2, s39
  ds_write_b128 v4, v[192:195] offset:0
  ds_write_b128 v4, v[196:199] offset:1024
  ds_write_b128 v4, v[200:203] offset:2048
  ds_write_b128 v4, v[204:207] offset:3072
  ds_write_b32 v5, v208
  ds_write_b32 v5, v212 offset:256
  s_lshl_b32 s39, s30, 10
  s_add_u32 s39, s39, 102400
  v_add_u32 v4, s39, v1
  v_bfe_u32 v5, v0, 4, 1
  v_lshl_add_u32 v5, v5, 8, v24
  v_add_u32 v5, 118784, v5
  s_lshr_b32 s39, s3, 1
  s_lshl_b32 s39, s39, 5
  s_add_u32 s39, s39, s49
  s_lshl_b32 s44, s39, 15
  s_lshl_b32 s40, s30, 10
  s_add_u32 s44, s44, s40
  s_add_u32 s44, s44, 524288
  s_lshl_b32 s45, s39, 10
  s_add_u32 s45, s45, 262144
  s_lshl_b32 s39, s48, 12
  s_add_u32 s39, s39, s44
  s_lshl_b32 s40, s48, 7
  s_add_u32 s40, s40, s45
  s_cmp_eq_u32 s30, 3
  s_cselect_b32 s40, s40, 0x7f000000
  s_waitcnt lgkmcnt(0)
  s_barrier
  ds_read_b128 v[192:195], v4 offset:0
  ds_read_b128 v[196:199], v4 offset:4096
  ds_read_b128 v[200:203], v4 offset:8192
  ds_read_b128 v[204:207], v4 offset:12288
  ds_read_b32 v208, v5 offset:0
  ds_read_b32 v209, v5 offset:512
  ds_read_b32 v210, v5 offset:1024
  ds_read_b32 v211, v5 offset:1536
  v_and_b32 v5, 31, v0
  v_lshlrev_b32 v5, 2, v5
  s_waitcnt lgkmcnt(4)
  v_pk_add_f32 v[192:193], v[192:193], v[196:197]
  v_pk_add_f32 v[194:195], v[194:195], v[198:199]
  v_pk_add_f32 v[192:193], v[192:193], v[200:201]
  v_pk_add_f32 v[194:195], v[194:195], v[202:203]
  v_pk_add_f32 v[192:193], v[192:193], v[204:205]
  v_pk_add_f32 v[194:195], v[194:195], v[206:207]
  buffer_store_dwordx4 v[192:195], v1, s[24:27], s39 offen sc1
  s_waitcnt lgkmcnt(0)
  v_pk_add_f32 v[208:209], v[208:209], v[210:211]
  v_add_f32 v208, v208, v209
  buffer_store_dword v208, v5, s[24:27], s40 offen sc1
  s_waitcnt lgkmcnt(4)
  v_mfma_f32_16x16x32_bf16 v[32:35], a[192:195], a[64:67], v[32:35]
  ds_read_b128 a[216:219], v11 offset:12288
  s_mul_i32 s39, s51, 131072
  s_add_u32 s39, s39, 39845888
  v_mfma_f32_16x16x32_bf16 v[32:35], a[196:199], a[80:83], v[32:35]
  ds_read_b128 a[220:223], v11 offset:18432
  s_add_u32 s16, s6, s39
  s_addc_u32 s17, s7, 0
  v_mfma_f32_16x16x32_bf16 v[36:39], a[196:199], a[84:87], v[36:39]
  s_mov_b32 s18, 131072
  s_mov_b32 s19, 0x20000
  v_mfma_f32_16x16x32_bf16 v[36:39], a[192:195], a[68:71], v[36:39]
  s_mul_i32 s39, s30, 8192
  v_mfma_f32_16x16x32_bf16 v[40:43], a[192:195], a[72:75], v[40:43]
  v_add_u32 v2, s39, v1
  v_add_u32 v3, 0x1000, v2
  v_mfma_f32_16x16x32_bf16 v[40:43], a[196:199], a[88:91], v[40:43]
  s_add_u32 s35, s39, 98304
  s_add_u32 s36, s39, 32768
  v_mfma_f32_16x16x32_bf16 v[44:47], a[196:199], a[92:95], v[44:47]
  s_mov_b32 s37, 4294901760
  s_mov_b32 s33, 0
  v_mfma_f32_16x16x32_bf16 v[44:47], a[192:195], a[76:79], v[44:47]
  s_mov_b32 s34, 0
  s_waitcnt lgkmcnt(4)
  v_mfma_f32_16x16x32_bf16 v[32:35], a[200:203], a[96:99], v[32:35]
  ds_read_b128 a[192:195], v11 offset:24576
  s_add_u32 m0, s35, 32768
  v_mfma_f32_16x16x32_bf16 v[32:35], a[204:207], a[112:115], v[32:35]
  ds_read_b128 a[196:199], v11 offset:30720
  v_mfma_f32_16x16x32_bf16 v[36:39], a[204:207], a[116:119], v[36:39]
  v_mfma_f32_16x16x32_bf16 v[36:39], a[200:203], a[100:103], v[36:39]
  v_mfma_f32_16x16x32_bf16 v[40:43], a[200:203], a[104:107], v[40:43]
  buffer_load_dwordx4 v2, s[16:19], s34 offen offset:0 lds
  v_mfma_f32_16x16x32_bf16 v[40:43], a[204:207], a[120:123], v[40:43]
  v_mfma_f32_16x16x32_bf16 v[44:47], a[204:207], a[124:127], v[44:47]
  v_mfma_f32_16x16x32_bf16 v[44:47], a[200:203], a[108:111], v[44:47]
  s_waitcnt lgkmcnt(4)
  v_mfma_f32_16x16x32_bf16 v[32:35], a[208:211], a[128:131], v[32:35]
  ds_read_b128 a[200:203], v11 offset:36864
  buffer_load_dwordx4 v2, s[16:19], s34 offen offset:1024 lds
  v_mfma_f32_16x16x32_bf16 v[32:35], a[212:215], a[144:147], v[32:35]
  ds_read_b128 a[204:207], v11 offset:43008
  v_mfma_f32_16x16x32_bf16 v[36:39], a[212:215], a[148:151], v[36:39]
  v_mfma_f32_16x16x32_bf16 v[36:39], a[208:211], a[132:135], v[36:39]
  v_mfma_f32_16x16x32_bf16 v[40:43], a[208:211], a[136:139], v[40:43]
  v_mfma_f32_16x16x32_bf16 v[40:43], a[212:215], a[152:155], v[40:43]
  v_mfma_f32_16x16x32_bf16 v[44:47], a[212:215], a[156:159], v[44:47]
  v_mfma_f32_16x16x32_bf16 v[44:47], a[208:211], a[140:143], v[44:47]
  s_waitcnt lgkmcnt(4)
  v_mfma_f32_16x16x32_bf16 v[32:35], a[216:219], a[160:163], v[32:35]
  ds_read_b128 a[208:211], v10 offset:24832
  buffer_load_dwordx4 v2, s[16:19], s34 offen offset:2048 lds
  v_mfma_f32_16x16x32_bf16 v[32:35], a[220:223], a[176:179], v[32:35]
  ds_read_b128 a[212:215], v10 offset:30976
  v_mfma_f32_16x16x32_bf16 v[36:39], a[220:223], a[180:183], v[36:39]
  v_mfma_f32_16x16x32_bf16 v[36:39], a[216:219], a[164:167], v[36:39]
  v_mfma_f32_16x16x32_bf16 v[40:43], a[216:219], a[168:171], v[40:43]
  v_mfma_f32_16x16x32_bf16 v[40:43], a[220:223], a[184:187], v[40:43]
  v_mfma_f32_16x16x32_bf16 v[44:47], a[220:223], a[188:191], v[44:47]
  v_mfma_f32_16x16x32_bf16 v[44:47], a[216:219], a[172:175], v[44:47]
  s_waitcnt lgkmcnt(4)
  v_mfma_f32_16x16x32_bf16 v[32:35], a[192:195], a[0:3], v[32:35]
  ds_read_b128 a[216:219], v10 offset:37120
  buffer_load_dwordx4 v2, s[16:19], s34 offen offset:3072 lds
  v_mfma_f32_16x16x32_bf16 v[32:35], a[196:199], a[16:19], v[32:35]
  ds_read_b128 a[220:223], v10 offset:43264
  v_mfma_f32_16x16x32_bf16 v[36:39], a[196:199], a[20:23], v[36:39]
  v_mfma_f32_16x16x32_bf16 v[36:39], a[192:195], a[4:7], v[36:39]
  v_mfma_f32_16x16x32_bf16 v[40:43], a[192:195], a[8:11], v[40:43]
  v_mfma_f32_16x16x32_bf16 v[40:43], a[196:199], a[24:27], v[40:43]
  v_mfma_f32_16x16x32_bf16 v[44:47], a[196:199], a[28:31], v[44:47]
  v_mfma_f32_16x16x32_bf16 v[44:47], a[192:195], a[12:15], v[44:47]
  s_waitcnt lgkmcnt(4)
  v_mfma_f32_16x16x32_bf16 v[32:35], a[200:203], a[32:35], v[32:35]
  ds_read_b128 a[192:195], v11 offset:256
  v_mfma_f32_16x16x32_bf16 v[32:35], a[204:207], a[48:51], v[32:35]
  ds_read_b128 a[196:199], v11 offset:6400
  v_mfma_f32_16x16x32_bf16 v[36:39], a[204:207], a[52:55], v[36:39]
  v_mfma_f32_16x16x32_bf16 v[36:39], a[200:203], a[36:39], v[36:39]
  v_mfma_f32_16x16x32_bf16 v[40:43], a[200:203], a[40:43], v[40:43]
  v_mfma_f32_16x16x32_bf16 v[40:43], a[204:207], a[56:59], v[40:43]
  v_mfma_f32_16x16x32_bf16 v[44:47], a[204:207], a[60:63], v[44:47]
  v_mfma_f32_16x16x32_bf16 v[44:47], a[200:203], a[44:47], v[44:47]
  s_waitcnt lgkmcnt(4)
  v_mfma_f32_16x16x32_bf16 v[48:51], a[208:211], a[64:67], v[48:51]
  ds_read_b128 a[200:203], v11 offset:12544
  s_add_u32 m0, s35, 36864
  v_mfma_f32_16x16x32_bf16 v[48:51], a[212:215], a[80:83], v[48:51]
  ds_read_b128 a[204:207], v11 offset:18688
  v_mfma_f32_16x16x32_bf16 v[52:55], a[212:215], a[84:87], v[52:55]
  v_mfma_f32_16x16x32_bf16 v[52:55], a[208:211], a[68:71], v[52:55]
  v_mfma_f32_16x16x32_bf16 v[56:59], a[208:211], a[72:75], v[56:59]
  buffer_load_dwordx4 v3, s[16:19], s34 offen offset:0 lds
  v_mfma_f32_16x16x32_bf16 v[56:59], a[212:215], a[88:91], v[56:59]
  v_mfma_f32_16x16x32_bf16 v[60:63], a[212:215], a[92:95], v[60:63]
  v_mfma_f32_16x16x32_bf16 v[60:63], a[208:211], a[76:79], v[60:63]
  s_waitcnt lgkmcnt(4)
  v_mfma_f32_16x16x32_bf16 v[48:51], a[216:219], a[96:99], v[48:51]
  ds_read_b128 a[208:211], v11 offset:24832
  buffer_load_dwordx4 v3, s[16:19], s34 offen offset:1024 lds
  v_mfma_f32_16x16x32_bf16 v[48:51], a[220:223], a[112:115], v[48:51]
  ds_read_b128 a[212:215], v11 offset:30976
  v_mfma_f32_16x16x32_bf16 v[52:55], a[220:223], a[116:119], v[52:55]
  v_mfma_f32_16x16x32_bf16 v[52:55], a[216:219], a[100:103], v[52:55]
  v_mfma_f32_16x16x32_bf16 v[56:59], a[216:219], a[104:107], v[56:59]
  v_mfma_f32_16x16x32_bf16 v[56:59], a[220:223], a[120:123], v[56:59]
  v_mfma_f32_16x16x32_bf16 v[60:63], a[220:223], a[124:127], v[60:63]
  v_mfma_f32_16x16x32_bf16 v[60:63], a[216:219], a[108:111], v[60:63]
  s_waitcnt lgkmcnt(4)
  v_mfma_f32_16x16x32_bf16 v[48:51], a[192:195], a[128:131], v[48:51]
  ds_read_b128 a[216:219], v11 offset:37120
  buffer_load_dwordx4 v3, s[16:19], s34 offen offset:2048 lds
  v_mfma_f32_16x16x32_bf16 v[48:51], a[196:199], a[144:147], v[48:51]
  ds_read_b128 a[220:223], v11 offset:43264
  v_mfma_f32_16x16x32_bf16 v[52:55], a[196:199], a[148:151], v[52:55]
  v_mfma_f32_16x16x32_bf16 v[52:55], a[192:195], a[132:135], v[52:55]
  v_mfma_f32_16x16x32_bf16 v[56:59], a[192:195], a[136:139], v[56:59]
  v_mfma_f32_16x16x32_bf16 v[56:59], a[196:199], a[152:155], v[56:59]
  v_mfma_f32_16x16x32_bf16 v[60:63], a[196:199], a[156:159], v[60:63]
  v_mfma_f32_16x16x32_bf16 v[60:63], a[192:195], a[140:143], v[60:63]
  s_waitcnt lgkmcnt(4)
  v_mfma_f32_16x16x32_bf16 v[48:51], a[200:203], a[160:163], v[48:51]
  buffer_load_dwordx4 v3, s[16:19], s34 offen offset:3072 lds
  v_mfma_f32_16x16x32_bf16 v[48:51], a[204:207], a[176:179], v[48:51]
  v_mfma_f32_16x16x32_bf16 v[52:55], a[204:207], a[180:183], v[52:55]
  v_mfma_f32_16x16x32_bf16 v[52:55], a[200:203], a[164:167], v[52:55]
  v_mfma_f32_16x16x32_bf16 v[56:59], a[200:203], a[168:171], v[56:59]
  s_add_u32 s34, s34, 32768
  v_mfma_f32_16x16x32_bf16 v[56:59], a[204:207], a[184:187], v[56:59]
  v_mfma_f32_16x16x32_bf16 v[60:63], a[204:207], a[188:191], v[60:63]
  v_mfma_f32_16x16x32_bf16 v[60:63], a[200:203], a[172:175], v[60:63]
  s_waitcnt lgkmcnt(2)
  v_mfma_f32_16x16x32_bf16 v[48:51], a[208:211], a[0:3], v[48:51]
  v_mfma_f32_16x16x32_bf16 v[48:51], a[212:215], a[16:19], v[48:51]
  v_mfma_f32_16x16x32_bf16 v[52:55], a[212:215], a[20:23], v[52:55]
  v_mfma_f32_16x16x32_bf16 v[52:55], a[208:211], a[4:7], v[52:55]
  v_mfma_f32_16x16x32_bf16 v[56:59], a[208:211], a[8:11], v[56:59]
  v_mfma_f32_16x16x32_bf16 v[56:59], a[212:215], a[24:27], v[56:59]
  v_mfma_f32_16x16x32_bf16 v[60:63], a[212:215], a[28:31], v[60:63]
  v_mfma_f32_16x16x32_bf16 v[60:63], a[208:211], a[12:15], v[60:63]
  s_waitcnt lgkmcnt(0)
  v_mfma_f32_16x16x32_bf16 v[48:51], a[216:219], a[32:35], v[48:51]
  v_mfma_f32_16x16x32_bf16 v[48:51], a[220:223], a[48:51], v[48:51]
  v_mfma_f32_16x16x32_bf16 v[52:55], a[220:223], a[52:55], v[52:55]
  v_mfma_f32_16x16x32_bf16 v[52:55], a[216:219], a[36:39], v[52:55]
  v_mfma_f32_16x16x32_bf16 v[56:59], a[216:219], a[40:43], v[56:59]
  v_mfma_f32_16x16x32_bf16 v[56:59], a[220:223], a[56:59], v[56:59]
  v_mfma_f32_16x16x32_bf16 v[60:63], a[220:223], a[60:63], v[60:63]
  v_mfma_f32_16x16x32_bf16 v[60:63], a[216:219], a[44:47], v[60:63]
  v_bfe_u32 v6, v0, 1, 3
  v_lshlrev_b32 v6, 7, v6
  v_and_b32 v7, 1, v0
  v_lshl_add_u32 v6, v7, 6, v6
  v_add_u32 v6, v6, v14
  s_mov_b32 s90, 200000
  s_mov_b32 s40, s44
  buffer_load_dwordx4 v[128:131], v1, s[24:27], s40 offen sc1
  s_add_u32 s40, s40, 0x1000
  buffer_load_dwordx4 v[132:135], v1, s[24:27], s40 offen sc1
  s_add_u32 s40, s40, 0x1000
  buffer_load_dwordx4 v[136:139], v1, s[24:27], s40 offen sc1
  s_add_u32 s40, s40, 0x1000
  buffer_load_dwordx4 v[140:143], v1, s[24:27], s40 offen sc1
  s_add_u32 s40, s40, 0x1000
  buffer_load_dwordx4 v[144:147], v1, s[24:27], s40 offen sc1
  s_add_u32 s40, s40, 0x1000
  buffer_load_dwordx4 v[148:151], v1, s[24:27], s40 offen sc1
  s_add_u32 s40, s40, 0x1000
  buffer_load_dwordx4 v[152:155], v1, s[24:27], s40 offen sc1
  s_add_u32 s40, s40, 0x1000
  buffer_load_dwordx4 v[156:159], v1, s[24:27], s40 offen sc1
  buffer_load_dwordx4 v[160:163], v6, s[24:27], s45 offen sc1
  s_barrier
  s_add_u32 s34, s34, 0x8000
  v_pk_fma_f32 v[32:33], v[32:33], v[176:177], s[54:55] op_sel_hi:[1,0,1]
  v_pk_fma_f32 v[34:35], v[34:35], v[176:177], s[54:55] op_sel_hi:[1,0,1]
  v_pk_fma_f32 v[36:37], v[36:37], v[178:179], s[54:55] op_sel_hi:[1,0,1]
  v_pk_fma_f32 v[38:39], v[38:39], v[178:179], s[54:55] op_sel_hi:[1,0,1]
  v_pk_fma_f32 v[40:41], v[40:41], v[180:181], s[54:55] op_sel_hi:[1,0,1]
  v_pk_fma_f32 v[42:43], v[42:43], v[180:181], s[54:55] op_sel_hi:[1,0,1]
  v_pk_fma_f32 v[44:45], v[44:45], v[182:183], s[54:55] op_sel_hi:[1,0,1]
  v_pk_fma_f32 v[46:47], v[46:47], v[182:183], s[54:55] op_sel_hi:[1,0,1]
  s_add_u32 m0, s36, 32768
  s_nop 0
  buffer_load_dwordx4 v2, s[16:19], s34 offen offset:0 lds
  v_pk_fma_f32 v[48:49], v[48:49], v[176:177], s[54:55] op_sel_hi:[1,0,1]
  v_pk_fma_f32 v[50:51], v[50:51], v[176:177], s[54:55] op_sel_hi:[1,0,1]
  v_pk_fma_f32 v[52:53], v[52:53], v[178:179], s[54:55] op_sel_hi:[1,0,1]
  v_pk_fma_f32 v[54:55], v[54:55], v[178:179], s[54:55] op_sel_hi:[1,0,1]
  v_pk_fma_f32 v[56:57], v[56:57], v[180:181], s[54:55] op_sel_hi:[1,0,1]
  v_pk_fma_f32 v[58:59], v[58:59], v[180:181], s[54:55] op_sel_hi:[1,0,1]
  v_pk_fma_f32 v[60:61], v[60:61], v[182:183], s[54:55] op_sel_hi:[1,0,1]
  v_pk_fma_f32 v[62:63], v[62:63], v[182:183], s[54:55] op_sel_hi:[1,0,1]
  buffer_load_dwordx4 v2, s[16:19], s34 offen offset:1024 lds
  v_pk_mul_f32 v[224:225], v[32:33], s[52:53]
  v_pk_mul_f32 v[226:227], v[34:35], s[52:53]
  v_pk_mul_f32 v[228:229], v[36:37], s[52:53]
  v_pk_mul_f32 v[230:231], v[38:39], s[52:53]
  v_pk_mul_f32 v[232:233], v[40:41], s[52:53]
  v_pk_mul_f32 v[234:235], v[42:43], s[52:53]
  v_pk_mul_f32 v[236:237], v[44:45], s[52:53]
  buffer_load_dwordx4 v2, s[16:19], s34 offen offset:2048 lds
  v_pk_mul_f32 v[238:239], v[46:47], s[52:53]
  v_pk_mul_f32 v[240:241], v[48:49], s[52:53]
  v_pk_mul_f32 v[242:243], v[50:51], s[52:53]
  v_pk_mul_f32 v[244:245], v[52:53], s[52:53]
  v_pk_mul_f32 v[246:247], v[54:55], s[52:53]
  v_pk_mul_f32 v[248:249], v[56:57], s[52:53]
  v_pk_mul_f32 v[250:251], v[58:59], s[52:53]
  v_pk_mul_f32 v[252:253], v[60:61], s[52:53]
  buffer_load_dwordx4 v2, s[16:19], s34 offen offset:3072 lds
  v_pk_mul_f32 v[254:255], v[62:63], s[52:53]
  v_exp_f32 v224, v224 clamp
  v_exp_f32 v225, v225 clamp
  v_exp_f32 v226, v226 clamp
  v_exp_f32 v227, v227 clamp
  v_exp_f32 v228, v228 clamp
  v_exp_f32 v229, v229 clamp
  s_add_u32 m0, s36, 36864
  s_nop 0
  buffer_load_dwordx4 v3, s[16:19], s34 offen offset:0 lds
  v_exp_f32 v230, v230 clamp
  v_exp_f32 v231, v231 clamp
  v_exp_f32 v232, v232 clamp
  v_exp_f32 v233, v233 clamp
  v_exp_f32 v234, v234 clamp
  v_exp_f32 v235, v235 clamp
  v_exp_f32 v236, v236 clamp
  v_exp_f32 v237, v237 clamp
  buffer_load_dwordx4 v3, s[16:19], s34 offen offset:1024 lds
  v_exp_f32 v238, v238 clamp
  v_exp_f32 v239, v239 clamp
  v_exp_f32 v240, v240 clamp
  v_exp_f32 v241, v241 clamp
  v_exp_f32 v242, v242 clamp
  v_exp_f32 v243, v243 clamp
  v_exp_f32 v244, v244 clamp
  buffer_load_dwordx4 v3, s[16:19], s34 offen offset:2048 lds
  v_exp_f32 v245, v245 clamp
  v_exp_f32 v246, v246 clamp
  v_exp_f32 v247, v247 clamp
  v_exp_f32 v248, v248 clamp
  v_exp_f32 v249, v249 clamp
  v_exp_f32 v250, v250 clamp
  v_exp_f32 v251, v251 clamp
  v_exp_f32 v252, v252 clamp
  buffer_load_dwordx4 v3, s[16:19], s34 offen offset:3072 lds
  s_add_u32 s34, s34, 32768
  v_exp_f32 v253, v253 clamp
  v_exp_f32 v254, v254 clamp
  v_exp_f32 v255, v255 clamp
  v_max_f32 v32, 897988541, v32
  v_max_f32 v33, 897988541, v33
  v_max_f32 v34, 897988541, v34
  v_max_f32 v35, 897988541, v35
  s_add_u32 m0, s36, 0
  s_nop 0
  buffer_load_dwordx4 v2, s[16:19], s34 offen offset:0 lds
  v_max_f32 v36, 897988541, v36
  v_max_f32 v37, 897988541, v37
  v_max_f32 v38, 897988541, v38
  v_max_f32 v39, 897988541, v39
  v_max_f32 v40, 897988541, v40
  v_max_f32 v41, 897988541, v41
  v_max_f32 v42, 897988541, v42
  v_max_f32 v43, 897988541, v43
  buffer_load_dwordx4 v2, s[16:19], s34 offen offset:1024 lds
  v_max_f32 v44, 897988541, v44
  v_max_f32 v45, 897988541, v45
  v_max_f32 v46, 897988541, v46
  v_max_f32 v47, 897988541, v47
  v_max_f32 v48, 897988541, v48
  v_max_f32 v49, 897988541, v49
  v_max_f32 v50, 897988541, v50
  buffer_load_dwordx4 v2, s[16:19], s34 offen offset:2048 lds
  v_max_f32 v51, 897988541, v51
  v_max_f32 v52, 897988541, v52
  v_max_f32 v53, 897988541, v53
  v_max_f32 v54, 897988541, v54
  v_max_f32 v55, 897988541, v55
  v_max_f32 v56, 897988541, v56
  v_max_f32 v57, 897988541, v57
  v_max_f32 v58, 897988541, v58
  buffer_load_dwordx4 v2, s[16:19], s34 offen offset:3072 lds
  v_max_f32 v59, 897988541, v59
  v_max_f32 v60, 897988541, v60
  v_max_f32 v61, 897988541, v61
  v_max_f32 v62, 897988541, v62
  v_max_f32 v63, 897988541, v63
  v_pk_add_f32 v[32:33], v[32:33], v[224:225]
  v_pk_add_f32 v[34:35], v[34:35], v[226:227]
  s_add_u32 m0, s36, 4096
  s_nop 0
  buffer_load_dwordx4 v3, s[16:19], s34 offen offset:0 lds
  v_pk_add_f32 v[36:37], v[36:37], v[228:229]
  v_pk_add_f32 v[38:39], v[38:39], v[230:231]
  v_pk_add_f32 v[40:41], v[40:41], v[232:233]
  v_pk_add_f32 v[42:43], v[42:43], v[234:235]
  v_pk_add_f32 v[44:45], v[44:45], v[236:237]
  v_pk_add_f32 v[46:47], v[46:47], v[238:239]
  v_pk_add_f32 v[48:49], v[48:49], v[240:241]
  v_pk_add_f32 v[50:51], v[50:51], v[242:243]
  buffer_load_dwordx4 v3, s[16:19], s34 offen offset:1024 lds
  v_pk_add_f32 v[52:53], v[52:53], v[244:245]
  v_pk_add_f32 v[54:55], v[54:55], v[246:247]
  v_pk_add_f32 v[56:57], v[56:57], v[248:249]
  v_pk_add_f32 v[58:59], v[58:59], v[250:251]
  v_pk_add_f32 v[60:61], v[60:61], v[252:253]
  v_pk_add_f32 v[62:63], v[62:63], v[254:255]
  v_cvt_pk_bf16_f32 v64, v32, v33
  buffer_load_dwordx4 v3, s[16:19], s34 offen offset:2048 lds
  v_cvt_pk_bf16_f32 v65, v34, v35
  v_cvt_pk_bf16_f32 v66, v48, v49
  v_cvt_pk_bf16_f32 v67, v50, v51
  v_cvt_pk_bf16_f32 v68, v36, v37
  v_cvt_pk_bf16_f32 v69, v38, v39
  v_cvt_pk_bf16_f32 v70, v52, v53
  v_cvt_pk_bf16_f32 v71, v54, v55
  v_cvt_pk_bf16_f32 v72, v40, v41
  buffer_load_dwordx4 v3, s[16:19], s34 offen offset:3072 lds
  s_add_u32 s34, s34, 32768
  v_cvt_pk_bf16_f32 v73, v42, v43
  v_cvt_pk_bf16_f32 v74, v56, v57
  v_cvt_pk_bf16_f32 v75, v58, v59
  v_cvt_pk_bf16_f32 v76, v44, v45
  v_cvt_pk_bf16_f32 v77, v46, v47
  v_cvt_pk_bf16_f32 v78, v60, v61
  v_cvt_pk_bf16_f32 v79, v62, v63
  s_lshl_b32 s39, s31, 16
  s_lshl_b32 s40, s49, 11
  s_add_u32 s39, s39, s40
  s_lshl_b32 s40, s3, 21
  s_add_u32 s39, s39, s40
  s_add_u32 s39, s39, 16777216
  s_add_u32 s20, s6, s39
  s_addc_u32 s21, s7, 0
  s_mov_b32 s22, 67584
  s_mov_b32 s23, 0x20000
  s_and_b32 s39, s30, 1
  s_lshl_b32 s39, s39, 10
  s_lshr_b32 s41, s30, 1
  s_lshl_b32 s41, s41, 3
  s_add_u32 s39, s39, s41
  s_add_u32 s39, s39, 4096
  v_add_u32 v4, s39, v1
  v_add_u32 v5, 4096, v1
  s_waitcnt vmcnt(16)
kv_chk:
  v_pk_add_f32 v[128:129], v[128:129], v[132:133]
  v_pk_add_f32 v[130:131], v[130:131], v[134:135]
  v_pk_add_f32 v[128:129], v[128:129], v[136:137]
  v_pk_add_f32 v[130:131], v[130:131], v[138:139]
  v_pk_add_f32 v[128:129], v[128:129], v[140:141]
  v_pk_add_f32 v[130:131], v[130:131], v[142:143]
  v_pk_add_f32 v[128:129], v[128:129], v[144:145]
  v_pk_add_f32 v[130:131], v[130:131], v[146:147]
  v_pk_add_f32 v[128:129], v[128:129], v[148:149]
  v_pk_add_f32 v[130:131], v[130:131], v[150:151]
  v_pk_add_f32 v[128:129], v[128:129], v[152:153]
  v_pk_add_f32 v[130:131], v[130:131], v[154:155]
  v_pk_add_f32 v[128:129], v[128:129], v[156:157]
  v_pk_add_f32 v[130:131], v[130:131], v[158:159]
  v_pk_add_f32 v[132:133], v[128:129], v[130:131]
  v_pk_add_f32 v[134:135], v[160:161], v[162:163]
  v_pk_add_f32 v[132:133], v[132:133], v[134:135]
  v_cmp_u_f32 vcc, v132, v133
  s_nop 4
  s_cbranch_vccz kv_ok
  s_sub_u32 s90, s90, 64
  s_cbranch_scc1 kv_ok
  s_sleep 1
  s_mov_b32 s40, s44
  buffer_load_dwordx4 v[128:131], v1, s[24:27], s40 offen sc1
  s_add_u32 s40, s40, 0x1000
  buffer_load_dwordx4 v[132:135], v1, s[24:27], s40 offen sc1
  s_add_u32 s40, s40, 0x1000
  buffer_load_dwordx4 v[136:139], v1, s[24:27], s40 offen sc1
  s_add_u32 s40, s40, 0x1000
  buffer_load_dwordx4 v[140:143], v1, s[24:27], s40 offen sc1
  s_add_u32 s40, s40, 0x1000
  buffer_load_dwordx4 v[144:147], v1, s[24:27], s40 offen sc1
  s_add_u32 s40, s40, 0x1000
  buffer_load_dwordx4 v[148:151], v1, s[24:27], s40 offen sc1
  s_add_u32 s40, s40, 0x1000
  buffer_load_dwordx4 v[152:155], v1, s[24:27], s40 offen sc1
  s_add_u32 s40, s40, 0x1000
  buffer_load_dwordx4 v[156:159], v1, s[24:27], s40 offen sc1
  buffer_load_dwordx4 v[160:163], v6, s[24:27], s45 offen sc1
  s_waitcnt vmcnt(0)
  s_branch kv_chk
kv_ok:
  v_cvt_pk_bf16_f32 v128, v128, v129
  v_cvt_pk_bf16_f32 v129, v130, v131
  ds_write_b64 v4, v[128:129]
  s_lshl_b32 s39, s32, 16
  s_lshl_b32 s40, s51, 12
  s_add_u32 s39, s39, s40
  s_lshl_b32 s40, s3, 22
  s_add_u32 s39, s39, s40
  s_add_u32 s56, s6, s39
  s_addc_u32 s57, s7, 0
  s_mov_b32 s58, 4096
  s_mov_b32 s59, 0x20000
  buffer_load_dwordx4 v[80:83], v13, s[56:59], 0 offen offset:0
  buffer_load_dwordx4 v[84:87], v13, s[56:59], 0 offen offset:1024
  buffer_load_dwordx4 v[88:91], v13, s[56:59], 0 offen offset:2048
  buffer_load_dwordx4 v[92:95], v13, s[56:59], 0 offen offset:3072
  v_add_f32_dpp v160, v160, v160 row_ror:2 row_mask:0xf bank_mask:0xf
  v_add_f32_dpp v161, v161, v161 row_ror:2 row_mask:0xf bank_mask:0xf
  v_add_f32_dpp v162, v162, v162 row_ror:2 row_mask:0xf bank_mask:0xf
  v_add_f32_dpp v163, v163, v163 row_ror:2 row_mask:0xf bank_mask:0xf
  v_add_f32_dpp v160, v160, v160 row_ror:4 row_mask:0xf bank_mask:0xf
  v_add_f32_dpp v161, v161, v161 row_ror:4 row_mask:0xf bank_mask:0xf
  v_add_f32_dpp v162, v162, v162 row_ror:4 row_mask:0xf bank_mask:0xf
  v_add_f32_dpp v163, v163, v163 row_ror:4 row_mask:0xf bank_mask:0xf
  v_add_f32_dpp v160, v160, v160 row_ror:8 row_mask:0xf bank_mask:0xf
  v_add_f32_dpp v161, v161, v161 row_ror:8 row_mask:0xf bank_mask:0xf
  v_add_f32_dpp v162, v162, v162 row_ror:8 row_mask:0xf bank_mask:0xf
  v_add_f32_dpp v163, v163, v163 row_ror:8 row_mask:0xf bank_mask:0xf
  v_cvt_pk_bf16_f32 v164, v160, v161
  v_cvt_pk_bf16_f32 v165, v162, v163
  s_nop 0
  v_mov_b32_dpp v200, v164 quad_perm:[0,0,2,2] row_mask:0xf bank_mask:0xf
  v_mov_b32_dpp v201, v165 quad_perm:[0,0,2,2] row_mask:0xf bank_mask:0xf
  v_mov_b32_dpp v202, v164 quad_perm:[1,1,3,3] row_mask:0xf bank_mask:0xf
  v_mov_b32_dpp v203, v165 quad_perm:[1,1,3,3] row_mask:0xf bank_mask:0xf
  s_waitcnt lgkmcnt(0)
  s_barrier
  ds_read_b128 v[192:195], v5 offset:0
  ds_read_b128 v[196:199], v5 offset:1024
  s_mov_b32 s40, 0x10000
  v_mfma_f32_16x16x32_bf16 v[128:131], v[200:203], v[64:67], 0
  v_mfma_f32_16x16x32_bf16 v[132:135], v[200:203], v[68:71], 0
  v_mfma_f32_16x16x32_bf16 v[136:139], v[200:203], v[72:75], 0
  v_mfma_f32_16x16x32_bf16 v[140:143], v[200:203], v[76:79], 0
  s_waitcnt lgkmcnt(0)
  v_mfma_f32_16x16x32_bf16 v[144:147], v[192:195], v[64:67], 0
  v_mfma_f32_16x16x32_bf16 v[148:151], v[196:199], v[64:67], 0
  v_mfma_f32_16x16x32_bf16 v[152:155], v[192:195], v[68:71], 0
  v_mfma_f32_16x16x32_bf16 v[156:159], v[196:199], v[68:71], 0
  v_mfma_f32_16x16x32_bf16 v[160:163], v[192:195], v[72:75], 0
  v_mfma_f32_16x16x32_bf16 v[164:167], v[196:199], v[72:75], 0
  v_mfma_f32_16x16x32_bf16 v[168:171], v[192:195], v[76:79], 0
  v_mfma_f32_16x16x32_bf16 v[172:175], v[196:199], v[76:79], 0
  v_add_f32 v128, 897988541, v128
  v_add_f32 v132, 897988541, v132
  v_add_f32 v136, 897988541, v136
  v_add_f32 v140, 897988541, v140
  v_rcp_f32 v128, v128
  v_rcp_f32 v132, v132
  v_rcp_f32 v136, v136
  v_rcp_f32 v140, v140
  v_pk_mul_f32 v[144:145], v[144:145], v[128:129] op_sel_hi:[1,0]
  v_pk_mul_f32 v[146:147], v[146:147], v[128:129] op_sel_hi:[1,0]
  v_pk_mul_f32 v[148:149], v[148:149], v[128:129] op_sel_hi:[1,0]
  v_pk_mul_f32 v[150:151], v[150:151], v[128:129] op_sel_hi:[1,0]
  v_pk_mul_f32 v[152:153], v[152:153], v[132:133] op_sel_hi:[1,0]
  v_pk_mul_f32 v[154:155], v[154:155], v[132:133] op_sel_hi:[1,0]
  v_pk_mul_f32 v[156:157], v[156:157], v[132:133] op_sel_hi:[1,0]
  v_pk_mul_f32 v[158:159], v[158:159], v[132:133] op_sel_hi:[1,0]
  v_pk_mul_f32 v[160:161], v[160:161], v[136:137] op_sel_hi:[1,0]
  v_pk_mul_f32 v[162:163], v[162:163], v[136:137] op_sel_hi:[1,0]
  v_pk_mul_f32 v[164:165], v[164:165], v[136:137] op_sel_hi:[1,0]
  v_pk_mul_f32 v[166:167], v[166:167], v[136:137] op_sel_hi:[1,0]
  v_pk_mul_f32 v[168:169], v[168:169], v[140:141] op_sel_hi:[1,0]
  v_pk_mul_f32 v[170:171], v[170:171], v[140:141] op_sel_hi:[1,0]
  v_pk_mul_f32 v[172:173], v[172:173], v[140:141] op_sel_hi:[1,0]
  v_pk_mul_f32 v[174:175], v[174:175], v[140:141] op_sel_hi:[1,0]
  v_cvt_pk_bf16_f32 v144, v144, v145
  v_cvt_pk_bf16_f32 v145, v146, v147
  v_cvt_pk_bf16_f32 v146, v148, v149
  v_cvt_pk_bf16_f32 v147, v150, v151
  v_cvt_pk_bf16_f32 v152, v152, v153
  v_cvt_pk_bf16_f32 v153, v154, v155
  v_cvt_pk_bf16_f32 v154, v156, v157
  v_cvt_pk_bf16_f32 v155, v158, v159
  v_cvt_pk_bf16_f32 v160, v160, v161
  v_cvt_pk_bf16_f32 v161, v162, v163
  v_cvt_pk_bf16_f32 v162, v164, v165
  v_cvt_pk_bf16_f32 v163, v166, v167
  v_cvt_pk_bf16_f32 v168, v168, v169
  v_cvt_pk_bf16_f32 v169, v170, v171
  v_cvt_pk_bf16_f32 v170, v172, v173
  v_cvt_pk_bf16_f32 v171, v174, v175
  v_permlane32_swap_b32 v144, v146
  v_permlane32_swap_b32 v145, v147
  v_permlane32_swap_b32 v152, v154
  v_permlane32_swap_b32 v153, v155
  v_permlane32_swap_b32 v160, v162
  v_permlane32_swap_b32 v161, v163
  v_permlane32_swap_b32 v168, v170
  v_permlane32_swap_b32 v169, v171
  buffer_store_dwordx4 v[144:147], v12, s[20:23], 0 offen offset:0 sc1
  buffer_store_dwordx4 v[152:155], v12, s[20:23], 0 offen offset:256 sc1
  buffer_store_dwordx4 v[160:163], v12, s[20:23], s40 offen offset:0 sc1
  buffer_store_dwordx4 v[168:171], v12, s[20:23], s40 offen offset:256 sc1
  s_lshl_b32 s43, s48, 10
  s_and_b32 s41, s49, 3
  s_lshl_b32 s41, s41, 8
  s_add_u32 s43, s43, s41
  s_add_u32 s43, s43, 8192
  s_add_u32 s43, s43, s28
  s_mov_b32 s34, 0x8000
  s_add_u32 m0, s35, 0
  s_nop 0
  buffer_load_dwordx4 v2, s[16:19], s34 offen offset:0 lds
  buffer_load_dwordx4 v2, s[16:19], s34 offen offset:1024 lds
  buffer_load_dwordx4 v2, s[16:19], s34 offen offset:2048 lds
  buffer_load_dwordx4 v2, s[16:19], s34 offen offset:3072 lds
  s_add_u32 m0, s35, 4096
  s_nop 0
  buffer_load_dwordx4 v3, s[16:19], s34 offen offset:0 lds
  buffer_load_dwordx4 v3, s[16:19], s34 offen offset:1024 lds
  buffer_load_dwordx4 v3, s[16:19], s34 offen offset:2048 lds
  buffer_load_dwordx4 v3, s[16:19], s34 offen offset:3072 lds
  s_add_u32 s34, s34, 32768
  v_and_b32 v4, 15, v0
  v_lshlrev_b32 v4, 4, v4
  v_bfe_u32 v5, v0, 4, 1
  v_lshl_add_u32 v4, v5, 9, v4
  v_lshl_add_u32 v12, v15, 10, v4
  v_lshl_add_u32 v13, v15, 8, v4
  v_mul_u32_u24 v5, 2048, v15
  v_add_u32 v4, v4, v5
  v_add_u32 v10, 98304, v4
  v_add_u32 v11, 32768, v4
  s_lshl_b32 s39, s3, 21
  s_lshl_b32 s40, s32, 16
  s_add_u32 s39, s39, s40
  s_add_u32 s39, s39, 16777216
  s_add_u32 s8, s6, s39
  s_addc_u32 s9, s7, 0
  s_mov_b32 s10, 65536
  s_mov_b32 s11, 0x20000
  s_lshl_b32 s39, s32, 16
  s_lshl_b32 s40, s51, 12
  s_add_u32 s39, s39, s40
  s_lshl_b32 s40, s3, 22
  s_add_u32 s39, s39, s40
  s_add_u32 s39, s39, 4194304
  s_add_u32 s20, s6, s39
  s_addc_u32 s21, s7, 0
  s_mov_b32 s22, 4096
  s_mov_b32 s23, 0x20000
  s_waitcnt vmcnt(12)
  v_permlane32_swap_b32 v80, v82
  v_permlane32_swap_b32 v81, v83
  v_permlane32_swap_b32 v84, v86
  v_permlane32_swap_b32 v85, v87
  v_permlane32_swap_b32 v88, v90
  v_permlane32_swap_b32 v89, v91
  v_permlane32_swap_b32 v92, v94
  v_permlane32_swap_b32 v93, v95
  v_lshlrev_b32 v32, 16, v80
  v_and_b32 v33, 0xffff0000, v80
  v_lshlrev_b32 v34, 16, v81
  v_and_b32 v35, 0xffff0000, v81
  v_lshlrev_b32 v36, 16, v82
  v_and_b32 v37, 0xffff0000, v82
  v_lshlrev_b32 v38, 16, v83
  v_and_b32 v39, 0xffff0000, v83
  v_lshlrev_b32 v40, 16, v84
  v_and_b32 v41, 0xffff0000, v84
  v_lshlrev_b32 v42, 16, v85
  v_and_b32 v43, 0xffff0000, v85
  v_lshlrev_b32 v44, 16, v86
  v_and_b32 v45, 0xffff0000, v86
  v_lshlrev_b32 v46, 16, v87
  v_and_b32 v47, 0xffff0000, v87
  v_lshlrev_b32 v48, 16, v88
  v_and_b32 v49, 0xffff0000, v88
  v_lshlrev_b32 v50, 16, v89
  v_and_b32 v51, 0xffff0000, v89
  v_lshlrev_b32 v52, 16, v90
  v_and_b32 v53, 0xffff0000, v90
  v_lshlrev_b32 v54, 16, v91
  v_and_b32 v55, 0xffff0000, v91
  v_lshlrev_b32 v56, 16, v92
  v_and_b32 v57, 0xffff0000, v92
  v_lshlrev_b32 v58, 16, v93
  v_and_b32 v59, 0xffff0000, v93
  v_lshlrev_b32 v60, 16, v94
  v_and_b32 v61, 0xffff0000, v94
  v_lshlrev_b32 v62, 16, v95
  v_and_b32 v63, 0xffff0000, v95
  s_waitcnt vmcnt(8)
  s_barrier
  s_cmp_lg_u32 s30, 0
  s_cbranch_scc1 arr2
  v_mov_b32 v8, 0
  v_mov_b32 v9, 1
  s_mov_b64 exec, 1
  buffer_atomic_add v9, v8, s[24:27], s43 offen sc1
  s_mov_b64 exec, -1
arr2:
ph_g24:
  s_lshr_b32 s39, s50, 1
  s_lshl_b32 s39, s39, 10
  s_add_u32 s39, s39, 8192
  s_add_u32 s39, s39, s28
  s_add_u32 s44, s39, 8192
  s_cmp_lg_u32 s30, 0
  s_cbranch_scc1 wt3_go
  v_and_b32 v8, 3, v0
  v_lshlrev_b32 v8, 8, v8
  s_mov_b64 exec, 15
  s_mov_b32 s40, 200000
wt3_poll:
  buffer_load_dword v9, v8, s[24:27], s39 offen sc1
  s_waitcnt vmcnt(0)
  v_cmp_gt_u32 vcc, 8, v9
  s_nop 4
  s_cbranch_vccz wt3_ok
  s_sleep 1
  s_sub_u32 s40, s40, 1
  s_cmp_lg_u32 s40, 0
  s_cbranch_scc1 wt3_poll
wt3_ok:
  s_mov_b64 exec, -1
wt3_go:
  s_waitcnt vmcnt(0) lgkmcnt(0)
  s_barrier
  s_mov_b32 s33, 0
  buffer_load_dwordx4 a[0:3], v12, s[8:11], s33 offen offset:0
  buffer_load_dwordx4 a[4:7], v12, s[8:11], s33 offen offset:2048
  s_mov_b32 s33, 4096
  buffer_load_dwordx4 a[8:11], v12, s[8:11], s33 offen offset:0
  buffer_load_dwordx4 a[12:15], v12, s[8:11], s33 offen offset:2048
  s_mov_b32 s33, 8192
  buffer_load_dwordx4 a[16:19], v12, s[8:11], s33 offen offset:0
  buffer_load_dwordx4 a[20:23], v12, s[8:11], s33 offen offset:2048
  s_mov_b32 s33, 12288
  buffer_load_dwordx4 a[24:27], v12, s[8:11], s33 offen offset:0
  buffer_load_dwordx4 a[28:31], v12, s[8:11], s33 offen offset:2048
  s_mov_b32 s33, 16384
  buffer_load_dwordx4 a[32:35], v12, s[8:11], s33 offen offset:0
  buffer_load_dwordx4 a[36:39], v12, s[8:11], s33 offen offset:2048
  s_mov_b32 s33, 20480
  buffer_load_dwordx4 a[40:43], v12, s[8:11], s33 offen offset:0
  buffer_load_dwordx4 a[44:47], v12, s[8:11], s33 offen offset:2048
  ds_read_b128 a[64:67], v10 offset:32768
  ds_read_b128 a[68:71], v10 offset:36864
  ds_read_b128 a[72:75], v10 offset:33024
  ds_read_b128 a[76:79], v10 offset:37120
  ds_read_b128 a[80:83], v10 offset:33792
  ds_read_b128 a[84:87], v10 offset:37888
  ds_read_b128 a[88:91], v10 offset:34048
  ds_read_b128 a[92:95], v10 offset:38144
  ds_read_b128 a[96:99], v10 offset:40960
  ds_read_b128 a[100:103], v10 offset:45056
  ds_read_b128 a[104:107], v10 offset:41216
  ds_read_b128 a[108:111], v10 offset:45312
  v_and_b32 v24, 15, v0
  v_lshlrev_b32 v24, 2, v24
  v_lshl_add_u32 v24, v15, 13, v24
  v_mov_b32 v30, 0
  v_mov_b32 v31, 1
  s_add_u32 s3, s3, 1
  s_lshl_b32 s42, s3, 14
  s_lshl_b32 s40, s32, 7
  s_add_u32 s42, s42, s40
  s_lshr_b32 s43, s50, 1
  s_lshl_b32 s43, s43, 10
  s_and_b32 s41, s51, 3
  s_lshl_b32 s41, s41, 8
  s_add_u32 s43, s43, s41
  s_add_u32 s43, s43, 57344
  s_add_u32 s43, s43, s28
  s_waitcnt vmcnt(10) lgkmcnt(10)
  v_mfma_f32_16x16x32_bf16 v[32:35], a[64:67], a[0:3], v[32:35]
  ds_read_b128 a[112:115], v10 offset:41984
  v_mov_b32 v72, 0
  v_mfma_f32_16x16x32_bf16 v[32:35], a[68:71], a[4:7], v[32:35]
  ds_read_b128 a[116:119], v10 offset:46080
  s_mov_b32 s33, 24576
  buffer_load_dwordx4 a[48:51], v12, s[8:11], s33 offen offset:0
  v_mov_b32 v73, 0
  s_waitcnt lgkmcnt(10)
  v_mfma_f32_16x16x32_bf16 v[40:43], a[72:75], a[0:3], v[40:43]
  ds_read_b128 a[120:123], v10 offset:42240
  v_mov_b32 v74, 0
  v_mfma_f32_16x16x32_bf16 v[40:43], a[76:79], a[4:7], v[40:43]
  ds_read_b128 a[124:127], v10 offset:46336
  v_mov_b32 v75, 0
  s_waitcnt lgkmcnt(10)
  v_mfma_f32_16x16x32_bf16 v[48:51], a[80:83], a[0:3], v[48:51]
  ds_read_b128 a[64:67], v10 offset:49152
  v_mov_b32 v76, 0
  v_mfma_f32_16x16x32_bf16 v[48:51], a[84:87], a[4:7], v[48:51]
  ds_read_b128 a[68:71], v10 offset:53248
  buffer_load_dwordx4 a[52:55], v12, s[8:11], s33 offen offset:2048
  v_mov_b32 v77, 0
  s_waitcnt lgkmcnt(10)
  v_mfma_f32_16x16x32_bf16 v[56:59], a[88:91], a[0:3], v[56:59]
  ds_read_b128 a[72:75], v10 offset:49408
  v_mov_b32 v78, 0
  v_mfma_f32_16x16x32_bf16 v[56:59], a[92:95], a[4:7], v[56:59]
  ds_read_b128 a[76:79], v10 offset:53504
  v_mov_b32 v79, 0
  s_waitcnt vmcnt(10) lgkmcnt(10)
  v_mfma_f32_16x16x32_bf16 v[32:35], a[96:99], a[8:11], v[32:35]
  ds_read_b128 a[80:83], v10 offset:50176
  v_mov_b32 v80, 0
  v_mfma_f32_16x16x32_bf16 v[32:35], a[100:103], a[12:15], v[32:35]
  ds_read_b128 a[84:87], v10 offset:54272
  s_mov_b32 s33, 28672
  buffer_load_dwordx4 a[56:59], v12, s[8:11], s33 offen offset:0
  v_mov_b32 v81, 0
  s_waitcnt lgkmcnt(10)
  v_mfma_f32_16x16x32_bf16 v[40:43], a[104:107], a[8:11], v[40:43]
  ds_read_b128 a[88:91], v10 offset:50432
  v_mov_b32 v82, 0
  v_mfma_f32_16x16x32_bf16 v[40:43], a[108:111], a[12:15], v[40:43]
  ds_read_b128 a[92:95], v10 offset:54528
  v_mov_b32 v83, 0
  s_waitcnt lgkmcnt(10)
  v_mfma_f32_16x16x32_bf16 v[48:51], a[112:115], a[8:11], v[48:51]
  ds_read_b128 a[96:99], v10 offset:57344
  v_mov_b32 v84, 0
  v_mfma_f32_16x16x32_bf16 v[48:51], a[116:119], a[12:15], v[48:51]
  ds_read_b128 a[100:103], v10 offset:61440
  buffer_load_dwordx4 a[60:63], v12, s[8:11], s33 offen offset:2048
  v_mov_b32 v85, 0
  s_waitcnt lgkmcnt(10)
  v_mfma_f32_16x16x32_bf16 v[56:59], a[120:123], a[8:11], v[56:59]
  ds_read_b128 a[104:107], v10 offset:57600
  v_mov_b32 v86, 0
  v_mfma_f32_16x16x32_bf16 v[56:59], a[124:127], a[12:15], v[56:59]
  ds_read_b128 a[108:111], v10 offset:61696
  v_mov_b32 v87, 0
  s_waitcnt vmcnt(10) lgkmcnt(10)
  v_mfma_f32_16x16x32_bf16 v[32:35], a[64:67], a[16:19], v[32:35]
  ds_read_b128 a[112:115], v10 offset:58368
  v_mov_b32 v88, 0
  v_mfma_f32_16x16x32_bf16 v[32:35], a[68:71], a[20:23], v[32:35]
  ds_read_b128 a[116:119], v10 offset:62464
  s_mov_b32 s33, 32768
  buffer_load_dwordx4 a[0:3], v12, s[8:11], s33 offen offset:0
  v_mov_b32 v89, 0
  s_waitcnt lgkmcnt(10)
  v_mfma_f32_16x16x32_bf16 v[40:43], a[72:75], a[16:19], v[40:43]
  ds_read_b128 a[120:123], v10 offset:58624
  v_mov_b32 v90, 0
  v_mfma_f32_16x16x32_bf16 v[40:43], a[76:79], a[20:23], v[40:43]
  ds_read_b128 a[124:127], v10 offset:62720
  v_mov_b32 v91, 0
  s_waitcnt lgkmcnt(10)
  v_mfma_f32_16x16x32_bf16 v[48:51], a[80:83], a[16:19], v[48:51]
  ds_read_b128 a[64:67], v10 offset:0
  v_mov_b32 v92, 0
  v_mfma_f32_16x16x32_bf16 v[48:51], a[84:87], a[20:23], v[48:51]
  ds_read_b128 a[68:71], v10 offset:4096
  buffer_load_dwordx4 a[4:7], v12, s[8:11], s33 offen offset:2048
  v_mov_b32 v93, 0
  s_waitcnt lgkmcnt(10)
  v_mfma_f32_16x16x32_bf16 v[56:59], a[88:91], a[16:19], v[56:59]
  ds_read_b128 a[72:75], v10 offset:256
  v_mov_b32 v94, 0
  v_mfma_f32_16x16x32_bf16 v[56:59], a[92:95], a[20:23], v[56:59]
  ds_read_b128 a[76:79], v10 offset:4352
  v_mov_b32 v95, 0
  s_waitcnt vmcnt(10) lgkmcnt(10)
  v_mfma_f32_16x16x32_bf16 v[32:35], a[96:99], a[24:27], v[32:35]
  ds_read_b128 a[80:83], v10 offset:1024
  v_mov_b32 v96, 0
  v_mfma_f32_16x16x32_bf16 v[32:35], a[100:103], a[28:31], v[32:35]
  ds_read_b128 a[84:87], v10 offset:5120
  s_mov_b32 s33, 36864
  buffer_load_dwordx4 a[8:11], v12, s[8:11], s33 offen offset:0
  v_mov_b32 v97, 0
  s_waitcnt lgkmcnt(10)
  v_mfma_f32_16x16x32_bf16 v[40:43], a[104:107], a[24:27], v[40:43]
  ds_read_b128 a[88:91], v10 offset:1280
  v_mov_b32 v98, 0
  v_mfma_f32_16x16x32_bf16 v[40:43], a[108:111], a[28:31], v[40:43]
  ds_read_b128 a[92:95], v10 offset:5376
  v_mov_b32 v99, 0
  s_waitcnt lgkmcnt(10)
  v_mfma_f32_16x16x32_bf16 v[48:51], a[112:115], a[24:27], v[48:51]
  ds_read_b128 a[96:99], v10 offset:8192
  v_mov_b32 v100, 0
  v_mfma_f32_16x16x32_bf16 v[48:51], a[116:119], a[28:31], v[48:51]
  ds_read_b128 a[100:103], v10 offset:12288
  buffer_load_dwordx4 a[12:15], v12, s[8:11], s33 offen offset:2048
  v_mov_b32 v101, 0
  s_waitcnt lgkmcnt(10)
  v_mfma_f32_16x16x32_bf16 v[56:59], a[120:123], a[24:27], v[56:59]
  ds_read_b128 a[104:107], v10 offset:8448
  v_mov_b32 v102, 0
  v_mfma_f32_16x16x32_bf16 v[56:59], a[124:127], a[28:31], v[56:59]
  ds_read_b128 a[108:111], v10 offset:12544
  v_mov_b32 v103, 0
  s_waitcnt vmcnt(10) lgkmcnt(10)
  v_mfma_f32_16x16x32_bf16 v[32:35], a[64:67], a[32:35], v[32:35]
  ds_read_b128 a[112:115], v10 offset:9216
  v_mov_b32 v104, 0
  v_mfma_f32_16x16x32_bf16 v[32:35], a[68:71], a[36:39], v[32:35]
  ds_read_b128 a[116:119], v10 offset:13312
  s_mov_b32 s33, 40960
  buffer_load_dwordx4 a[16:19], v12, s[8:11], s33 offen offset:0
  v_mov_b32 v105, 0
  s_waitcnt lgkmcnt(10)
  v_mfma_f32_16x16x32_bf16 v[40:43], a[72:75], a[32:35], v[40:43]
  ds_read_b128 a[120:123], v10 offset:9472
  v_mov_b32 v106, 0
  v_mfma_f32_16x16x32_bf16 v[40:43], a[76:79], a[36:39], v[40:43]
  ds_read_b128 a[124:127], v10 offset:13568
  v_mov_b32 v107, 0
  s_waitcnt lgkmcnt(10)
  v_mfma_f32_16x16x32_bf16 v[48:51], a[80:83], a[32:35], v[48:51]
  ds_read_b128 a[64:67], v10 offset:16384
  v_mov_b32 v108, 0
  v_mfma_f32_16x16x32_bf16 v[48:51], a[84:87], a[36:39], v[48:51]
  ds_read_b128 a[68:71], v10 offset:20480
  buffer_load_dwordx4 a[20:23], v12, s[8:11], s33 offen offset:2048
  v_mov_b32 v109, 0
  s_waitcnt lgkmcnt(10)
  v_mfma_f32_16x16x32_bf16 v[56:59], a[88:91], a[32:35], v[56:59]
  ds_read_b128 a[72:75], v10 offset:16640
  v_mov_b32 v110, 0
  v_mfma_f32_16x16x32_bf16 v[56:59], a[92:95], a[36:39], v[56:59]
  ds_read_b128 a[76:79], v10 offset:20736
  v_mov_b32 v111, 0
  s_waitcnt vmcnt(10) lgkmcnt(10)
  v_mfma_f32_16x16x32_bf16 v[32:35], a[96:99], a[40:43], v[32:35]
  ds_read_b128 a[80:83], v10 offset:17408
  v_mov_b32 v112, 0
  v_mfma_f32_16x16x32_bf16 v[32:35], a[100:103], a[44:47], v[32:35]
  ds_read_b128 a[84:87], v10 offset:21504
  s_mov_b32 s33, 45056
  buffer_load_dwordx4 a[24:27], v12, s[8:11], s33 offen offset:0
  v_mov_b32 v113, 0
  s_waitcnt lgkmcnt(10)
  v_mfma_f32_16x16x32_bf16 v[40:43], a[104:107], a[40:43], v[40:43]
  ds_read_b128 a[88:91], v10 offset:17664
  v_mov_b32 v114, 0
  v_mfma_f32_16x16x32_bf16 v[40:43], a[108:111], a[44:47], v[40:43]
  ds_read_b128 a[92:95], v10 offset:21760
  v_mov_b32 v115, 0
  s_waitcnt lgkmcnt(10)
  v_mfma_f32_16x16x32_bf16 v[48:51], a[112:115], a[40:43], v[48:51]
  ds_read_b128 a[96:99], v10 offset:24576
  v_mov_b32 v116, 0
  v_mfma_f32_16x16x32_bf16 v[48:51], a[116:119], a[44:47], v[48:51]
  ds_read_b128 a[100:103], v10 offset:28672
  buffer_load_dwordx4 a[28:31], v12, s[8:11], s33 offen offset:2048
  v_mov_b32 v117, 0
  s_waitcnt lgkmcnt(10)
  v_mfma_f32_16x16x32_bf16 v[56:59], a[120:123], a[40:43], v[56:59]
  ds_read_b128 a[104:107], v10 offset:24832
  v_mov_b32 v118, 0
  v_mfma_f32_16x16x32_bf16 v[56:59], a[124:127], a[44:47], v[56:59]
  ds_read_b128 a[108:111], v10 offset:28928
  v_mov_b32 v119, 0
  s_waitcnt vmcnt(10) lgkmcnt(10)
  v_mfma_f32_16x16x32_bf16 v[32:35], a[64:67], a[48:51], v[32:35]
  ds_read_b128 a[112:115], v10 offset:25600
  v_mov_b32 v120, 0
  v_mfma_f32_16x16x32_bf16 v[32:35], a[68:71], a[52:55], v[32:35]
  ds_read_b128 a[116:119], v10 offset:29696
  s_mov_b32 s33, 49152
  buffer_load_dwordx4 a[32:35], v12, s[8:11], s33 offen offset:0
  v_mov_b32 v121, 0
  s_waitcnt lgkmcnt(10)
  v_mfma_f32_16x16x32_bf16 v[40:43], a[72:75], a[48:51], v[40:43]
  ds_read_b128 a[120:123], v10 offset:25856
  v_mov_b32 v122, 0
  v_mfma_f32_16x16x32_bf16 v[40:43], a[76:79], a[52:55], v[40:43]
  ds_read_b128 a[124:127], v10 offset:29952
  v_mov_b32 v123, 0
  s_waitcnt lgkmcnt(10)
  v_mfma_f32_16x16x32_bf16 v[48:51], a[80:83], a[48:51], v[48:51]
  ds_read_b128 a[64:67], v11 offset:32768
  v_mov_b32 v124, 0
  v_mfma_f32_16x16x32_bf16 v[48:51], a[84:87], a[52:55], v[48:51]
  ds_read_b128 a[68:71], v11 offset:36864
  buffer_load_dwordx4 a[36:39], v12, s[8:11], s33 offen offset:2048
  v_mov_b32 v125, 0
  s_waitcnt lgkmcnt(10)
  v_mfma_f32_16x16x32_bf16 v[56:59], a[88:91], a[48:51], v[56:59]
  ds_read_b128 a[72:75], v11 offset:33024
  v_mov_b32 v126, 0
  v_mfma_f32_16x16x32_bf16 v[56:59], a[92:95], a[52:55], v[56:59]
  ds_read_b128 a[76:79], v11 offset:37120
  v_mov_b32 v127, 0
  s_waitcnt vmcnt(10) lgkmcnt(10)
  v_mfma_f32_16x16x32_bf16 v[32:35], a[96:99], a[56:59], v[32:35]
  ds_read_b128 a[80:83], v11 offset:33792
  v_mov_b32 v128, 0
  v_mfma_f32_16x16x32_bf16 v[32:35], a[100:103], a[60:63], v[32:35]
  ds_read_b128 a[84:87], v11 offset:37888
  s_mov_b32 s33, 53248
  buffer_load_dwordx4 a[40:43], v12, s[8:11], s33 offen offset:0
  v_mov_b32 v129, 0
  s_waitcnt lgkmcnt(10)
  v_mfma_f32_16x16x32_bf16 v[40:43], a[104:107], a[56:59], v[40:43]
  ds_read_b128 a[88:91], v11 offset:34048
  v_mov_b32 v130, 0
  v_mfma_f32_16x16x32_bf16 v[40:43], a[108:111], a[60:63], v[40:43]
  ds_read_b128 a[92:95], v11 offset:38144
  v_mov_b32 v131, 0
  s_waitcnt lgkmcnt(10)
  v_mfma_f32_16x16x32_bf16 v[48:51], a[112:115], a[56:59], v[48:51]
  ds_read_b128 a[96:99], v11 offset:40960
  v_mov_b32 v132, 0
  v_mfma_f32_16x16x32_bf16 v[48:51], a[116:119], a[60:63], v[48:51]
  ds_read_b128 a[100:103], v11 offset:45056
  buffer_load_dwordx4 a[44:47], v12, s[8:11], s33 offen offset:2048
  v_mov_b32 v133, 0
  s_waitcnt lgkmcnt(10)
  v_mfma_f32_16x16x32_bf16 v[56:59], a[120:123], a[56:59], v[56:59]
  ds_read_b128 a[104:107], v11 offset:41216
  v_mov_b32 v134, 0
  v_mfma_f32_16x16x32_bf16 v[56:59], a[124:127], a[60:63], v[56:59]
  ds_read_b128 a[108:111], v11 offset:45312
  v_mov_b32 v135, 0
  s_waitcnt vmcnt(10) lgkmcnt(10)
  v_mfma_f32_16x16x32_bf16 v[32:35], a[64:67], a[0:3], v[32:35]
  ds_read_b128 a[112:115], v11 offset:41984
  v_mov_b32 v136, 0
  v_mfma_f32_16x16x32_bf16 v[32:35], a[68:71], a[4:7], v[32:35]
  ds_read_b128 a[116:119], v11 offset:46080
  s_mov_b32 s33, 57344
  buffer_load_dwordx4 a[48:51], v12, s[8:11], s33 offen offset:0
  v_mov_b32 v137, 0
  s_waitcnt lgkmcnt(10)
  v_mfma_f32_16x16x32_bf16 v[40:43], a[72:75], a[0:3], v[40:43]
  ds_read_b128 a[120:123], v11 offset:42240
  v_mov_b32 v138, 0
  v_mfma_f32_16x16x32_bf16 v[40:43], a[76:79], a[4:7], v[40:43]
  ds_read_b128 a[124:127], v11 offset:46336
  v_mov_b32 v139, 0
  s_waitcnt lgkmcnt(10)
  v_mfma_f32_16x16x32_bf16 v[48:51], a[80:83], a[0:3], v[48:51]
  ds_read_b128 a[64:67], v11 offset:49152
  v_mov_b32 v140, 0
  v_mfma_f32_16x16x32_bf16 v[48:51], a[84:87], a[4:7], v[48:51]
  ds_read_b128 a[68:71], v11 offset:53248
  buffer_load_dwordx4 a[52:55], v12, s[8:11], s33 offen offset:2048
  v_mov_b32 v141, 0
  s_waitcnt lgkmcnt(10)
  v_mfma_f32_16x16x32_bf16 v[56:59], a[88:91], a[0:3], v[56:59]
  ds_read_b128 a[72:75], v11 offset:49408
  v_lshlrev_b32 v25, 2, v0
  s_mul_i32 s39, s49, 896
  s_lshl_b32 s40, s30, 8
  s_add_u32 s39, s39, s40
  s_add_u32 s39, s39, 2646016
  buffer_load_dword v26, v25, s[24:27], s39 offen
  s_add_u32 s39, s39, 53248
  buffer_load_dword v27, v25, s[24:27], s39 offen
  s_add_u32 s39, s39, 53248
  buffer_load_dword v28, v25, s[24:27], s39 offen
  s_add_u32 s39, s39, 53248
  buffer_load_dword v29, v25, s[24:27], s39 offen
  v_mov_b32 v142, 0
  v_mfma_f32_16x16x32_bf16 v[56:59], a[92:95], a[4:7], v[56:59]
  ds_read_b128 a[76:79], v11 offset:53504
  v_mov_b32 v143, 0
  s_waitcnt vmcnt(14) lgkmcnt(10)
  v_mfma_f32_16x16x32_bf16 v[32:35], a[96:99], a[8:11], v[32:35]
  ds_read_b128 a[80:83], v11 offset:50176
  v_mov_b32 v144, 0
  v_mfma_f32_16x16x32_bf16 v[32:35], a[100:103], a[12:15], v[32:35]
  ds_read_b128 a[84:87], v11 offset:54272
  s_mov_b32 s33, 61440
  buffer_load_dwordx4 a[56:59], v12, s[8:11], s33 offen offset:0
  v_mov_b32 v145, 0
  s_waitcnt lgkmcnt(10)
  v_mfma_f32_16x16x32_bf16 v[40:43], a[104:107], a[8:11], v[40:43]
  ds_read_b128 a[88:91], v11 offset:50432
  v_mov_b32 v146, 0
  v_mfma_f32_16x16x32_bf16 v[40:43], a[108:111], a[12:15], v[40:43]
  ds_read_b128 a[92:95], v11 offset:54528
  v_mov_b32 v147, 0
  s_waitcnt lgkmcnt(10)
  v_mfma_f32_16x16x32_bf16 v[48:51], a[112:115], a[8:11], v[48:51]
  ds_read_b128 a[96:99], v11 offset:57344
  v_mov_b32 v148, 0
  v_mfma_f32_16x16x32_bf16 v[48:51], a[116:119], a[12:15], v[48:51]
  ds_read_b128 a[100:103], v11 offset:61440
  buffer_load_dwordx4 a[60:63], v12, s[8:11], s33 offen offset:2048
  v_mov_b32 v149, 0
  s_waitcnt lgkmcnt(10)
  v_mfma_f32_16x16x32_bf16 v[56:59], a[120:123], a[8:11], v[56:59]
  ds_read_b128 a[104:107], v11 offset:57600
  v_mov_b32 v150, 0
  v_mfma_f32_16x16x32_bf16 v[56:59], a[124:127], a[12:15], v[56:59]
  ds_read_b128 a[108:111], v11 offset:61696
  v_mov_b32 v151, 0
  s_waitcnt vmcnt(14) lgkmcnt(10)
  v_mfma_f32_16x16x32_bf16 v[32:35], a[64:67], a[16:19], v[32:35]
  ds_read_b128 a[112:115], v11 offset:58368
  v_mov_b32 v152, 0
  v_mfma_f32_16x16x32_bf16 v[32:35], a[68:71], a[20:23], v[32:35]
  ds_read_b128 a[116:119], v11 offset:62464
  s_mov_b32 s33, 49152
  buffer_load_dwordx4 a[0:3], v12, s[8:11], s33 offen offset:256
  v_mov_b32 v153, 0
  s_waitcnt lgkmcnt(10)
  v_mfma_f32_16x16x32_bf16 v[40:43], a[72:75], a[16:19], v[40:43]
  ds_read_b128 a[120:123], v11 offset:58624
  v_mov_b32 v154, 0
  v_mfma_f32_16x16x32_bf16 v[40:43], a[76:79], a[20:23], v[40:43]
  ds_read_b128 a[124:127], v11 offset:62720
  v_mov_b32 v155, 0
  s_waitcnt lgkmcnt(10)
  v_mfma_f32_16x16x32_bf16 v[48:51], a[80:83], a[16:19], v[48:51]
  ds_read_b128 a[64:67], v11 offset:0
  v_mov_b32 v156, 0
  v_mfma_f32_16x16x32_bf16 v[48:51], a[84:87], a[20:23], v[48:51]
  ds_read_b128 a[68:71], v11 offset:4096
  buffer_load_dwordx4 a[4:7], v12, s[8:11], s33 offen offset:2304
  v_mov_b32 v157, 0
  s_waitcnt lgkmcnt(10)
  v_mfma_f32_16x16x32_bf16 v[56:59], a[88:91], a[16:19], v[56:59]
  ds_read_b128 a[72:75], v11 offset:256
  v_mov_b32 v158, 0
  v_mfma_f32_16x16x32_bf16 v[56:59], a[92:95], a[20:23], v[56:59]
  ds_read_b128 a[76:79], v11 offset:4352
  v_mov_b32 v159, 0
  s_waitcnt vmcnt(14) lgkmcnt(10)
  v_mfma_f32_16x16x32_bf16 v[32:35], a[96:99], a[24:27], v[32:35]
  ds_read_b128 a[80:83], v11 offset:1024
  v_mov_b32 v160, 0
  v_mfma_f32_16x16x32_bf16 v[32:35], a[100:103], a[28:31], v[32:35]
  ds_read_b128 a[84:87], v11 offset:5120
  s_mov_b32 s33, 53248
  buffer_load_dwordx4 a[8:11], v12, s[8:11], s33 offen offset:256
  v_mov_b32 v161, 0
  s_waitcnt lgkmcnt(10)
  v_mfma_f32_16x16x32_bf16 v[40:43], a[104:107], a[24:27], v[40:43]
  ds_read_b128 a[88:91], v11 offset:1280
  v_mov_b32 v162, 0
  v_mfma_f32_16x16x32_bf16 v[40:43], a[108:111], a[28:31], v[40:43]
  ds_read_b128 a[92:95], v11 offset:5376
  v_mov_b32 v163, 0
  s_waitcnt lgkmcnt(10)
  v_mfma_f32_16x16x32_bf16 v[48:51], a[112:115], a[24:27], v[48:51]
  ds_read_b128 a[96:99], v11 offset:8192
  v_mov_b32 v164, 0
  v_mfma_f32_16x16x32_bf16 v[48:51], a[116:119], a[28:31], v[48:51]
  ds_read_b128 a[100:103], v11 offset:12288
  buffer_load_dwordx4 a[12:15], v12, s[8:11], s33 offen offset:2304
  v_mov_b32 v165, 0
  s_waitcnt lgkmcnt(10)
  v_mfma_f32_16x16x32_bf16 v[56:59], a[120:123], a[24:27], v[56:59]
  ds_read_b128 a[104:107], v11 offset:8448
  v_mov_b32 v166, 0
  v_mfma_f32_16x16x32_bf16 v[56:59], a[124:127], a[28:31], v[56:59]
  ds_read_b128 a[108:111], v11 offset:12544
  v_mov_b32 v167, 0
  s_waitcnt vmcnt(14) lgkmcnt(10)
  v_mfma_f32_16x16x32_bf16 v[32:35], a[64:67], a[32:35], v[32:35]
  ds_read_b128 a[112:115], v11 offset:9216
  v_mov_b32 v168, 0
  v_mfma_f32_16x16x32_bf16 v[32:35], a[68:71], a[36:39], v[32:35]
  ds_read_b128 a[116:119], v11 offset:13312
  s_mov_b32 s33, 57344
  buffer_load_dwordx4 a[16:19], v12, s[8:11], s33 offen offset:256
  v_mov_b32 v169, 0
  s_waitcnt lgkmcnt(10)
  v_mfma_f32_16x16x32_bf16 v[40:43], a[72:75], a[32:35], v[40:43]
  ds_read_b128 a[120:123], v11 offset:9472
  v_mov_b32 v170, 0
  v_mfma_f32_16x16x32_bf16 v[40:43], a[76:79], a[36:39], v[40:43]
  ds_read_b128 a[124:127], v11 offset:13568
  v_mov_b32 v171, 0
  s_waitcnt lgkmcnt(10)
  v_mfma_f32_16x16x32_bf16 v[48:51], a[80:83], a[32:35], v[48:51]
  ds_read_b128 a[64:67], v11 offset:16384
  v_mov_b32 v172, 0
  v_mfma_f32_16x16x32_bf16 v[48:51], a[84:87], a[36:39], v[48:51]
  ds_read_b128 a[68:71], v11 offset:20480
  buffer_load_dwordx4 a[20:23], v12, s[8:11], s33 offen offset:2304
  v_mov_b32 v173, 0
  s_waitcnt lgkmcnt(10)
  v_mfma_f32_16x16x32_bf16 v[56:59], a[88:91], a[32:35], v[56:59]
  ds_read_b128 a[72:75], v11 offset:16640
  v_mov_b32 v174, 0
  v_mfma_f32_16x16x32_bf16 v[56:59], a[92:95], a[36:39], v[56:59]
  ds_read_b128 a[76:79], v11 offset:20736
  v_mov_b32 v175, 0
  s_waitcnt vmcnt(14) lgkmcnt(10)
  v_mfma_f32_16x16x32_bf16 v[32:35], a[96:99], a[40:43], v[32:35]
  ds_read_b128 a[80:83], v11 offset:17408
  v_mov_b32 v176, 0
  v_mfma_f32_16x16x32_bf16 v[32:35], a[100:103], a[44:47], v[32:35]
  ds_read_b128 a[84:87], v11 offset:21504
  s_mov_b32 s33, 61440
  buffer_load_dwordx4 a[24:27], v12, s[8:11], s33 offen offset:256
  v_mov_b32 v177, 0
  s_waitcnt lgkmcnt(10)
  v_mfma_f32_16x16x32_bf16 v[40:43], a[104:107], a[40:43], v[40:43]
  ds_read_b128 a[88:91], v11 offset:17664
  v_mov_b32 v178, 0
  v_mfma_f32_16x16x32_bf16 v[40:43], a[108:111], a[44:47], v[40:43]
  ds_read_b128 a[92:95], v11 offset:21760
  v_mov_b32 v179, 0
  s_waitcnt lgkmcnt(10)
  v_mfma_f32_16x16x32_bf16 v[48:51], a[112:115], a[40:43], v[48:51]
  ds_read_b128 a[96:99], v11 offset:24576
  v_mov_b32 v180, 0
  v_mfma_f32_16x16x32_bf16 v[48:51], a[116:119], a[44:47], v[48:51]
  ds_read_b128 a[100:103], v11 offset:28672
  buffer_load_dwordx4 a[28:31], v12, s[8:11], s33 offen offset:2304
  v_mov_b32 v181, 0
  s_waitcnt lgkmcnt(10)
  v_mfma_f32_16x16x32_bf16 v[56:59], a[120:123], a[40:43], v[56:59]
  ds_read_b128 a[104:107], v11 offset:24832
  v_mov_b32 v182, 0
  v_mfma_f32_16x16x32_bf16 v[56:59], a[124:127], a[44:47], v[56:59]
  ds_read_b128 a[108:111], v11 offset:28928
  v_mov_b32 v183, 0
  s_waitcnt vmcnt(14) lgkmcnt(10)
  v_mfma_f32_16x16x32_bf16 v[32:35], a[64:67], a[48:51], v[32:35]
  ds_read_b128 a[112:115], v11 offset:25600
  v_mov_b32 v184, 0
  v_mfma_f32_16x16x32_bf16 v[32:35], a[68:71], a[52:55], v[32:35]
  ds_read_b128 a[116:119], v11 offset:29696
  s_mov_b32 s33, 32768
  buffer_load_dwordx4 a[32:35], v12, s[8:11], s33 offen offset:256
  v_mov_b32 v185, 0
  s_waitcnt lgkmcnt(10)
  v_mfma_f32_16x16x32_bf16 v[40:43], a[72:75], a[48:51], v[40:43]
  ds_read_b128 a[120:123], v11 offset:25856
  v_mov_b32 v186, 0
  v_mfma_f32_16x16x32_bf16 v[40:43], a[76:79], a[52:55], v[40:43]
  ds_read_b128 a[124:127], v11 offset:29952
  v_mov_b32 v187, 0
  s_waitcnt lgkmcnt(10)
  v_mfma_f32_16x16x32_bf16 v[48:51], a[80:83], a[48:51], v[48:51]
  ds_read_b128 a[64:67], v11 offset:0
  v_mov_b32 v188, 0
  v_mfma_f32_16x16x32_bf16 v[48:51], a[84:87], a[52:55], v[48:51]
  ds_read_b128 a[68:71], v11 offset:4096
  buffer_load_dwordx4 a[36:39], v12, s[8:11], s33 offen offset:2304
  v_mov_b32 v189, 0
  s_waitcnt lgkmcnt(10)
  v_mfma_f32_16x16x32_bf16 v[56:59], a[88:91], a[48:51], v[56:59]
  ds_read_b128 a[72:75], v11 offset:256
  v_mov_b32 v190, 0
  v_mfma_f32_16x16x32_bf16 v[56:59], a[92:95], a[52:55], v[56:59]
  ds_read_b128 a[76:79], v11 offset:4352
  v_mov_b32 v191, 0
  s_waitcnt vmcnt(10) lgkmcnt(10)
  v_mfma_f32_16x16x32_bf16 v[32:35], a[96:99], a[56:59], v[32:35]
  ds_read_b128 a[80:83], v11 offset:1024
  s_waitcnt vmcnt(12)
  v_add_f32 v26, v26, v27
  v_add_f32 v28, v28, v29
  v_add_f32 v26, v26, v28
  v_lshlrev_b32 v27, 2, v0
  s_lshl_b32 s39, s30, 8
  v_add_u32 v27, s39, v27
  ds_write_b32 v27, v26 offset:3072
  s_lshl_b32 s45, s48, 10
  s_add_u32 s45, s45, 57344
  s_add_u32 s45, s45, s28
  v_and_b32 v8, 3, v0
  v_lshlrev_b32 v8, 8, v8
  s_mov_b32 s90, 200000
  v_mov_b32 v192, 0
  v_mfma_f32_16x16x32_bf16 v[32:35], a[100:103], a[60:63], v[32:35]
  ds_read_b128 a[84:87], v11 offset:5120
  s_mov_b32 s33, 36864
  buffer_load_dwordx4 a[40:43], v12, s[8:11], s33 offen offset:256
  v_mov_b32 v193, 0
  s_waitcnt lgkmcnt(11)
  v_mfma_f32_16x16x32_bf16 v[40:43], a[104:107], a[56:59], v[40:43]
  ds_read_b128 a[88:91], v11 offset:1280
  v_mov_b32 v194, 0
  v_mfma_f32_16x16x32_bf16 v[40:43], a[108:111], a[60:63], v[40:43]
  ds_read_b128 a[92:95], v11 offset:5376
  v_mov_b32 v195, 0
  s_waitcnt lgkmcnt(11)
  v_mfma_f32_16x16x32_bf16 v[48:51], a[112:115], a[56:59], v[48:51]
  ds_read_b128 a[96:99], v11 offset:8192
  v_mov_b32 v196, 0
  v_mfma_f32_16x16x32_bf16 v[48:51], a[116:119], a[60:63], v[48:51]
  ds_read_b128 a[100:103], v11 offset:12288
  buffer_load_dwordx4 a[44:47], v12, s[8:11], s33 offen offset:2304
  v_mov_b32 v197, 0
  s_waitcnt lgkmcnt(11)
  v_mfma_f32_16x16x32_bf16 v[56:59], a[120:123], a[56:59], v[56:59]
  ds_read_b128 a[104:107], v11 offset:8448
  v_mov_b32 v198, 0
  v_mfma_f32_16x16x32_bf16 v[56:59], a[124:127], a[60:63], v[56:59]
  ds_read_b128 a[108:111], v11 offset:12544
  v_mov_b32 v199, 0
  s_waitcnt vmcnt(10) lgkmcnt(11)
  v_mfma_f32_16x16x32_bf16 v[36:39], a[64:67], a[0:3], v[36:39]
  ds_read_b128 a[112:115], v11 offset:9216
  v_mfma_f32_16x16x32_bf16 v[36:39], a[68:71], a[4:7], v[36:39]
  ds_read_b128 a[116:119], v11 offset:13312
  s_mov_b32 s33, 40960
  buffer_load_dwordx4 a[48:51], v12, s[8:11], s33 offen offset:256
  s_waitcnt lgkmcnt(11)
  v_mfma_f32_16x16x32_bf16 v[44:47], a[72:75], a[0:3], v[44:47]
  ds_read_b128 a[120:123], v11 offset:9472
  v_mfma_f32_16x16x32_bf16 v[44:47], a[76:79], a[4:7], v[44:47]
  ds_read_b128 a[124:127], v11 offset:13568
  s_waitcnt lgkmcnt(10)
  v_mfma_f32_16x16x32_bf16 v[52:55], a[80:83], a[0:3], v[52:55]
  ds_read_b128 a[64:67], v11 offset:16384
  v_mul_f32 v5, v32, v32
  v_add_f32 v4, v32, v33
  v_fmac_f32 v5, v33, v33
  v_mfma_f32_16x16x32_bf16 v[52:55], a[84:87], a[4:7], v[52:55]
  ds_read_b128 a[68:71], v11 offset:20480
  buffer_load_dwordx4 a[52:55], v12, s[8:11], s33 offen offset:2304
  v_fmac_f32 v5, v34, v34
  v_add_f32 v4, v4, v34
  v_fmac_f32 v5, v35, v35
  s_waitcnt lgkmcnt(10)
  v_mfma_f32_16x16x32_bf16 v[60:63], a[88:91], a[0:3], v[60:63]
  ds_read_b128 a[72:75], v11 offset:16640
  v_add_f32 v4, v4, v35
  v_fmac_f32 v5, v40, v40
  v_add_f32 v4, v4, v40
  v_mfma_f32_16x16x32_bf16 v[60:63], a[92:95], a[4:7], v[60:63]
  ds_read_b128 a[76:79], v11 offset:20736
  v_fmac_f32 v5, v41, v41
  v_add_f32 v4, v4, v41
  v_fmac_f32 v5, v42, v42
  s_waitcnt vmcnt(10) lgkmcnt(10)
  v_mfma_f32_16x16x32_bf16 v[36:39], a[96:99], a[8:11], v[36:39]
  ds_read_b128 a[80:83], v11 offset:17408
  v_add_f32 v4, v4, v42
  v_fmac_f32 v5, v43, v43
  v_add_f32 v4, v4, v43
  v_mfma_f32_16x16x32_bf16 v[36:39], a[100:103], a[12:15], v[36:39]
  ds_read_b128 a[84:87], v11 offset:21504
  s_mov_b32 s33, 45056
  buffer_load_dwordx4 a[56:59], v12, s[8:11], s33 offen offset:256
  v_fmac_f32 v5, v48, v48
  v_add_f32 v4, v4, v48
  v_fmac_f32 v5, v49, v49
  s_waitcnt lgkmcnt(10)
  v_mfma_f32_16x16x32_bf16 v[44:47], a[104:107], a[8:11], v[44:47]
  ds_read_b128 a[88:91], v11 offset:17664
  v_add_f32 v4, v4, v49
  v_fmac_f32 v5, v50, v50
  v_add_f32 v4, v4, v50
  v_mfma_f32_16x16x32_bf16 v[44:47], a[108:111], a[12:15], v[44:47]
  ds_read_b128 a[92:95], v11 offset:21760
  v_fmac_f32 v5, v51, v51
  v_add_f32 v4, v4, v51
  v_fmac_f32 v5, v56, v56
  s_waitcnt lgkmcnt(10)
  v_mfma_f32_16x16x32_bf16 v[52:55], a[112:115], a[8:11], v[52:55]
  ds_read_b128 a[96:99], v11 offset:24576
  v_add_f32 v4, v4, v56
  v_fmac_f32 v5, v57, v57
  v_add_f32 v4, v4, v57
  v_mfma_f32_16x16x32_bf16 v[52:55], a[116:119], a[12:15], v[52:55]
  ds_read_b128 a[100:103], v11 offset:28672
  buffer_load_dwordx4 a[60:63], v12, s[8:11], s33 offen offset:2304
  v_fmac_f32 v5, v58, v58
  v_add_f32 v4, v4, v58
  v_fmac_f32 v5, v59, v59
  s_waitcnt lgkmcnt(10)
  v_mfma_f32_16x16x32_bf16 v[60:63], a[120:123], a[8:11], v[60:63]
  ds_read_b128 a[104:107], v11 offset:24832
  v_add_f32 v4, v4, v59
  s_nop 1
  v_permlane32_swap_b32 v4, v5
  v_add_f32 v4, v4, v5
  v_mfma_f32_16x16x32_bf16 v[60:63], a[124:127], a[12:15], v[60:63]
  ds_read_b128 a[108:111], v11 offset:28928
  v_mov_b32 v5, v4
  s_nop 1
  v_permlane16_swap_b32 v4, v5
  v_add_f32 v6, v4, v5
  s_waitcnt vmcnt(10) lgkmcnt(10)
  v_mfma_f32_16x16x32_bf16 v[36:39], a[64:67], a[16:19], v[36:39]
  ds_read_b128 a[112:115], v11 offset:25600
  s_mov_b32 exec_lo, 0xffff
  s_mov_b32 exec_hi, 0xffff
  buffer_atomic_add_f32 v6, v24, s[24:27], s42 offen offset:0 sc1
  s_mov_b64 exec, -1
  v_cvt_pk_bf16_f32 v16, v32, v33
  v_cvt_pk_bf16_f32 v17, v34, v35
  v_mfma_f32_16x16x32_bf16 v[36:39], a[68:71], a[20:23], v[36:39]
  ds_read_b128 a[116:119], v11 offset:29696
  s_mov_b32 s33, 16384
  buffer_load_dwordx4 a[0:3], v12, s[8:11], s33 offen offset:256
  v_cvt_pk_bf16_f32 v18, v40, v41
  v_cvt_pk_bf16_f32 v19, v42, v43
  v_cvt_pk_bf16_f32 v20, v48, v49
  s_waitcnt lgkmcnt(10)
  v_mfma_f32_16x16x32_bf16 v[44:47], a[72:75], a[16:19], v[44:47]
  ds_read_b128 a[120:123], v11 offset:25856
  v_cvt_pk_bf16_f32 v21, v50, v51
  v_cvt_pk_bf16_f32 v22, v56, v57
  v_cvt_pk_bf16_f32 v23, v58, v59
  v_mfma_f32_16x16x32_bf16 v[44:47], a[76:79], a[20:23], v[44:47]
  ds_read_b128 a[124:127], v11 offset:29952
  v_permlane32_swap_b32 v16, v18
  v_permlane32_swap_b32 v17, v19
  v_permlane32_swap_b32 v20, v22
  s_waitcnt lgkmcnt(10)
  v_mfma_f32_16x16x32_bf16 v[52:55], a[80:83], a[16:19], v[52:55]
  ds_read_b128 a[64:67], v11 offset:32768
  v_permlane32_swap_b32 v21, v23
  buffer_store_dwordx4 v[16:19], v12, s[20:23], 0 offen offset:0 sc1
  buffer_store_dwordx4 v[20:23], v12, s[20:23], 0 offen offset:2048 sc1
  v_mfma_f32_16x16x32_bf16 v[52:55], a[84:87], a[20:23], v[52:55]
  ds_read_b128 a[68:71], v11 offset:36864
  buffer_load_dwordx4 a[4:7], v12, s[8:11], s33 offen offset:2304
  v_mov_b32 v200, 0
  s_waitcnt lgkmcnt(10)
  v_mfma_f32_16x16x32_bf16 v[60:63], a[88:91], a[16:19], v[60:63]
  ds_read_b128 a[72:75], v11 offset:33024
  v_mov_b32 v201, 0
  v_mfma_f32_16x16x32_bf16 v[60:63], a[92:95], a[20:23], v[60:63]
  ds_read_b128 a[76:79], v11 offset:37120
  v_mov_b32 v202, 0
  s_waitcnt vmcnt(13) lgkmcnt(10)
  v_mfma_f32_16x16x32_bf16 v[36:39], a[96:99], a[24:27], v[36:39]
  ds_read_b128 a[80:83], v11 offset:33792
  v_mov_b32 v203, 0
  v_mfma_f32_16x16x32_bf16 v[36:39], a[100:103], a[28:31], v[36:39]
  ds_read_b128 a[84:87], v11 offset:37888
  s_mov_b32 s33, 20480
  buffer_load_dwordx4 a[8:11], v12, s[8:11], s33 offen offset:256
  v_mov_b32 v204, 0
  s_waitcnt lgkmcnt(10)
  v_mfma_f32_16x16x32_bf16 v[44:47], a[104:107], a[24:27], v[44:47]
  ds_read_b128 a[88:91], v11 offset:34048
  v_mov_b32 v205, 0
  v_mfma_f32_16x16x32_bf16 v[44:47], a[108:111], a[28:31], v[44:47]
  ds_read_b128 a[92:95], v11 offset:38144
  v_mov_b32 v206, 0
  s_waitcnt lgkmcnt(10)
  v_mfma_f32_16x16x32_bf16 v[52:55], a[112:115], a[24:27], v[52:55]
  ds_read_b128 a[96:99], v11 offset:40960
  v_mov_b32 v207, 0
  v_mfma_f32_16x16x32_bf16 v[52:55], a[116:119], a[28:31], v[52:55]
  ds_read_b128 a[100:103], v11 offset:45056
  buffer_load_dwordx4 a[12:15], v12, s[8:11], s33 offen offset:2304
  v_mov_b32 v208, 0
  s_waitcnt lgkmcnt(10)
  v_mfma_f32_16x16x32_bf16 v[60:63], a[120:123], a[24:27], v[60:63]
  ds_read_b128 a[104:107], v11 offset:41216
  v_mov_b32 v209, 0
  v_mfma_f32_16x16x32_bf16 v[60:63], a[124:127], a[28:31], v[60:63]
  ds_read_b128 a[108:111], v11 offset:45312
  v_mov_b32 v210, 0
  s_waitcnt vmcnt(13) lgkmcnt(10)
  v_mfma_f32_16x16x32_bf16 v[36:39], a[64:67], a[32:35], v[36:39]
  ds_read_b128 a[112:115], v11 offset:41984
  v_mov_b32 v211, 0
  v_mfma_f32_16x16x32_bf16 v[36:39], a[68:71], a[36:39], v[36:39]
  ds_read_b128 a[116:119], v11 offset:46080
  s_mov_b32 s33, 24576
  buffer_load_dwordx4 a[16:19], v12, s[8:11], s33 offen offset:256
  v_mov_b32 v212, 0
  s_waitcnt lgkmcnt(10)
  v_mfma_f32_16x16x32_bf16 v[44:47], a[72:75], a[32:35], v[44:47]
  ds_read_b128 a[120:123], v11 offset:42240
  v_mov_b32 v213, 0
  v_mfma_f32_16x16x32_bf16 v[44:47], a[76:79], a[36:39], v[44:47]
  ds_read_b128 a[124:127], v11 offset:46336
  v_mov_b32 v214, 0
  s_waitcnt lgkmcnt(10)
  v_mfma_f32_16x16x32_bf16 v[52:55], a[80:83], a[32:35], v[52:55]
  ds_read_b128 a[64:67], v11 offset:49152
  v_mov_b32 v215, 0
  v_mfma_f32_16x16x32_bf16 v[52:55], a[84:87], a[36:39], v[52:55]
  ds_read_b128 a[68:71], v11 offset:53248
  buffer_load_dwordx4 a[20:23], v12, s[8:11], s33 offen offset:2304
  v_mov_b32 v216, 0
  s_waitcnt lgkmcnt(10)
  v_mfma_f32_16x16x32_bf16 v[60:63], a[88:91], a[32:35], v[60:63]
  ds_read_b128 a[72:75], v11 offset:49408
  v_mov_b32 v217, 0
  v_mfma_f32_16x16x32_bf16 v[60:63], a[92:95], a[36:39], v[60:63]
  ds_read_b128 a[76:79], v11 offset:53504
  v_mov_b32 v218, 0
  s_waitcnt vmcnt(13) lgkmcnt(10)
  v_mfma_f32_16x16x32_bf16 v[36:39], a[96:99], a[40:43], v[36:39]
  ds_read_b128 a[80:83], v11 offset:50176
  v_mov_b32 v219, 0
  v_mfma_f32_16x16x32_bf16 v[36:39], a[100:103], a[44:47], v[36:39]
  ds_read_b128 a[84:87], v11 offset:54272
  s_mov_b32 s33, 28672
  buffer_load_dwordx4 a[24:27], v12, s[8:11], s33 offen offset:256
  v_mov_b32 v220, 0
  s_waitcnt lgkmcnt(10)
  v_mfma_f32_16x16x32_bf16 v[44:47], a[104:107], a[40:43], v[44:47]
  ds_read_b128 a[88:91], v11 offset:50432
  v_mov_b32 v221, 0
  v_mfma_f32_16x16x32_bf16 v[44:47], a[108:111], a[44:47], v[44:47]
  ds_read_b128 a[92:95], v11 offset:54528
  v_mov_b32 v222, 0
  s_waitcnt lgkmcnt(10)
  v_mfma_f32_16x16x32_bf16 v[52:55], a[112:115], a[40:43], v[52:55]
  ds_read_b128 a[96:99], v11 offset:57344
  v_mov_b32 v223, 0
  v_mfma_f32_16x16x32_bf16 v[52:55], a[116:119], a[44:47], v[52:55]
  ds_read_b128 a[100:103], v11 offset:61440
  buffer_load_dwordx4 a[28:31], v12, s[8:11], s33 offen offset:2304
  v_mov_b32 v224, 0
  s_waitcnt lgkmcnt(10)
  v_mfma_f32_16x16x32_bf16 v[60:63], a[120:123], a[40:43], v[60:63]
  ds_read_b128 a[104:107], v11 offset:57600
  v_mov_b32 v225, 0
  v_mfma_f32_16x16x32_bf16 v[60:63], a[124:127], a[44:47], v[60:63]
  ds_read_b128 a[108:111], v11 offset:61696
  v_mov_b32 v226, 0
  s_waitcnt vmcnt(13) lgkmcnt(10)
  v_mfma_f32_16x16x32_bf16 v[36:39], a[64:67], a[48:51], v[36:39]
  ds_read_b128 a[112:115], v11 offset:58368
  v_mov_b32 v227, 0
  v_mfma_f32_16x16x32_bf16 v[36:39], a[68:71], a[52:55], v[36:39]
  ds_read_b128 a[116:119], v11 offset:62464
  s_mov_b32 s33, 0
  buffer_load_dwordx4 a[32:35], v12, s[8:11], s33 offen offset:256
  v_mov_b32 v228, 0
  s_waitcnt lgkmcnt(10)
  v_mfma_f32_16x16x32_bf16 v[44:47], a[72:75], a[48:51], v[44:47]
  ds_read_b128 a[120:123], v11 offset:58624
  v_mov_b32 v229, 0
  v_mfma_f32_16x16x32_bf16 v[44:47], a[76:79], a[52:55], v[44:47]
  ds_read_b128 a[124:127], v11 offset:62720
  v_mov_b32 v230, 0
  s_waitcnt lgkmcnt(10)
  v_mfma_f32_16x16x32_bf16 v[52:55], a[80:83], a[48:51], v[52:55]
  ds_read_b128 a[64:67], v10 offset:0
  v_mov_b32 v231, 0
  v_mfma_f32_16x16x32_bf16 v[52:55], a[84:87], a[52:55], v[52:55]
  ds_read_b128 a[68:71], v10 offset:4096
  buffer_load_dwordx4 a[36:39], v12, s[8:11], s33 offen offset:2304
  v_mov_b32 v232, 0
  s_waitcnt lgkmcnt(10)
  v_mfma_f32_16x16x32_bf16 v[60:63], a[88:91], a[48:51], v[60:63]
  ds_read_b128 a[72:75], v10 offset:256
  v_mov_b32 v233, 0
  v_mfma_f32_16x16x32_bf16 v[60:63], a[92:95], a[52:55], v[60:63]
  ds_read_b128 a[76:79], v10 offset:4352
  v_mov_b32 v234, 0
  s_waitcnt vmcnt(13) lgkmcnt(10)
  v_mfma_f32_16x16x32_bf16 v[36:39], a[96:99], a[56:59], v[36:39]
  ds_read_b128 a[80:83], v10 offset:1024
  v_mov_b32 v235, 0
  v_mfma_f32_16x16x32_bf16 v[36:39], a[100:103], a[60:63], v[36:39]
  ds_read_b128 a[84:87], v10 offset:5120
  s_mov_b32 s33, 4096
  buffer_load_dwordx4 a[40:43], v12, s[8:11], s33 offen offset:256
  v_mov_b32 v236, 0
  s_waitcnt lgkmcnt(10)
  v_mfma_f32_16x16x32_bf16 v[44:47], a[104:107], a[56:59], v[44:47]
  ds_read_b128 a[88:91], v10 offset:1280
  v_mov_b32 v237, 0
  v_mfma_f32_16x16x32_bf16 v[44:47], a[108:111], a[60:63], v[44:47]
  ds_read_b128 a[92:95], v10 offset:5376
  v_mov_b32 v238, 0
  s_waitcnt lgkmcnt(10)
  v_mfma_f32_16x16x32_bf16 v[52:55], a[112:115], a[56:59], v[52:55]
  ds_read_b128 a[96:99], v10 offset:8192
  v_mov_b32 v239, 0
  s_waitcnt vmcnt(10)
  s_barrier
  s_cmp_lg_u32 s30, 0
  s_cbranch_scc1 xa_skip
  s_mov_b64 exec, 1
  buffer_atomic_add v31, v30, s[24:27], s43 offen sc1
  s_mov_b64 exec, -1
xa_skip:
  v_mfma_f32_16x16x32_bf16 v[52:55], a[116:119], a[60:63], v[52:55]
  ds_read_b128 a[100:103], v10 offset:12288
  buffer_load_dwordx4 a[44:47], v12, s[8:11], s33 offen offset:2304
  v_mov_b32 v240, 0
  s_waitcnt lgkmcnt(10)
  v_mfma_f32_16x16x32_bf16 v[60:63], a[120:123], a[56:59], v[60:63]
  ds_read_b128 a[104:107], v10 offset:8448
  v_mov_b32 v241, 0
  v_mfma_f32_16x16x32_bf16 v[60:63], a[124:127], a[60:63], v[60:63]
  ds_read_b128 a[108:111], v10 offset:12544
  v_mov_b32 v242, 0
  s_waitcnt vmcnt(10) lgkmcnt(10)
  v_mfma_f32_16x16x32_bf16 v[36:39], a[64:67], a[0:3], v[36:39]
  ds_read_b128 a[112:115], v10 offset:9216
  v_mov_b32 v243, 0
  v_mfma_f32_16x16x32_bf16 v[36:39], a[68:71], a[4:7], v[36:39]
  ds_read_b128 a[116:119], v10 offset:13312
  s_mov_b32 s33, 8192
  buffer_load_dwordx4 a[48:51], v12, s[8:11], s33 offen offset:256
  v_mov_b32 v244, 0
  s_waitcnt lgkmcnt(10)
  v_mfma_f32_16x16x32_bf16 v[44:47], a[72:75], a[0:3], v[44:47]
  ds_read_b128 a[120:123], v10 offset:9472
  v_mov_b32 v245, 0
  v_mfma_f32_16x16x32_bf16 v[44:47], a[76:79], a[4:7], v[44:47]
  ds_read_b128 a[124:127], v10 offset:13568
  v_mov_b32 v246, 0
  s_waitcnt lgkmcnt(10)
  v_mfma_f32_16x16x32_bf16 v[52:55], a[80:83], a[0:3], v[52:55]
  ds_read_b128 a[64:67], v10 offset:16384
  v_mov_b32 v247, 0
  v_mfma_f32_16x16x32_bf16 v[52:55], a[84:87], a[4:7], v[52:55]
  ds_read_b128 a[68:71], v10 offset:20480
  buffer_load_dwordx4 a[52:55], v12, s[8:11], s33 offen offset:2304
  v_mov_b32 v248, 0
  s_waitcnt lgkmcnt(10)
  v_mfma_f32_16x16x32_bf16 v[60:63], a[88:91], a[0:3], v[60:63]
  ds_read_b128 a[72:75], v10 offset:16640
  v_mov_b32 v249, 0
  v_mfma_f32_16x16x32_bf16 v[60:63], a[92:95], a[4:7], v[60:63]
  ds_read_b128 a[76:79], v10 offset:20736
  v_mov_b32 v250, 0
  s_waitcnt vmcnt(10) lgkmcnt(10)
  v_mfma_f32_16x16x32_bf16 v[36:39], a[96:99], a[8:11], v[36:39]
  ds_read_b128 a[80:83], v10 offset:17408
  v_mov_b32 v251, 0
  v_mfma_f32_16x16x32_bf16 v[36:39], a[100:103], a[12:15], v[36:39]
  ds_read_b128 a[84:87], v10 offset:21504
  s_mov_b32 s33, 12288
  buffer_load_dwordx4 a[56:59], v12, s[8:11], s33 offen offset:256
  v_mov_b32 v252, 0
  s_waitcnt lgkmcnt(10)
  v_mfma_f32_16x16x32_bf16 v[44:47], a[104:107], a[8:11], v[44:47]
  ds_read_b128 a[88:91], v10 offset:17664
  v_mov_b32 v253, 0
  v_mfma_f32_16x16x32_bf16 v[44:47], a[108:111], a[12:15], v[44:47]
  ds_read_b128 a[92:95], v10 offset:21760
  v_mov_b32 v254, 0
  s_waitcnt lgkmcnt(10)
  v_mfma_f32_16x16x32_bf16 v[52:55], a[112:115], a[8:11], v[52:55]
  ds_read_b128 a[96:99], v10 offset:24576
  v_mov_b32 v255, 0
  v_mfma_f32_16x16x32_bf16 v[52:55], a[116:119], a[12:15], v[52:55]
  ds_read_b128 a[100:103], v10 offset:28672
  buffer_load_dwordx4 a[60:63], v12, s[8:11], s33 offen offset:2304
  s_waitcnt lgkmcnt(10)
  v_mfma_f32_16x16x32_bf16 v[60:63], a[120:123], a[8:11], v[60:63]
  ds_read_b128 a[104:107], v10 offset:24832
  v_mfma_f32_16x16x32_bf16 v[60:63], a[124:127], a[12:15], v[60:63]
  ds_read_b128 a[108:111], v10 offset:28928
  s_waitcnt vmcnt(10) lgkmcnt(10)
  v_mfma_f32_16x16x32_bf16 v[36:39], a[64:67], a[16:19], v[36:39]
  ds_read_b128 a[112:115], v10 offset:25600
  v_mfma_f32_16x16x32_bf16 v[36:39], a[68:71], a[20:23], v[36:39]
  ds_read_b128 a[116:119], v10 offset:29696
  s_mul_i32 s39, s49, 458752
  s_add_u32 s39, s39, 41943040
  s_add_u32 s16, s6, s39
  s_addc_u32 s17, s7, 0
  s_mov_b32 s18, 458752
  s_mov_b32 s19, 0x20000
  s_mul_i32 s39, s30, 7168
  v_add_u32 v2, s39, v1
  v_add_u32 v3, 0x1000, v2
  s_add_u32 s35, s39, 4096
  s_add_u32 s36, s39, 61440
  s_mov_b32 s37, 57344
  s_mov_b32 s33, 0
  s_mov_b32 s34, 0
  s_add_u32 m0, s35, 0
  s_nop 0
  buffer_load_dwordx4 v2, s[16:19], s34 offen offset:0 lds
  s_waitcnt lgkmcnt(10)
  v_mfma_f32_16x16x32_bf16 v[44:47], a[72:75], a[16:19], v[44:47]
  ds_read_b128 a[120:123], v10 offset:25856
  v_mfma_f32_16x16x32_bf16 v[44:47], a[76:79], a[20:23], v[44:47]
  ds_read_b128 a[124:127], v10 offset:29952
  s_lshl_b32 s39, s31, 16
  s_lshl_b32 s40, s3, 22
  s_add_u32 s39, s39, s40
  s_add_u32 s8, s6, s39
  s_addc_u32 s9, s7, 0
  s_mov_b32 s10, 65536
  s_mov_b32 s11, 0x20000
  s_add_u32 s39, s39, 0x10000
  s_add_u32 s12, s6, s39
  s_addc_u32 s13, s7, 0
  s_mov_b32 s14, 65536
  s_mov_b32 s15, 0x20000
  buffer_load_dwordx4 v2, s[16:19], s34 offen offset:1024 lds
  s_waitcnt lgkmcnt(10)
  v_mfma_f32_16x16x32_bf16 v[52:55], a[80:83], a[16:19], v[52:55]
  ds_read_b128 a[64:67], v10 offset:32768
  v_mfma_f32_16x16x32_bf16 v[52:55], a[84:87], a[20:23], v[52:55]
  ds_read_b128 a[68:71], v10 offset:36864
  buffer_load_dwordx4 v2, s[16:19], s34 offen offset:2048 lds
  s_waitcnt lgkmcnt(10)
  v_mfma_f32_16x16x32_bf16 v[60:63], a[88:91], a[16:19], v[60:63]
  ds_read_b128 a[72:75], v10 offset:33024
  v_mfma_f32_16x16x32_bf16 v[60:63], a[92:95], a[20:23], v[60:63]
  ds_read_b128 a[76:79], v10 offset:37120
  buffer_load_dwordx4 v2, s[16:19], s34 offen offset:3072 lds
  s_waitcnt vmcnt(12) lgkmcnt(10)
  v_mfma_f32_16x16x32_bf16 v[36:39], a[96:99], a[24:27], v[36:39]
  ds_read_b128 a[80:83], v10 offset:33792
  v_mfma_f32_16x16x32_bf16 v[36:39], a[100:103], a[28:31], v[36:39]
  ds_read_b128 a[84:87], v10 offset:37888
  s_add_u32 m0, s35, 4096
  s_nop 0
  buffer_load_dwordx4 v3, s[16:19], s34 offen offset:0 lds
  s_waitcnt lgkmcnt(10)
  v_mfma_f32_16x16x32_bf16 v[44:47], a[104:107], a[24:27], v[44:47]
  ds_read_b128 a[88:91], v10 offset:34048
  v_mfma_f32_16x16x32_bf16 v[44:47], a[108:111], a[28:31], v[44:47]
  ds_read_b128 a[92:95], v10 offset:38144
  buffer_load_dwordx4 v3, s[16:19], s34 offen offset:1024 lds
  s_waitcnt lgkmcnt(10)
  v_mfma_f32_16x16x32_bf16 v[52:55], a[112:115], a[24:27], v[52:55]
  ds_read_b128 a[96:99], v10 offset:40960
  v_mfma_f32_16x16x32_bf16 v[52:55], a[116:119], a[28:31], v[52:55]
  ds_read_b128 a[100:103], v10 offset:45056
  buffer_load_dwordx4 v3, s[16:19], s34 offen offset:2048 lds
  s_add_u32 s34, s34, 28672
  s_waitcnt lgkmcnt(10)
  v_mfma_f32_16x16x32_bf16 v[60:63], a[120:123], a[24:27], v[60:63]
  ds_read_b128 a[104:107], v10 offset:41216
  v_mfma_f32_16x16x32_bf16 v[60:63], a[124:127], a[28:31], v[60:63]
  ds_read_b128 a[108:111], v10 offset:45312
  s_add_u32 m0, s35, 28672
  s_nop 0
  buffer_load_dwordx4 v2, s[16:19], s34 offen offset:0 lds
  s_waitcnt vmcnt(14) lgkmcnt(10)
  v_mfma_f32_16x16x32_bf16 v[36:39], a[64:67], a[32:35], v[36:39]
  ds_read_b128 a[112:115], v10 offset:41984
  v_mfma_f32_16x16x32_bf16 v[36:39], a[68:71], a[36:39], v[36:39]
  ds_read_b128 a[116:119], v10 offset:46080
  buffer_load_dwordx4 v2, s[16:19], s34 offen offset:1024 lds
  s_waitcnt lgkmcnt(10)
  v_mfma_f32_16x16x32_bf16 v[44:47], a[72:75], a[32:35], v[44:47]
  ds_read_b128 a[120:123], v10 offset:42240
  v_mfma_f32_16x16x32_bf16 v[44:47], a[76:79], a[36:39], v[44:47]
  ds_read_b128 a[124:127], v10 offset:46336
  buffer_load_dwordx4 v2, s[16:19], s34 offen offset:2048 lds
  s_waitcnt lgkmcnt(10)
  v_mfma_f32_16x16x32_bf16 v[52:55], a[80:83], a[32:35], v[52:55]
  ds_read_b128 a[64:67], v10 offset:49152
  v_mfma_f32_16x16x32_bf16 v[52:55], a[84:87], a[36:39], v[52:55]
  ds_read_b128 a[68:71], v10 offset:53248
  buffer_load_dwordx4 v2, s[16:19], s34 offen offset:3072 lds
  s_waitcnt lgkmcnt(10)
  v_mfma_f32_16x16x32_bf16 v[60:63], a[88:91], a[32:35], v[60:63]
  ds_read_b128 a[72:75], v10 offset:49408
  v_mfma_f32_16x16x32_bf16 v[60:63], a[92:95], a[36:39], v[60:63]
  ds_read_b128 a[76:79], v10 offset:53504
  s_add_u32 m0, s35, 32768
  s_nop 0
  buffer_load_dwordx4 v3, s[16:19], s34 offen offset:0 lds
  s_waitcnt vmcnt(16) lgkmcnt(10)
  v_mfma_f32_16x16x32_bf16 v[36:39], a[96:99], a[40:43], v[36:39]
  ds_read_b128 a[80:83], v10 offset:50176
  v_mfma_f32_16x16x32_bf16 v[36:39], a[100:103], a[44:47], v[36:39]
  ds_read_b128 a[84:87], v10 offset:54272
  buffer_load_dwordx4 v3, s[16:19], s34 offen offset:1024 lds
  s_waitcnt lgkmcnt(10)
  v_mfma_f32_16x16x32_bf16 v[44:47], a[104:107], a[40:43], v[44:47]
  ds_read_b128 a[88:91], v10 offset:50432
  v_mfma_f32_16x16x32_bf16 v[44:47], a[108:111], a[44:47], v[44:47]
  ds_read_b128 a[92:95], v10 offset:54528
  buffer_load_dwordx4 v3, s[16:19], s34 offen offset:2048 lds
  s_add_u32 s34, s34, 28672
  s_waitcnt lgkmcnt(10)
  v_mfma_f32_16x16x32_bf16 v[52:55], a[112:115], a[40:43], v[52:55]
  ds_read_b128 a[96:99], v10 offset:57344
  v_mfma_f32_16x16x32_bf16 v[52:55], a[116:119], a[44:47], v[52:55]
  ds_read_b128 a[100:103], v10 offset:61440
  s_waitcnt lgkmcnt(10)
  v_mfma_f32_16x16x32_bf16 v[60:63], a[120:123], a[40:43], v[60:63]
  ds_read_b128 a[104:107], v10 offset:57600
  v_mfma_f32_16x16x32_bf16 v[60:63], a[124:127], a[44:47], v[60:63]
  ds_read_b128 a[108:111], v10 offset:61696
  s_waitcnt vmcnt(16) lgkmcnt(10)
  v_mfma_f32_16x16x32_bf16 v[36:39], a[64:67], a[48:51], v[36:39]
  ds_read_b128 a[112:115], v10 offset:58368
  v_mfma_f32_16x16x32_bf16 v[36:39], a[68:71], a[52:55], v[36:39]
  ds_read_b128 a[116:119], v10 offset:62464
  s_waitcnt lgkmcnt(10)
  v_mfma_f32_16x16x32_bf16 v[44:47], a[72:75], a[48:51], v[44:47]
  ds_read_b128 a[120:123], v10 offset:58624
  v_mfma_f32_16x16x32_bf16 v[44:47], a[76:79], a[52:55], v[44:47]
  ds_read_b128 a[124:127], v10 offset:62720
  s_waitcnt lgkmcnt(10)
  v_mfma_f32_16x16x32_bf16 v[52:55], a[80:83], a[48:51], v[52:55]
  v_mfma_f32_16x16x32_bf16 v[52:55], a[84:87], a[52:55], v[52:55]
  s_waitcnt lgkmcnt(8)
  v_mfma_f32_16x16x32_bf16 v[60:63], a[88:91], a[48:51], v[60:63]
  buffer_load_dword v9, v8, s[24:27], s45 offen sc1
  v_mfma_f32_16x16x32_bf16 v[60:63], a[92:95], a[52:55], v[60:63]
  s_waitcnt vmcnt(15) lgkmcnt(6)
  v_mfma_f32_16x16x32_bf16 v[36:39], a[96:99], a[56:59], v[36:39]
  v_mfma_f32_16x16x32_bf16 v[36:39], a[100:103], a[60:63], v[36:39]
  s_waitcnt lgkmcnt(4)
  v_mfma_f32_16x16x32_bf16 v[44:47], a[104:107], a[56:59], v[44:47]
  v_mfma_f32_16x16x32_bf16 v[44:47], a[108:111], a[60:63], v[44:47]
  s_waitcnt lgkmcnt(2)
  v_mfma_f32_16x16x32_bf16 v[52:55], a[112:115], a[56:59], v[52:55]
  v_mfma_f32_16x16x32_bf16 v[52:55], a[116:119], a[60:63], v[52:55]
  s_waitcnt lgkmcnt(0)
  v_mfma_f32_16x16x32_bf16 v[60:63], a[120:123], a[56:59], v[60:63]
  v_mfma_f32_16x16x32_bf16 v[60:63], a[124:127], a[60:63], v[60:63]
  v_mul_f32 v5, v36, v36
  v_add_f32 v4, v36, v37
  v_fmac_f32 v5, v37, v37
  v_fmac_f32 v5, v38, v38
  v_add_f32 v4, v4, v38
  v_fmac_f32 v5, v39, v39
  v_add_f32 v4, v4, v39
  v_fmac_f32 v5, v44, v44
  v_add_f32 v4, v4, v44
  v_fmac_f32 v5, v45, v45
  v_add_f32 v4, v4, v45
  v_fmac_f32 v5, v46, v46
  v_add_f32 v4, v4, v46
  v_fmac_f32 v5, v47, v47
  v_add_f32 v4, v4, v47
  v_fmac_f32 v5, v52, v52
  v_add_f32 v4, v4, v52
  v_fmac_f32 v5, v53, v53
  v_add_f32 v4, v4, v53
  v_fmac_f32 v5, v54, v54
  v_add_f32 v4, v4, v54
  v_fmac_f32 v5, v55, v55
  v_add_f32 v4, v4, v55
  v_fmac_f32 v5, v60, v60
  v_add_f32 v4, v4, v60
  v_fmac_f32 v5, v61, v61
  v_add_f32 v4, v4, v61
  v_fmac_f32 v5, v62, v62
  v_add_f32 v4, v4, v62
  v_fmac_f32 v5, v63, v63
  v_add_f32 v4, v4, v63
  s_nop 1
  v_permlane32_swap_b32 v4, v5
  v_add_f32 v4, v4, v5
  v_mov_b32 v5, v4
  s_nop 1
  v_permlane16_swap_b32 v4, v5
  v_add_f32 v7, v4, v5
  s_mov_b32 exec_lo, 0xffff
  s_mov_b32 exec_hi, 0xffff
  buffer_atomic_add_f32 v7, v24, s[24:27], s42 offen offset:64 sc1
  s_mov_b64 exec, -1
  v_cvt_pk_bf16_f32 v64, v36, v37
  v_cvt_pk_bf16_f32 v65, v38, v39
  v_cvt_pk_bf16_f32 v66, v44, v45
  v_cvt_pk_bf16_f32 v67, v46, v47
  v_cvt_pk_bf16_f32 v68, v52, v53
  v_cvt_pk_bf16_f32 v69, v54, v55
  v_cvt_pk_bf16_f32 v70, v60, v61
  v_cvt_pk_bf16_f32 v71, v62, v63
  v_permlane32_swap_b32 v64, v66
  v_permlane32_swap_b32 v65, v67
  v_permlane32_swap_b32 v68, v70
  v_permlane32_swap_b32 v69, v71
  buffer_store_dwordx4 v[64:67], v12, s[20:23], 0 offen offset:256 sc1
  buffer_store_dwordx4 v[68:71], v12, s[20:23], 0 offen offset:2304 sc1
  s_waitcnt vmcnt(3)
xa_chk:
  v_cmp_gt_u32 vcc, 8, v9
  s_nop 4
  s_cbranch_vccz xa_ok
  s_sleep 1
  buffer_load_dword v9, v8, s[24:27], s45 offen sc1
  s_sub_u32 s90, s90, 1
  s_cmp_lg_u32 s90, 0
  s_waitcnt vmcnt(0)
  s_cbranch_scc1 xa_chk
xa_ok:
  s_mov_b32 s33, 0
  buffer_load_dwordx4 a[0:3], v12, s[8:11], s33 offen offset:0
  buffer_load_dwordx4 a[8:11], v12, s[12:15], s33 offen offset:0
  buffer_load_dwordx4 a[16:19], v12, s[8:11], s33 offen offset:2048
  buffer_load_dwordx4 a[24:27], v12, s[12:15], s33 offen offset:2048
  s_mov_b32 s33, 4096
  buffer_load_dwordx4 a[32:35], v12, s[8:11], s33 offen offset:0
  buffer_load_dwordx4 a[40:43], v12, s[12:15], s33 offen offset:0
  buffer_load_dwordx4 a[48:51], v12, s[8:11], s33 offen offset:2048
  buffer_load_dwordx4 a[56:59], v12, s[12:15], s33 offen offset:2048
  s_lshr_b32 s42, s50, 1
  s_lshl_b32 s42, s42, 10
  s_and_b32 s41, s51, 3
  s_lshl_b32 s41, s41, 8
  s_add_u32 s42, s42, s41
  s_add_u32 s42, s42, 16384
  s_add_u32 s42, s42, s28
  v_mov_b32 v32, 0
  v_mov_b32 v33, 0
  v_mov_b32 v34, 0
  v_mov_b32 v35, 0
  v_mov_b32 v36, 0
  v_mov_b32 v37, 0
  v_mov_b32 v38, 0
  v_mov_b32 v39, 0
  v_mov_b32 v40, 0
  v_mov_b32 v41, 0
  v_mov_b32 v42, 0
  v_mov_b32 v43, 0
  v_mov_b32 v44, 0
  v_mov_b32 v45, 0
  v_mov_b32 v46, 0
  v_mov_b32 v47, 0
  v_mov_b32 v48, 0
  v_mov_b32 v49, 0
  v_mov_b32 v50, 0
  v_mov_b32 v51, 0
  v_mov_b32 v52, 0
  v_mov_b32 v53, 0
  v_mov_b32 v54, 0
  v_mov_b32 v55, 0
  v_mov_b32 v56, 0
  v_mov_b32 v57, 0
  v_mov_b32 v58, 0
  v_mov_b32 v59, 0
  v_mov_b32 v60, 0
  v_mov_b32 v61, 0
  v_mov_b32 v62, 0
  v_mov_b32 v63, 0
  v_mov_b32 v64, 0
  v_mov_b32 v65, 0
  v_mov_b32 v66, 0
  v_mov_b32 v67, 0
  v_mov_b32 v68, 0
  v_mov_b32 v69, 0
  v_mov_b32 v70, 0
  v_mov_b32 v71, 0
  v_and_b32 v24, 31, v0
  v_lshlrev_b32 v24, 2, v24
  s_lshl_b32 s46, s31, 7
  s_lshl_b32 s47, s3, 14
  s_add_u32 s46, s46, s47
  s_add_u32 s47, s46, 0x2000
  s_mov_b32 s38, 4
  v_and_b32 v24, 15, v0
  v_lshlrev_b32 v4, 4, v24
  v_lshlrev_b32 v24, 2, v24
  v_bfe_u32 v5, v0, 4, 1
  v_lshl_add_u32 v4, v5, 9, v4
  v_lshl_add_u32 v12, v15, 10, v4
  v_lshl_add_u32 v13, v15, 8, v4
  v_mul_u32_u24 v5, 7168, v15
  v_add3_u32 v10, v4, v5, s29
  v_add_u32 v11, 57344, v10
  v_lshrrev_b32 v14, 4, v0
  v_lshlrev_b32 v14, 4, v14
  s_and_b32 s39, s49, 15
  s_lshr_b32 s40, s49, 4
  s_mul_i32 s40, s40, 114688
  s_lshl_b32 s92, s39, 10
  s_add_u32 s92, s92, s40
  s_lshr_b32 s39, s3, 1
  s_lshl_b32 s39, s39, 8
  s_xor_b32 s41, s2, 0
  s_add_u32 s39, s39, s41
  s_lshl_b32 s39, s39, 2
  s_add_u32 s39, s39, s30
  s_lshl_b32 s39, s39, 13
  s_add_u32 s39, s39, 100663296
  s_add_u32 s96, s6, s39
  s_addc_u32 s97, s7, 0
  s_mov_b32 s98, 4096
  s_mov_b32 s99, 0x20000
  s_load_dwordx2 s[56:57], s[0:1], 48
  s_mov_b32 s95, 0
  v_accvgpr_write_b32 a248, -1
  v_accvgpr_write_b32 a249, -1
  v_accvgpr_write_b32 a250, -1
  v_accvgpr_write_b32 a251, -1
  s_mul_i32 s39, s31, 229376
  s_lshr_b32 s40, s3, 1
  s_lshl_b32 s40, s40, 24
  s_add_u32 s39, s39, s40
  s_add_u32 s39, s39, 67108864
  s_add_u32 s20, s6, s39
  s_addc_u32 s21, s7, 0
  s_mov_b32 s22, 458752
  s_mov_b32 s23, 0x20000
  s_mov_b32 s58, 7340032
  s_mov_b32 s59, 0x20000
  s_and_b32 s39, s2, 7
  s_and_b32 s40, s2, 0xf8
  s_lshl_b32 s41, s30, 1
  s_add_u32 s40, s40, s41
  s_lshl_b32 s91, s40, 15
  s_lshl_b32 s41, s39, 8
  s_add_u32 s91, s91, s41
  s_cmp_ge_u32 s40, 112
  s_cselect_b32 s41, 1, 0
  s_lshl_b32 s43, s39, 1
  s_add_u32 s43, s43, s41
  s_lshl_b32 s43, s43, 8
  s_add_u32 s43, s43, 491520
  s_mul_i32 s39, s39, 917504
  s_add_u32 s39, s39, 27262976
  s_lshl_b32 s41, s41, 11
  s_mul_i32 s89, s40, 9363
  s_lshr_b32 s89, s89, 16
  s_mul_i32 s93, s89, 7
  s_sub_u32 s93, s40, s93
  s_and_b32 vcc_lo, s89, 15
  s_lshr_b32 s89, s89, 4
  s_mul_i32 s89, s89, 112
  s_lshl_b32 s93, s93, 4
  s_add_u32 s89, s89, s93
  s_add_u32 s89, s89, vcc_lo
  s_lshl_b32 s89, s89, 12
  s_add_u32 s89, s89, s39
  s_sub_u32 s93, s89, s41
  s_add_u32 s93, s93, 2048
  s_add_u32 s89, s89, s41
  s_add_u32 s40, s40, 1
  s_mul_i32 s90, s40, 9363
  s_lshr_b32 s90, s90, 16
  s_mul_i32 s94, s90, 7
  s_sub_u32 s94, s40, s94
  s_and_b32 vcc_lo, s90, 15
  s_lshr_b32 s90, s90, 4
  s_mul_i32 s90, s90, 112
  s_lshl_b32 s94, s94, 4
  s_add_u32 s90, s90, s94
  s_add_u32 s90, s90, vcc_lo
  s_lshl_b32 s90, s90, 12
  s_add_u32 s90, s90, s39
  s_sub_u32 s94, s90, s41
  s_add_u32 s94, s94, 2048
  s_add_u32 s90, s90, s41
  s_add_u32 s40, s40, 1
  s_lshl_b32 s41, s30, 13
  s_add_u32 s41, s41, 0x20000
  s_cmp_lt_u32 s2, 224
  s_cselect_b32 s40, 4, 0
  s_cmp_eq_u32 s3, 1
  s_cselect_b32 s29, s40, 0
  v_bfe_u32 v4, v0, 2, 2
  v_lshrrev_b32 v5, 4, v0
  v_lshlrev_b32 v6, 11, v5
  v_xor_b32 v5, v5, v4
  v_lshl_add_u32 v6, v5, 6, v6
  v_and_b32 v5, 3, v0
  v_lshl_add_u32 v6, v5, 4, v6
  v_add_u32 v7, 0x2000, v6
  v_and_b32 v5, 1, v0
  v_lshlrev_b32 v5, 4, v5
  v_and_b32 v8, 2, v0
  v_lshl_add_u32 v5, v8, 2, v5
  v_and_b32 v8, 16, v0
  v_lshl_add_u32 v5, v8, 1, v5
  v_lshl_add_u32 v5, v4, 8, v5
  v_lshl_add_u32 v5, v15, 11, v5
  v_add_u32 v5, s41, v5
  v_xor_b32 v8, 2, v4
  v_lshl_add_u32 v30, v8, 6, v5
  v_xor_b32 v8, 3, v4
  v_lshl_add_u32 v31, v8, 6, v5
  v_xor_b32 v8, 1, v4
  v_lshl_add_u32 v4, v4, 6, v5
  v_lshl_add_u32 v5, v8, 6, v5
  s_sub_u32 s45, s45, 40960
  v_and_b32 v16, 3, v0
  v_lshlrev_b32 v16, 8, v16
  s_waitcnt lgkmcnt(0)
  s_waitcnt vmcnt(8)
  s_barrier
  s_cmp_lg_u32 s30, 0
  s_cbranch_scc1 arr4
  v_mov_b32 v8, 0
  v_mov_b32 v9, 1
  s_mov_b64 exec, 1
  buffer_atomic_add v9, v8, s[24:27], s42 offen sc1
  s_mov_b64 exec, -1
arr4:
  v_mov_b32 v8, 0
  v_mov_b32 v9, 1
  s_mov_b32 s40, s29
  s_movk_i32 s29, 4096
  v_mov_b32 v28, v4
  v_mov_b32 v29, v5
  ds_read_b128 a[128:131], v10 offset:0
  ds_read_b128 a[132:135], v10 offset:14336
  ds_read_b128 a[136:139], v10 offset:256
  ds_read_b128 a[140:143], v10 offset:14592
  ds_read_b128 a[144:147], v10 offset:1024
  ds_read_b128 a[148:151], v10 offset:15360
  s_waitcnt vmcnt(4) lgkmcnt(4)
  v_mfma_f32_16x16x32_bf16 v[32:35], a[128:131], a[0:3], v[32:35]
  ds_read_b128 a[152:155], v10 offset:1280
  v_mfma_f32_16x16x32_bf16 v[32:35], a[132:135], a[16:19], v[32:35]
  ds_read_b128 a[156:159], v10 offset:15616
  v_mfma_f32_16x16x32_bf16 v[40:43], a[132:135], a[24:27], v[40:43]
  s_add_u32 m0, s36, 0
  s_nop 0
  buffer_load_dwordx4 v2, s[16:19], s34 offen offset:0 lds
  v_mfma_f32_16x16x32_bf16 v[40:43], a[128:131], a[8:11], v[40:43]
  s_waitcnt lgkmcnt(4)
  v_mfma_f32_16x16x32_bf16 v[48:51], a[136:139], a[0:3], v[48:51]
  ds_read_b128 a[128:131], v10 offset:2048
  v_mfma_f32_16x16x32_bf16 v[48:51], a[140:143], a[16:19], v[48:51]
  ds_read_b128 a[132:135], v10 offset:16384
  v_mfma_f32_16x16x32_bf16 v[56:59], a[140:143], a[24:27], v[56:59]
  buffer_load_dwordx4 v2, s[16:19], s34 offen offset:1024 lds
  v_mfma_f32_16x16x32_bf16 v[56:59], a[136:139], a[8:11], v[56:59]
  s_waitcnt lgkmcnt(4)
  v_mfma_f32_16x16x32_bf16 v[64:67], a[144:147], a[0:3], v[64:67]
  ds_read_b128 a[136:139], v10 offset:2304
  v_mfma_f32_16x16x32_bf16 v[64:67], a[148:151], a[16:19], v[64:67]
  ds_read_b128 a[140:143], v10 offset:16640
  v_mfma_f32_16x16x32_bf16 v[72:75], a[148:151], a[24:27], v[72:75]
  buffer_load_dwordx4 v2, s[16:19], s34 offen offset:2048 lds
  v_mfma_f32_16x16x32_bf16 v[72:75], a[144:147], a[8:11], v[72:75]
  s_waitcnt lgkmcnt(4)
  v_mfma_f32_16x16x32_bf16 v[80:83], a[152:155], a[0:3], v[80:83]
  ds_read_b128 a[144:147], v10 offset:3072
  v_mfma_f32_16x16x32_bf16 v[80:83], a[156:159], a[16:19], v[80:83]
  ds_read_b128 a[148:151], v10 offset:17408
  v_mfma_f32_16x16x32_bf16 v[88:91], a[156:159], a[24:27], v[88:91]
  buffer_load_dwordx4 v2, s[16:19], s34 offen offset:3072 lds
  v_mfma_f32_16x16x32_bf16 v[88:91], a[152:155], a[8:11], v[88:91]
  s_waitcnt lgkmcnt(4)
  v_mfma_f32_16x16x32_bf16 v[96:99], a[128:131], a[0:3], v[96:99]
  ds_read_b128 a[152:155], v10 offset:3328
  v_mfma_f32_16x16x32_bf16 v[96:99], a[132:135], a[16:19], v[96:99]
  ds_read_b128 a[156:159], v10 offset:17664
  v_mfma_f32_16x16x32_bf16 v[104:107], a[132:135], a[24:27], v[104:107]
  s_add_u32 m0, s36, 4096
  s_nop 0
  buffer_load_dwordx4 v3, s[16:19], s34 offen offset:0 lds
  v_mfma_f32_16x16x32_bf16 v[104:107], a[128:131], a[8:11], v[104:107]
  s_waitcnt lgkmcnt(4)
  v_mfma_f32_16x16x32_bf16 v[112:115], a[136:139], a[0:3], v[112:115]
  ds_read_b128 a[128:131], v10 offset:4096
  v_mfma_f32_16x16x32_bf16 v[112:115], a[140:143], a[16:19], v[112:115]
  ds_read_b128 a[132:135], v10 offset:18432
  v_mfma_f32_16x16x32_bf16 v[120:123], a[140:143], a[24:27], v[120:123]
  buffer_load_dwordx4 v3, s[16:19], s34 offen offset:1024 lds
  v_mfma_f32_16x16x32_bf16 v[120:123], a[136:139], a[8:11], v[120:123]
  s_waitcnt lgkmcnt(4)
  v_mfma_f32_16x16x32_bf16 v[128:131], a[144:147], a[0:3], v[128:131]
  ds_read_b128 a[136:139], v10 offset:4352
  v_mfma_f32_16x16x32_bf16 v[128:131], a[148:151], a[16:19], v[128:131]
  ds_read_b128 a[140:143], v10 offset:18688
  v_mfma_f32_16x16x32_bf16 v[136:139], a[148:151], a[24:27], v[136:139]
  buffer_load_dwordx4 v3, s[16:19], s34 offen offset:2048 lds
  s_add_u32 s34, s34, 28672
  v_mfma_f32_16x16x32_bf16 v[136:139], a[144:147], a[8:11], v[136:139]
  s_waitcnt lgkmcnt(4)
  v_mfma_f32_16x16x32_bf16 v[144:147], a[152:155], a[0:3], v[144:147]
  ds_read_b128 a[144:147], v10 offset:5120
  v_mfma_f32_16x16x32_bf16 v[144:147], a[156:159], a[16:19], v[144:147]
  ds_read_b128 a[148:151], v10 offset:19456
  v_mfma_f32_16x16x32_bf16 v[152:155], a[156:159], a[24:27], v[152:155]
  v_mfma_f32_16x16x32_bf16 v[152:155], a[152:155], a[8:11], v[152:155]
  s_waitcnt lgkmcnt(4)
  v_mfma_f32_16x16x32_bf16 v[160:163], a[128:131], a[0:3], v[160:163]
  ds_read_b128 a[152:155], v10 offset:5376
  v_mfma_f32_16x16x32_bf16 v[160:163], a[132:135], a[16:19], v[160:163]
  ds_read_b128 a[156:159], v10 offset:19712
  v_mfma_f32_16x16x32_bf16 v[168:171], a[132:135], a[24:27], v[168:171]
  v_mfma_f32_16x16x32_bf16 v[168:171], a[128:131], a[8:11], v[168:171]
  s_waitcnt lgkmcnt(4)
  v_mfma_f32_16x16x32_bf16 v[176:179], a[136:139], a[0:3], v[176:179]
  ds_read_b128 a[128:131], v10 offset:6144
  v_mfma_f32_16x16x32_bf16 v[176:179], a[140:143], a[16:19], v[176:179]
  ds_read_b128 a[132:135], v10 offset:20480
  v_mfma_f32_16x16x32_bf16 v[184:187], a[140:143], a[24:27], v[184:187]
  v_mfma_f32_16x16x32_bf16 v[184:187], a[136:139], a[8:11], v[184:187]
  s_waitcnt lgkmcnt(4)
  v_mfma_f32_16x16x32_bf16 v[192:195], a[144:147], a[0:3], v[192:195]
  ds_read_b128 a[136:139], v10 offset:6400
  v_mfma_f32_16x16x32_bf16 v[192:195], a[148:151], a[16:19], v[192:195]
  ds_read_b128 a[140:143], v10 offset:20736
  v_mfma_f32_16x16x32_bf16 v[200:203], a[148:151], a[24:27], v[200:203]
  v_mfma_f32_16x16x32_bf16 v[200:203], a[144:147], a[8:11], v[200:203]
  s_waitcnt lgkmcnt(4)
  v_mfma_f32_16x16x32_bf16 v[208:211], a[152:155], a[0:3], v[208:211]
  ds_read_b128 a[144:147], v10 offset:28672
  v_mfma_f32_16x16x32_bf16 v[208:211], a[156:159], a[16:19], v[208:211]
  ds_read_b128 a[148:151], v10 offset:43008
  v_mfma_f32_16x16x32_bf16 v[216:219], a[156:159], a[24:27], v[216:219]
  v_mfma_f32_16x16x32_bf16 v[216:219], a[152:155], a[8:11], v[216:219]
  s_waitcnt lgkmcnt(4)
  v_mfma_f32_16x16x32_bf16 v[224:227], a[128:131], a[0:3], v[224:227]
  ds_read_b128 a[152:155], v10 offset:28928
  v_mfma_f32_16x16x32_bf16 v[224:227], a[132:135], a[16:19], v[224:227]
  ds_read_b128 a[156:159], v10 offset:43264
  v_mfma_f32_16x16x32_bf16 v[232:235], a[132:135], a[24:27], v[232:235]
  v_mfma_f32_16x16x32_bf16 v[232:235], a[128:131], a[8:11], v[232:235]
  s_waitcnt lgkmcnt(4)
  v_mfma_f32_16x16x32_bf16 v[240:243], a[136:139], a[0:3], v[240:243]
  ds_read_b128 a[128:131], v10 offset:29696
  v_mfma_f32_16x16x32_bf16 v[240:243], a[140:143], a[16:19], v[240:243]
  ds_read_b128 a[132:135], v10 offset:44032
  v_mfma_f32_16x16x32_bf16 v[248:251], a[140:143], a[24:27], v[248:251]
  buffer_load_dword v17, v16, s[24:27], s45 offen sc1
  v_mfma_f32_16x16x32_bf16 v[248:251], a[136:139], a[8:11], v[248:251]
  s_waitcnt vmcnt(8) lgkmcnt(4)
  v_mfma_f32_16x16x32_bf16 v[32:35], a[144:147], a[32:35], v[32:35]
  ds_read_b128 a[136:139], v10 offset:29952
  v_mfma_f32_16x16x32_bf16 v[32:35], a[148:151], a[48:51], v[32:35]
  ds_read_b128 a[140:143], v10 offset:44288
  v_mfma_f32_16x16x32_bf16 v[40:43], a[148:151], a[56:59], v[40:43]
  v_mfma_f32_16x16x32_bf16 v[40:43], a[144:147], a[40:43], v[40:43]
  s_waitcnt lgkmcnt(4)
  v_mfma_f32_16x16x32_bf16 v[48:51], a[152:155], a[32:35], v[48:51]
  ds_read_b128 a[144:147], v10 offset:30720
  v_mfma_f32_16x16x32_bf16 v[48:51], a[156:159], a[48:51], v[48:51]
  ds_read_b128 a[148:151], v10 offset:45056
  v_mfma_f32_16x16x32_bf16 v[56:59], a[156:159], a[56:59], v[56:59]
  v_mfma_f32_16x16x32_bf16 v[56:59], a[152:155], a[40:43], v[56:59]
  s_waitcnt lgkmcnt(4)
  v_mfma_f32_16x16x32_bf16 v[64:67], a[128:131], a[32:35], v[64:67]
  ds_read_b128 a[152:155], v10 offset:30976
  v_mfma_f32_16x16x32_bf16 v[64:67], a[132:135], a[48:51], v[64:67]
  ds_read_b128 a[156:159], v10 offset:45312
  v_mfma_f32_16x16x32_bf16 v[72:75], a[132:135], a[56:59], v[72:75]
  v_mfma_f32_16x16x32_bf16 v[72:75], a[128:131], a[40:43], v[72:75]
  s_waitcnt lgkmcnt(4)
  v_mfma_f32_16x16x32_bf16 v[80:83], a[136:139], a[32:35], v[80:83]
  ds_read_b128 a[128:131], v10 offset:31744
  v_mfma_f32_16x16x32_bf16 v[80:83], a[140:143], a[48:51], v[80:83]
  ds_read_b128 a[132:135], v10 offset:46080
  v_mfma_f32_16x16x32_bf16 v[88:91], a[140:143], a[56:59], v[88:91]
  v_mfma_f32_16x16x32_bf16 v[88:91], a[136:139], a[40:43], v[88:91]
  s_waitcnt lgkmcnt(4)
  v_mfma_f32_16x16x32_bf16 v[96:99], a[144:147], a[32:35], v[96:99]
  ds_read_b128 a[136:139], v10 offset:32000
  v_mfma_f32_16x16x32_bf16 v[96:99], a[148:151], a[48:51], v[96:99]
  ds_read_b128 a[140:143], v10 offset:46336
  v_mfma_f32_16x16x32_bf16 v[104:107], a[148:151], a[56:59], v[104:107]
  v_mfma_f32_16x16x32_bf16 v[104:107], a[144:147], a[40:43], v[104:107]
  s_waitcnt lgkmcnt(4)
  v_mfma_f32_16x16x32_bf16 v[112:115], a[152:155], a[32:35], v[112:115]
  ds_read_b128 a[144:147], v10 offset:32768
  v_mfma_f32_16x16x32_bf16 v[112:115], a[156:159], a[48:51], v[112:115]
  ds_read_b128 a[148:151], v10 offset:47104
  v_mfma_f32_16x16x32_bf16 v[120:123], a[156:159], a[56:59], v[120:123]
  s_waitcnt vmcnt(0)
  v_cmp_gt_u32 vcc, 8, v17
  s_nop 4
  s_cbranch_vccnz xb_chk
xb_ok:
  s_mov_b32 s33, 0
  buffer_load_dwordx4 a[4:7], v12, s[8:11], s33 offen offset:256
  v_mfma_f32_16x16x32_bf16 v[120:123], a[152:155], a[40:43], v[120:123]
  buffer_load_dwordx4 a[12:15], v12, s[12:15], s33 offen offset:256
  s_waitcnt lgkmcnt(4)
  v_mfma_f32_16x16x32_bf16 v[128:131], a[128:131], a[32:35], v[128:131]
  ds_read_b128 a[152:155], v10 offset:33024
  v_mfma_f32_16x16x32_bf16 v[128:131], a[132:135], a[48:51], v[128:131]
  ds_read_b128 a[156:159], v10 offset:47360
  v_mfma_f32_16x16x32_bf16 v[136:139], a[132:135], a[56:59], v[136:139]
  buffer_load_dwordx4 a[20:23], v12, s[8:11], s33 offen offset:2304
  v_mfma_f32_16x16x32_bf16 v[136:139], a[128:131], a[40:43], v[136:139]
  buffer_load_dwordx4 a[28:31], v12, s[12:15], s33 offen offset:2304
  s_waitcnt lgkmcnt(4)
  v_mfma_f32_16x16x32_bf16 v[144:147], a[136:139], a[32:35], v[144:147]
  ds_read_b128 a[128:131], v10 offset:33792
  v_mfma_f32_16x16x32_bf16 v[144:147], a[140:143], a[48:51], v[144:147]
  ds_read_b128 a[132:135], v10 offset:48128
  v_mfma_f32_16x16x32_bf16 v[152:155], a[140:143], a[56:59], v[152:155]
  s_mov_b32 s33, 4096
  buffer_load_dwordx4 a[36:39], v12, s[8:11], s33 offen offset:256
  v_mfma_f32_16x16x32_bf16 v[152:155], a[136:139], a[40:43], v[152:155]
  buffer_load_dwordx4 a[44:47], v12, s[12:15], s33 offen offset:256
  s_waitcnt lgkmcnt(4)
  v_mfma_f32_16x16x32_bf16 v[160:163], a[144:147], a[32:35], v[160:163]
  ds_read_b128 a[136:139], v10 offset:34048
  v_mfma_f32_16x16x32_bf16 v[160:163], a[148:151], a[48:51], v[160:163]
  ds_read_b128 a[140:143], v10 offset:48384
  v_mfma_f32_16x16x32_bf16 v[168:171], a[148:151], a[56:59], v[168:171]
  buffer_load_dwordx4 a[52:55], v12, s[8:11], s33 offen offset:2304
  v_mfma_f32_16x16x32_bf16 v[168:171], a[144:147], a[40:43], v[168:171]
  buffer_load_dwordx4 a[60:63], v12, s[12:15], s33 offen offset:2304
  s_waitcnt lgkmcnt(4)
  v_mfma_f32_16x16x32_bf16 v[176:179], a[152:155], a[32:35], v[176:179]
  ds_read_b128 a[144:147], v10 offset:34816
  v_mfma_f32_16x16x32_bf16 v[176:179], a[156:159], a[48:51], v[176:179]
  ds_read_b128 a[148:151], v10 offset:49152
  v_mfma_f32_16x16x32_bf16 v[184:187], a[156:159], a[56:59], v[184:187]
  buffer_load_dword v16, v24, s[24:27], s46 offen offset:0
  v_mfma_f32_16x16x32_bf16 v[184:187], a[152:155], a[40:43], v[184:187]
  buffer_load_dword v20, v24, s[24:27], s47 offen offset:0
  s_waitcnt lgkmcnt(4)
  v_mfma_f32_16x16x32_bf16 v[192:195], a[128:131], a[32:35], v[192:195]
  ds_read_b128 a[152:155], v10 offset:35072
  v_mfma_f32_16x16x32_bf16 v[192:195], a[132:135], a[48:51], v[192:195]
  ds_read_b128 a[156:159], v10 offset:49408
  v_mfma_f32_16x16x32_bf16 v[200:203], a[132:135], a[56:59], v[200:203]
  buffer_load_dword v17, v24, s[24:27], s46 offen offset:64
  v_mfma_f32_16x16x32_bf16 v[200:203], a[128:131], a[40:43], v[200:203]
  buffer_load_dword v21, v24, s[24:27], s47 offen offset:64
  s_waitcnt lgkmcnt(4)
  v_mfma_f32_16x16x32_bf16 v[208:211], a[136:139], a[32:35], v[208:211]
  ds_read_b128 a[128:131], v10 offset:0
  v_mfma_f32_16x16x32_bf16 v[208:211], a[140:143], a[48:51], v[208:211]
  ds_read_b128 a[132:135], v10 offset:14336
  v_mfma_f32_16x16x32_bf16 v[216:219], a[140:143], a[56:59], v[216:219]
  buffer_load_dword v18, v24, s[24:27], s46 offen offset:128
  v_mfma_f32_16x16x32_bf16 v[216:219], a[136:139], a[40:43], v[216:219]
  buffer_load_dword v22, v24, s[24:27], s47 offen offset:128
  s_waitcnt lgkmcnt(4)
  v_mfma_f32_16x16x32_bf16 v[224:227], a[144:147], a[32:35], v[224:227]
  ds_read_b128 a[136:139], v10 offset:256
  v_mfma_f32_16x16x32_bf16 v[224:227], a[148:151], a[48:51], v[224:227]
  ds_read_b128 a[140:143], v10 offset:14592
  v_mfma_f32_16x16x32_bf16 v[232:235], a[148:151], a[56:59], v[232:235]
  buffer_load_dword v19, v24, s[24:27], s46 offen offset:192
  v_mfma_f32_16x16x32_bf16 v[232:235], a[144:147], a[40:43], v[232:235]
  buffer_load_dword v23, v24, s[24:27], s47 offen offset:192
  s_mov_b32 s46, s40
  s_sub_u32 s47, s40, 1
  s_sub_u32 s40, s40, 3
  s_waitcnt lgkmcnt(4)
  v_mfma_f32_16x16x32_bf16 v[240:243], a[152:155], a[32:35], v[240:243]
  ds_read_b128 a[144:147], v10 offset:1024
  v_mfma_f32_16x16x32_bf16 v[240:243], a[156:159], a[48:51], v[240:243]
  ds_read_b128 a[148:151], v10 offset:15360
  v_mfma_f32_16x16x32_bf16 v[248:251], a[156:159], a[56:59], v[248:251]
  v_mfma_f32_16x16x32_bf16 v[248:251], a[152:155], a[40:43], v[248:251]
  s_waitcnt vmcnt(12) lgkmcnt(4)
  v_mfma_f32_16x16x32_bf16 v[36:39], a[128:131], a[4:7], v[36:39]
  ds_read_b128 a[152:155], v10 offset:1280
  v_mfma_f32_16x16x32_bf16 v[36:39], a[132:135], a[20:23], v[36:39]
  ds_read_b128 a[156:159], v10 offset:15616
  v_mfma_f32_16x16x32_bf16 v[44:47], a[132:135], a[28:31], v[44:47]
  s_add_u32 m0, s36, 28672
  s_nop 0
  buffer_load_dwordx4 v2, s[16:19], s34 offen offset:0 lds
  v_mfma_f32_16x16x32_bf16 v[44:47], a[128:131], a[12:15], v[44:47]
  s_waitcnt lgkmcnt(4)
  v_mfma_f32_16x16x32_bf16 v[52:55], a[136:139], a[4:7], v[52:55]
  ds_read_b128 a[128:131], v10 offset:2048
  v_mfma_f32_16x16x32_bf16 v[52:55], a[140:143], a[20:23], v[52:55]
  ds_read_b128 a[132:135], v10 offset:16384
  v_mfma_f32_16x16x32_bf16 v[60:63], a[140:143], a[28:31], v[60:63]
  buffer_load_dwordx4 v2, s[16:19], s34 offen offset:1024 lds
  v_mfma_f32_16x16x32_bf16 v[60:63], a[136:139], a[12:15], v[60:63]
  s_waitcnt lgkmcnt(4)
  v_mfma_f32_16x16x32_bf16 v[68:71], a[144:147], a[4:7], v[68:71]
  ds_read_b128 a[136:139], v10 offset:2304
  v_mfma_f32_16x16x32_bf16 v[68:71], a[148:151], a[20:23], v[68:71]
  ds_read_b128 a[140:143], v10 offset:16640
  v_mfma_f32_16x16x32_bf16 v[76:79], a[148:151], a[28:31], v[76:79]
  buffer_load_dwordx4 v2, s[16:19], s34 offen offset:2048 lds
  v_mfma_f32_16x16x32_bf16 v[76:79], a[144:147], a[12:15], v[76:79]
  s_waitcnt lgkmcnt(4)
  v_mfma_f32_16x16x32_bf16 v[84:87], a[152:155], a[4:7], v[84:87]
  ds_read_b128 a[144:147], v10 offset:3072
  v_mfma_f32_16x16x32_bf16 v[84:87], a[156:159], a[20:23], v[84:87]
  ds_read_b128 a[148:151], v10 offset:17408
  v_mfma_f32_16x16x32_bf16 v[92:95], a[156:159], a[28:31], v[92:95]
  buffer_load_dwordx4 v2, s[16:19], s34 offen offset:3072 lds
  v_mfma_f32_16x16x32_bf16 v[92:95], a[152:155], a[12:15], v[92:95]
  s_waitcnt lgkmcnt(4)
  v_mfma_f32_16x16x32_bf16 v[100:103], a[128:131], a[4:7], v[100:103]
  ds_read_b128 a[152:155], v10 offset:3328
  v_mfma_f32_16x16x32_bf16 v[100:103], a[132:135], a[20:23], v[100:103]
  ds_read_b128 a[156:159], v10 offset:17664
  v_mfma_f32_16x16x32_bf16 v[108:111], a[132:135], a[28:31], v[108:111]
  s_add_u32 m0, s36, 32768
  s_nop 0
  buffer_load_dwordx4 v3, s[16:19], s34 offen offset:0 lds
  v_mfma_f32_16x16x32_bf16 v[108:111], a[128:131], a[12:15], v[108:111]
  s_waitcnt lgkmcnt(4)
  v_mfma_f32_16x16x32_bf16 v[116:119], a[136:139], a[4:7], v[116:119]
  ds_read_b128 a[128:131], v10 offset:4096
  v_mfma_f32_16x16x32_bf16 v[116:119], a[140:143], a[20:23], v[116:119]
  ds_read_b128 a[132:135], v10 offset:18432
  v_mfma_f32_16x16x32_bf16 v[124:127], a[140:143], a[28:31], v[124:127]
  buffer_load_dwordx4 v3, s[16:19], s34 offen offset:1024 lds
  v_mfma_f32_16x16x32_bf16 v[124:127], a[136:139], a[12:15], v[124:127]
  s_waitcnt lgkmcnt(4)
  v_mfma_f32_16x16x32_bf16 v[132:135], a[144:147], a[4:7], v[132:135]
  ds_read_b128 a[136:139], v10 offset:4352
  v_mfma_f32_16x16x32_bf16 v[132:135], a[148:151], a[20:23], v[132:135]
  ds_read_b128 a[140:143], v10 offset:18688
  v_mfma_f32_16x16x32_bf16 v[140:143], a[148:151], a[28:31], v[140:143]
  buffer_load_dwordx4 v3, s[16:19], s34 offen offset:2048 lds
  s_add_u32 s34, s34, 28672
  v_mfma_f32_16x16x32_bf16 v[140:143], a[144:147], a[12:15], v[140:143]
  s_waitcnt lgkmcnt(4)
  v_mfma_f32_16x16x32_bf16 v[148:151], a[152:155], a[4:7], v[148:151]
  ds_read_b128 a[144:147], v10 offset:5120
  v_mfma_f32_16x16x32_bf16 v[148:151], a[156:159], a[20:23], v[148:151]
  ds_read_b128 a[148:151], v10 offset:19456
  v_mfma_f32_16x16x32_bf16 v[156:159], a[156:159], a[28:31], v[156:159]
  v_mfma_f32_16x16x32_bf16 v[156:159], a[152:155], a[12:15], v[156:159]
  s_waitcnt lgkmcnt(4)
  v_mfma_f32_16x16x32_bf16 v[164:167], a[128:131], a[4:7], v[164:167]
  ds_read_b128 a[152:155], v10 offset:5376
  v_mfma_f32_16x16x32_bf16 v[164:167], a[132:135], a[20:23], v[164:167]
  ds_read_b128 a[156:159], v10 offset:19712
  v_mfma_f32_16x16x32_bf16 v[172:175], a[132:135], a[28:31], v[172:175]
  v_mfma_f32_16x16x32_bf16 v[172:175], a[128:131], a[12:15], v[172:175]
  s_waitcnt lgkmcnt(4)
  v_mfma_f32_16x16x32_bf16 v[180:183], a[136:139], a[4:7], v[180:183]
  ds_read_b128 a[128:131], v10 offset:6144
  v_mfma_f32_16x16x32_bf16 v[180:183], a[140:143], a[20:23], v[180:183]
  ds_read_b128 a[132:135], v10 offset:20480
  v_mfma_f32_16x16x32_bf16 v[188:191], a[140:143], a[28:31], v[188:191]
  v_mfma_f32_16x16x32_bf16 v[188:191], a[136:139], a[12:15], v[188:191]
  s_waitcnt lgkmcnt(4)
  v_mfma_f32_16x16x32_bf16 v[196:199], a[144:147], a[4:7], v[196:199]
  ds_read_b128 a[136:139], v10 offset:6400
  v_mfma_f32_16x16x32_bf16 v[196:199], a[148:151], a[20:23], v[196:199]
  ds_read_b128 a[140:143], v10 offset:20736
  v_mfma_f32_16x16x32_bf16 v[204:207], a[148:151], a[28:31], v[204:207]
  v_mfma_f32_16x16x32_bf16 v[204:207], a[144:147], a[12:15], v[204:207]
  s_waitcnt lgkmcnt(0)
  s_barrier
  v_mfma_f32_16x16x32_bf16 v[212:215], a[152:155], a[4:7], v[212:215]
  ds_read_b128 a[144:147], v10 offset:28672
  v_mfma_f32_16x16x32_bf16 v[212:215], a[156:159], a[20:23], v[212:215]
  ds_read_b128 a[148:151], v10 offset:43008
  v_mfma_f32_16x16x32_bf16 v[220:223], a[156:159], a[28:31], v[220:223]
  v_mfma_f32_16x16x32_bf16 v[220:223], a[152:155], a[12:15], v[220:223]
  s_waitcnt lgkmcnt(4)
  v_mfma_f32_16x16x32_bf16 v[228:231], a[128:131], a[4:7], v[228:231]
  ds_read_b128 a[152:155], v10 offset:28928
  v_mfma_f32_16x16x32_bf16 v[228:231], a[132:135], a[20:23], v[228:231]
  ds_read_b128 a[156:159], v10 offset:43264
  v_mfma_f32_16x16x32_bf16 v[236:239], a[132:135], a[28:31], v[236:239]
  v_mfma_f32_16x16x32_bf16 v[236:239], a[128:131], a[12:15], v[236:239]
  s_waitcnt lgkmcnt(4)
  v_mfma_f32_16x16x32_bf16 v[244:247], a[136:139], a[4:7], v[244:247]
  ds_read_b128 a[128:131], v10 offset:29696
  v_mfma_f32_16x16x32_bf16 v[244:247], a[140:143], a[20:23], v[244:247]
  ds_read_b128 a[132:135], v10 offset:44032
  v_mfma_f32_16x16x32_bf16 v[252:255], a[140:143], a[28:31], v[252:255]
  v_mfma_f32_16x16x32_bf16 v[252:255], a[136:139], a[12:15], v[252:255]
  s_waitcnt vmcnt(15) lgkmcnt(4)
  v_mfma_f32_16x16x32_bf16 v[36:39], a[144:147], a[36:39], v[36:39]
  ds_read_b128 a[136:139], v10 offset:29952
  v_mfma_f32_16x16x32_bf16 v[36:39], a[148:151], a[52:55], v[36:39]
  ds_read_b128 a[140:143], v10 offset:44288
  v_mfma_f32_16x16x32_bf16 v[44:47], a[148:151], a[60:63], v[44:47]
  s_add_u32 s33, s33, 0x1000
  buffer_load_dwordx4 a[0:3], v12, s[8:11], s33 offen offset:0
  v_mfma_f32_16x16x32_bf16 v[44:47], a[144:147], a[44:47], v[44:47]
  buffer_load_dwordx4 a[4:7], v12, s[8:11], s33 offen offset:256
  s_waitcnt lgkmcnt(4)
  v_mfma_f32_16x16x32_bf16 v[52:55], a[152:155], a[36:39], v[52:55]
  ds_read_b128 a[144:147], v10 offset:30720
  v_mfma_f32_16x16x32_bf16 v[52:55], a[156:159], a[52:55], v[52:55]
  ds_read_b128 a[148:151], v10 offset:45056
  v_mfma_f32_16x16x32_bf16 v[60:63], a[156:159], a[60:63], v[60:63]
  buffer_load_dwordx4 a[8:11], v12, s[12:15], s33 offen offset:0
  v_mfma_f32_16x16x32_bf16 v[60:63], a[152:155], a[44:47], v[60:63]
  buffer_load_dwordx4 a[12:15], v12, s[12:15], s33 offen offset:256
  s_waitcnt lgkmcnt(4)
  v_mfma_f32_16x16x32_bf16 v[68:71], a[128:131], a[36:39], v[68:71]
  ds_read_b128 a[152:155], v10 offset:30976
  v_mfma_f32_16x16x32_bf16 v[68:71], a[132:135], a[52:55], v[68:71]
  ds_read_b128 a[156:159], v10 offset:45312
  v_mfma_f32_16x16x32_bf16 v[76:79], a[132:135], a[60:63], v[76:79]
  buffer_load_dwordx4 a[16:19], v12, s[8:11], s33 offen offset:2048
  v_mfma_f32_16x16x32_bf16 v[76:79], a[128:131], a[44:47], v[76:79]
  buffer_load_dwordx4 a[20:23], v12, s[8:11], s33 offen offset:2304
  s_waitcnt lgkmcnt(4)
  v_mfma_f32_16x16x32_bf16 v[84:87], a[136:139], a[36:39], v[84:87]
  ds_read_b128 a[128:131], v10 offset:31744
  v_mfma_f32_16x16x32_bf16 v[84:87], a[140:143], a[52:55], v[84:87]
  ds_read_b128 a[132:135], v10 offset:46080
  v_mfma_f32_16x16x32_bf16 v[92:95], a[140:143], a[60:63], v[92:95]
  buffer_load_dwordx4 a[24:27], v12, s[12:15], s33 offen offset:2048
  v_mfma_f32_16x16x32_bf16 v[92:95], a[136:139], a[44:47], v[92:95]
  buffer_load_dwordx4 a[28:31], v12, s[12:15], s33 offen offset:2304
  s_waitcnt lgkmcnt(4)
  v_mfma_f32_16x16x32_bf16 v[100:103], a[144:147], a[36:39], v[100:103]
  ds_read_b128 a[136:139], v10 offset:32000
  v_mfma_f32_16x16x32_bf16 v[100:103], a[148:151], a[52:55], v[100:103]
  ds_read_b128 a[140:143], v10 offset:46336
  v_mfma_f32_16x16x32_bf16 v[108:111], a[148:151], a[60:63], v[108:111]
  s_add_u32 m0, s35, 0
  s_nop 0
  buffer_load_dwordx4 v2, s[16:19], s34 offen offset:0 lds
  v_mfma_f32_16x16x32_bf16 v[108:111], a[144:147], a[44:47], v[108:111]
  s_waitcnt lgkmcnt(4)
  v_mfma_f32_16x16x32_bf16 v[116:119], a[152:155], a[36:39], v[116:119]
  ds_read_b128 a[144:147], v10 offset:32768
  v_mfma_f32_16x16x32_bf16 v[116:119], a[156:159], a[52:55], v[116:119]
  ds_read_b128 a[148:151], v10 offset:47104
  v_mfma_f32_16x16x32_bf16 v[124:127], a[156:159], a[60:63], v[124:127]
  buffer_load_dwordx4 v2, s[16:19], s34 offen offset:1024 lds
  v_mfma_f32_16x16x32_bf16 v[124:127], a[152:155], a[44:47], v[124:127]
  s_waitcnt lgkmcnt(4)
  v_mfma_f32_16x16x32_bf16 v[132:135], a[128:131], a[36:39], v[132:135]
  ds_read_b128 a[152:155], v10 offset:33024
  v_mfma_f32_16x16x32_bf16 v[132:135], a[132:135], a[52:55], v[132:135]
  ds_read_b128 a[156:159], v10 offset:47360
  v_mfma_f32_16x16x32_bf16 v[140:143], a[132:135], a[60:63], v[140:143]
  buffer_load_dwordx4 v2, s[16:19], s34 offen offset:2048 lds
  v_mfma_f32_16x16x32_bf16 v[140:143], a[128:131], a[44:47], v[140:143]
  s_waitcnt lgkmcnt(4)
  v_mfma_f32_16x16x32_bf16 v[148:151], a[136:139], a[36:39], v[148:151]
  ds_read_b128 a[128:131], v10 offset:33792
  v_mfma_f32_16x16x32_bf16 v[148:151], a[140:143], a[52:55], v[148:151]
  ds_read_b128 a[132:135], v10 offset:48128
  v_mfma_f32_16x16x32_bf16 v[156:159], a[140:143], a[60:63], v[156:159]
  buffer_load_dwordx4 v2, s[16:19], s34 offen offset:3072 lds
  v_mfma_f32_16x16x32_bf16 v[156:159], a[136:139], a[44:47], v[156:159]
  s_waitcnt lgkmcnt(4)
  v_mfma_f32_16x16x32_bf16 v[164:167], a[144:147], a[36:39], v[164:167]
  ds_read_b128 a[136:139], v10 offset:34048
  v_mfma_f32_16x16x32_bf16 v[164:167], a[148:151], a[52:55], v[164:167]
  ds_read_b128 a[140:143], v10 offset:48384
  v_mfma_f32_16x16x32_bf16 v[172:175], a[148:151], a[60:63], v[172:175]
  s_add_u32 m0, s35, 4096
  s_nop 0
  buffer_load_dwordx4 v3, s[16:19], s34 offen offset:0 lds
  v_mfma_f32_16x16x32_bf16 v[172:175], a[144:147], a[44:47], v[172:175]
  s_waitcnt lgkmcnt(4)
  v_mfma_f32_16x16x32_bf16 v[180:183], a[152:155], a[36:39], v[180:183]
  ds_read_b128 a[144:147], v10 offset:34816
  v_mfma_f32_16x16x32_bf16 v[180:183], a[156:159], a[52:55], v[180:183]
  ds_read_b128 a[148:151], v10 offset:49152
  v_mfma_f32_16x16x32_bf16 v[188:191], a[156:159], a[60:63], v[188:191]
  buffer_load_dwordx4 v3, s[16:19], s34 offen offset:1024 lds
  v_mfma_f32_16x16x32_bf16 v[188:191], a[152:155], a[44:47], v[188:191]
  s_waitcnt lgkmcnt(4)
  v_mfma_f32_16x16x32_bf16 v[196:199], a[128:131], a[36:39], v[196:199]
  ds_read_b128 a[152:155], v10 offset:35072
  v_mfma_f32_16x16x32_bf16 v[196:199], a[132:135], a[52:55], v[196:199]
  ds_read_b128 a[156:159], v10 offset:49408
  v_mfma_f32_16x16x32_bf16 v[204:207], a[132:135], a[60:63], v[204:207]
  buffer_load_dwordx4 v3, s[16:19], s34 offen offset:2048 lds
  s_add_u32 s34, s34, 28672
  v_mfma_f32_16x16x32_bf16 v[204:207], a[128:131], a[44:47], v[204:207]
  s_waitcnt vmcnt(39) lgkmcnt(0)
  s_barrier
  v_mfma_f32_16x16x32_bf16 v[212:215], a[136:139], a[36:39], v[212:215]
  ds_read_b128 a[128:131], v11 offset:0
  v_mfma_f32_16x16x32_bf16 v[212:215], a[140:143], a[52:55], v[212:215]
  ds_read_b128 a[132:135], v11 offset:14336
  v_mfma_f32_16x16x32_bf16 v[220:223], a[140:143], a[60:63], v[220:223]
  v_mfma_f32_16x16x32_bf16 v[220:223], a[136:139], a[44:47], v[220:223]
  s_waitcnt lgkmcnt(4)
  v_mfma_f32_16x16x32_bf16 v[228:231], a[144:147], a[36:39], v[228:231]
  ds_read_b128 a[136:139], v11 offset:256
  v_mfma_f32_16x16x32_bf16 v[228:231], a[148:151], a[52:55], v[228:231]
  ds_read_b128 a[140:143], v11 offset:14592
  v_mfma_f32_16x16x32_bf16 v[236:239], a[148:151], a[60:63], v[236:239]
  v_mfma_f32_16x16x32_bf16 v[236:239], a[144:147], a[44:47], v[236:239]
  s_waitcnt lgkmcnt(4)
  v_mfma_f32_16x16x32_bf16 v[244:247], a[152:155], a[36:39], v[244:247]
  ds_read_b128 a[144:147], v11 offset:1024
  v_mfma_f32_16x16x32_bf16 v[244:247], a[156:159], a[52:55], v[244:247]
  ds_read_b128 a[148:151], v11 offset:15360
  v_mfma_f32_16x16x32_bf16 v[252:255], a[156:159], a[60:63], v[252:255]
  v_mfma_f32_16x16x32_bf16 v[252:255], a[152:155], a[44:47], v[252:255]
  v_swap_b32 v10, v11
  s_mov_b32 s39, s35
  s_mov_b32 s35, s36
  s_mov_b32 s36, s39
  .p2align 3
g3_loop:
  s_waitcnt vmcnt(7) lgkmcnt(4)
  v_mfma_f32_16x16x32_bf16 v[32:35], a[128:131], a[0:3], v[32:35]
  ds_read_b128 a[152:155], v10 offset:1280
  v_mfma_f32_16x16x32_bf16 v[32:35], a[132:135], a[16:19], v[32:35]
  ds_read_b128 a[156:159], v10 offset:15616
  v_mfma_f32_16x16x32_bf16 v[36:39], a[132:135], a[20:23], v[36:39]
  s_add_u32 s33, s33, 0x1000
  buffer_load_dwordx4 a[32:35], v12, s[8:11], s33 offen offset:0
  v_mfma_f32_16x16x32_bf16 v[36:39], a[128:131], a[4:7], v[36:39]
  v_mfma_f32_16x16x32_bf16 v[40:43], a[128:131], a[8:11], v[40:43]
  v_mfma_f32_16x16x32_bf16 v[40:43], a[132:135], a[24:27], v[40:43]
  buffer_load_dwordx4 a[36:39], v12, s[8:11], s33 offen offset:256
  v_mfma_f32_16x16x32_bf16 v[44:47], a[132:135], a[28:31], v[44:47]
  v_mfma_f32_16x16x32_bf16 v[44:47], a[128:131], a[12:15], v[44:47]
  s_waitcnt lgkmcnt(4)
  s_cmp_eq_u32 s38, s47
  s_cbranch_scc1 bg_b0
bg_b0_r:
  v_mfma_f32_16x16x32_bf16 v[48:51], a[136:139], a[0:3], v[48:51]
  ds_read_b128 a[128:131], v10 offset:2048
  v_mfma_f32_16x16x32_bf16 v[48:51], a[140:143], a[16:19], v[48:51]
  ds_read_b128 a[132:135], v10 offset:16384
  v_mfma_f32_16x16x32_bf16 v[52:55], a[140:143], a[20:23], v[52:55]
  buffer_load_dwordx4 a[40:43], v12, s[12:15], s33 offen offset:0
  v_mfma_f32_16x16x32_bf16 v[52:55], a[136:139], a[4:7], v[52:55]
  v_mfma_f32_16x16x32_bf16 v[56:59], a[136:139], a[8:11], v[56:59]
  v_mfma_f32_16x16x32_bf16 v[56:59], a[140:143], a[24:27], v[56:59]
  buffer_load_dwordx4 a[44:47], v12, s[12:15], s33 offen offset:256
  v_mfma_f32_16x16x32_bf16 v[60:63], a[140:143], a[28:31], v[60:63]
  v_mfma_f32_16x16x32_bf16 v[60:63], a[136:139], a[12:15], v[60:63]
  s_waitcnt lgkmcnt(4)
  v_mfma_f32_16x16x32_bf16 v[64:67], a[144:147], a[0:3], v[64:67]
  ds_read_b128 a[136:139], v10 offset:2304
  v_mfma_f32_16x16x32_bf16 v[64:67], a[148:151], a[16:19], v[64:67]
  ds_read_b128 a[140:143], v10 offset:16640
  v_mfma_f32_16x16x32_bf16 v[68:71], a[148:151], a[20:23], v[68:71]
  buffer_load_dwordx4 a[48:51], v12, s[8:11], s33 offen offset:2048
  v_mfma_f32_16x16x32_bf16 v[68:71], a[144:147], a[4:7], v[68:71]
  v_mfma_f32_16x16x32_bf16 v[72:75], a[144:147], a[8:11], v[72:75]
  v_mfma_f32_16x16x32_bf16 v[72:75], a[148:151], a[24:27], v[72:75]
  buffer_load_dwordx4 a[52:55], v12, s[8:11], s33 offen offset:2304
  v_mfma_f32_16x16x32_bf16 v[76:79], a[148:151], a[28:31], v[76:79]
  v_mfma_f32_16x16x32_bf16 v[76:79], a[144:147], a[12:15], v[76:79]
  s_waitcnt lgkmcnt(4)
  v_mfma_f32_16x16x32_bf16 v[80:83], a[152:155], a[0:3], v[80:83]
  ds_read_b128 a[144:147], v10 offset:3072
  v_mfma_f32_16x16x32_bf16 v[80:83], a[156:159], a[16:19], v[80:83]
  ds_read_b128 a[148:151], v10 offset:17408
  v_mfma_f32_16x16x32_bf16 v[84:87], a[156:159], a[20:23], v[84:87]
  buffer_load_dwordx4 a[56:59], v12, s[12:15], s33 offen offset:2048
  v_mfma_f32_16x16x32_bf16 v[84:87], a[152:155], a[4:7], v[84:87]
  v_mfma_f32_16x16x32_bf16 v[88:91], a[152:155], a[8:11], v[88:91]
  v_mfma_f32_16x16x32_bf16 v[88:91], a[156:159], a[24:27], v[88:91]
  buffer_load_dwordx4 a[60:63], v12, s[12:15], s33 offen offset:2304
  v_mfma_f32_16x16x32_bf16 v[92:95], a[156:159], a[28:31], v[92:95]
  v_mfma_f32_16x16x32_bf16 v[92:95], a[152:155], a[12:15], v[92:95]
  s_waitcnt lgkmcnt(4)
  s_cmp_eq_u32 s38, s46
  s_cbranch_scc1 bg_a0
bg_a0_r:
  v_mfma_f32_16x16x32_bf16 v[96:99], a[128:131], a[0:3], v[96:99]
  ds_read_b128 a[152:155], v10 offset:3328
  v_mfma_f32_16x16x32_bf16 v[96:99], a[132:135], a[16:19], v[96:99]
  ds_read_b128 a[156:159], v10 offset:17664
  v_mfma_f32_16x16x32_bf16 v[100:103], a[132:135], a[20:23], v[100:103]
  s_add_u32 m0, s36, 28672
  s_nop 0
  buffer_load_dwordx4 v2, s[16:19], s34 offen offset:0 lds
  v_mfma_f32_16x16x32_bf16 v[100:103], a[128:131], a[4:7], v[100:103]
  v_mfma_f32_16x16x32_bf16 v[104:107], a[128:131], a[8:11], v[104:107]
  v_mfma_f32_16x16x32_bf16 v[104:107], a[132:135], a[24:27], v[104:107]
  v_mfma_f32_16x16x32_bf16 v[108:111], a[132:135], a[28:31], v[108:111]
  v_mfma_f32_16x16x32_bf16 v[108:111], a[128:131], a[12:15], v[108:111]
  s_waitcnt lgkmcnt(4)
  s_cmp_eq_u32 s38, s47
  s_cbranch_scc1 bg_c0
bg_c0_r:
  v_mfma_f32_16x16x32_bf16 v[112:115], a[136:139], a[0:3], v[112:115]
  ds_read_b128 a[128:131], v10 offset:4096
  v_mfma_f32_16x16x32_bf16 v[112:115], a[140:143], a[16:19], v[112:115]
  ds_read_b128 a[132:135], v10 offset:18432
  v_mfma_f32_16x16x32_bf16 v[116:119], a[140:143], a[20:23], v[116:119]
  buffer_load_dwordx4 v2, s[16:19], s34 offen offset:1024 lds
  v_mfma_f32_16x16x32_bf16 v[116:119], a[136:139], a[4:7], v[116:119]
  v_mfma_f32_16x16x32_bf16 v[120:123], a[136:139], a[8:11], v[120:123]
  v_mfma_f32_16x16x32_bf16 v[120:123], a[140:143], a[24:27], v[120:123]
  v_mfma_f32_16x16x32_bf16 v[124:127], a[140:143], a[28:31], v[124:127]
  v_mfma_f32_16x16x32_bf16 v[124:127], a[136:139], a[12:15], v[124:127]
  s_waitcnt lgkmcnt(4)
  v_mfma_f32_16x16x32_bf16 v[128:131], a[144:147], a[0:3], v[128:131]
  ds_read_b128 a[136:139], v10 offset:4352
  v_mfma_f32_16x16x32_bf16 v[128:131], a[148:151], a[16:19], v[128:131]
  ds_read_b128 a[140:143], v10 offset:18688
  v_mfma_f32_16x16x32_bf16 v[132:135], a[148:151], a[20:23], v[132:135]
  buffer_load_dwordx4 v2, s[16:19], s34 offen offset:2048 lds
  v_mfma_f32_16x16x32_bf16 v[132:135], a[144:147], a[4:7], v[132:135]
  v_mfma_f32_16x16x32_bf16 v[136:139], a[144:147], a[8:11], v[136:139]
  v_mfma_f32_16x16x32_bf16 v[136:139], a[148:151], a[24:27], v[136:139]
  v_mfma_f32_16x16x32_bf16 v[140:143], a[148:151], a[28:31], v[140:143]
  v_mfma_f32_16x16x32_bf16 v[140:143], a[144:147], a[12:15], v[140:143]
  s_waitcnt lgkmcnt(4)
  v_mfma_f32_16x16x32_bf16 v[144:147], a[152:155], a[0:3], v[144:147]
  ds_read_b128 a[144:147], v10 offset:5120
  v_mfma_f32_16x16x32_bf16 v[144:147], a[156:159], a[16:19], v[144:147]
  ds_read_b128 a[148:151], v10 offset:19456
  v_mfma_f32_16x16x32_bf16 v[148:151], a[156:159], a[20:23], v[148:151]
  buffer_load_dwordx4 v2, s[16:19], s34 offen offset:3072 lds
  v_mfma_f32_16x16x32_bf16 v[148:151], a[152:155], a[4:7], v[148:151]
  v_mfma_f32_16x16x32_bf16 v[152:155], a[152:155], a[8:11], v[152:155]
  v_mfma_f32_16x16x32_bf16 v[152:155], a[156:159], a[24:27], v[152:155]
  v_mfma_f32_16x16x32_bf16 v[156:159], a[156:159], a[28:31], v[156:159]
  v_mfma_f32_16x16x32_bf16 v[156:159], a[152:155], a[12:15], v[156:159]
  s_waitcnt lgkmcnt(4)
  v_mfma_f32_16x16x32_bf16 v[160:163], a[128:131], a[0:3], v[160:163]
  ds_read_b128 a[152:155], v10 offset:5376
  v_mfma_f32_16x16x32_bf16 v[160:163], a[132:135], a[16:19], v[160:163]
  ds_read_b128 a[156:159], v10 offset:19712
  v_mfma_f32_16x16x32_bf16 v[164:167], a[132:135], a[20:23], v[164:167]
  s_add_u32 m0, s36, 32768
  s_nop 0
  buffer_load_dwordx4 v3, s[16:19], s34 offen offset:0 lds
  v_mfma_f32_16x16x32_bf16 v[164:167], a[128:131], a[4:7], v[164:167]
  v_mfma_f32_16x16x32_bf16 v[168:171], a[128:131], a[8:11], v[168:171]
  v_mfma_f32_16x16x32_bf16 v[168:171], a[132:135], a[24:27], v[168:171]
  v_mfma_f32_16x16x32_bf16 v[172:175], a[132:135], a[28:31], v[172:175]
  v_mfma_f32_16x16x32_bf16 v[172:175], a[128:131], a[12:15], v[172:175]
  s_waitcnt lgkmcnt(4)
  v_mfma_f32_16x16x32_bf16 v[176:179], a[136:139], a[0:3], v[176:179]
  ds_read_b128 a[128:131], v10 offset:6144
  v_mfma_f32_16x16x32_bf16 v[176:179], a[140:143], a[16:19], v[176:179]
  ds_read_b128 a[132:135], v10 offset:20480
  v_mfma_f32_16x16x32_bf16 v[180:183], a[140:143], a[20:23], v[180:183]
  buffer_load_dwordx4 v3, s[16:19], s34 offen offset:1024 lds
  v_mfma_f32_16x16x32_bf16 v[180:183], a[136:139], a[4:7], v[180:183]
  v_mfma_f32_16x16x32_bf16 v[184:187], a[136:139], a[8:11], v[184:187]
  v_mfma_f32_16x16x32_bf16 v[184:187], a[140:143], a[24:27], v[184:187]
  v_mfma_f32_16x16x32_bf16 v[188:191], a[140:143], a[28:31], v[188:191]
  v_mfma_f32_16x16x32_bf16 v[188:191], a[136:139], a[12:15], v[188:191]
  s_waitcnt lgkmcnt(4)
  v_mfma_f32_16x16x32_bf16 v[192:195], a[144:147], a[0:3], v[192:195]
  ds_read_b128 a[136:139], v10 offset:6400
  v_mfma_f32_16x16x32_bf16 v[192:195], a[148:151], a[16:19], v[192:195]
  ds_read_b128 a[140:143], v10 offset:20736
  v_mfma_f32_16x16x32_bf16 v[196:199], a[148:151], a[20:23], v[196:199]
  buffer_load_dwordx4 v3, s[16:19], s34 offen offset:2048 lds
  s_add_u32 s34, s34, 28672
  v_mfma_f32_16x16x32_bf16 v[196:199], a[144:147], a[4:7], v[196:199]
  v_mfma_f32_16x16x32_bf16 v[200:203], a[144:147], a[8:11], v[200:203]
  v_mfma_f32_16x16x32_bf16 v[200:203], a[148:151], a[24:27], v[200:203]
  v_mfma_f32_16x16x32_bf16 v[204:207], a[148:151], a[28:31], v[204:207]
  v_mfma_f32_16x16x32_bf16 v[204:207], a[144:147], a[12:15], v[204:207]
  s_waitcnt vmcnt(30) lgkmcnt(0)
  s_barrier
  s_cmp_eq_u32 s38, s40
  s_cbranch_scc1 bg_d
bg_d_r:
  v_mfma_f32_16x16x32_bf16 v[208:211], a[152:155], a[0:3], v[208:211]
  ds_read_b128 a[144:147], v10 offset:28672
  v_mfma_f32_16x16x32_bf16 v[208:211], a[156:159], a[16:19], v[208:211]
  ds_read_b128 a[148:151], v10 offset:43008
  v_mfma_f32_16x16x32_bf16 v[212:215], a[156:159], a[20:23], v[212:215]
  buffer_load_dwordx4 a[252:255], v1, s[84:87], s88 offen
  v_mfma_f32_16x16x32_bf16 v[212:215], a[152:155], a[4:7], v[212:215]
  v_mfma_f32_16x16x32_bf16 v[216:219], a[152:155], a[8:11], v[216:219]
  v_mfma_f32_16x16x32_bf16 v[216:219], a[156:159], a[24:27], v[216:219]
  v_mfma_f32_16x16x32_bf16 v[220:223], a[156:159], a[28:31], v[220:223]
  v_mfma_f32_16x16x32_bf16 v[220:223], a[152:155], a[12:15], v[220:223]
  s_waitcnt lgkmcnt(4)
  v_mfma_f32_16x16x32_bf16 v[224:227], a[128:131], a[0:3], v[224:227]
  ds_read_b128 a[152:155], v10 offset:28928
  v_mfma_f32_16x16x32_bf16 v[224:227], a[132:135], a[16:19], v[224:227]
  ds_read_b128 a[156:159], v10 offset:43264
  v_mfma_f32_16x16x32_bf16 v[228:231], a[132:135], a[20:23], v[228:231]
  v_mfma_f32_16x16x32_bf16 v[228:231], a[128:131], a[4:7], v[228:231]
  v_mfma_f32_16x16x32_bf16 v[232:235], a[128:131], a[8:11], v[232:235]
  v_mfma_f32_16x16x32_bf16 v[232:235], a[132:135], a[24:27], v[232:235]
  v_mfma_f32_16x16x32_bf16 v[236:239], a[132:135], a[28:31], v[236:239]
  v_mfma_f32_16x16x32_bf16 v[236:239], a[128:131], a[12:15], v[236:239]
  s_waitcnt lgkmcnt(4)
  v_mfma_f32_16x16x32_bf16 v[240:243], a[136:139], a[0:3], v[240:243]
  ds_read_b128 a[128:131], v10 offset:29696
  v_mfma_f32_16x16x32_bf16 v[240:243], a[140:143], a[16:19], v[240:243]
  ds_read_b128 a[132:135], v10 offset:44032
  v_mfma_f32_16x16x32_bf16 v[244:247], a[140:143], a[20:23], v[244:247]
  v_mfma_f32_16x16x32_bf16 v[244:247], a[136:139], a[4:7], v[244:247]
  v_mfma_f32_16x16x32_bf16 v[248:251], a[136:139], a[8:11], v[248:251]
  v_mfma_f32_16x16x32_bf16 v[248:251], a[140:143], a[24:27], v[248:251]
  v_mfma_f32_16x16x32_bf16 v[252:255], a[140:143], a[28:31], v[252:255]
  v_mfma_f32_16x16x32_bf16 v[252:255], a[136:139], a[12:15], v[252:255]
  s_waitcnt vmcnt(8) lgkmcnt(4)
  v_mfma_f32_16x16x32_bf16 v[32:35], a[144:147], a[32:35], v[32:35]
  ds_read_b128 a[136:139], v10 offset:29952
  v_mfma_f32_16x16x32_bf16 v[32:35], a[148:151], a[48:51], v[32:35]
  ds_read_b128 a[140:143], v10 offset:44288
  v_mfma_f32_16x16x32_bf16 v[36:39], a[148:151], a[52:55], v[36:39]
  s_add_u32 s33, s33, 0x1000
  buffer_load_dwordx4 a[0:3], v12, s[8:11], s33 offen offset:0
  v_mfma_f32_16x16x32_bf16 v[36:39], a[144:147], a[36:39], v[36:39]
  v_mfma_f32_16x16x32_bf16 v[40:43], a[144:147], a[40:43], v[40:43]
  v_mfma_f32_16x16x32_bf16 v[40:43], a[148:151], a[56:59], v[40:43]
  buffer_load_dwordx4 a[4:7], v12, s[8:11], s33 offen offset:256
  v_mfma_f32_16x16x32_bf16 v[44:47], a[148:151], a[60:63], v[44:47]
  v_mfma_f32_16x16x32_bf16 v[44:47], a[144:147], a[44:47], v[44:47]
  s_waitcnt lgkmcnt(4)
  s_cmp_eq_u32 s38, s47
  s_cbranch_scc1 bg_b1
bg_b1_r:
  v_mfma_f32_16x16x32_bf16 v[48:51], a[152:155], a[32:35], v[48:51]
  ds_read_b128 a[144:147], v10 offset:30720
  v_mfma_f32_16x16x32_bf16 v[48:51], a[156:159], a[48:51], v[48:51]
  ds_read_b128 a[148:151], v10 offset:45056
  v_mfma_f32_16x16x32_bf16 v[52:55], a[156:159], a[52:55], v[52:55]
  buffer_load_dwordx4 a[8:11], v12, s[12:15], s33 offen offset:0
  v_mfma_f32_16x16x32_bf16 v[52:55], a[152:155], a[36:39], v[52:55]
  v_mfma_f32_16x16x32_bf16 v[56:59], a[152:155], a[40:43], v[56:59]
  v_mfma_f32_16x16x32_bf16 v[56:59], a[156:159], a[56:59], v[56:59]
  buffer_load_dwordx4 a[12:15], v12, s[12:15], s33 offen offset:256
  v_mfma_f32_16x16x32_bf16 v[60:63], a[156:159], a[60:63], v[60:63]
  v_mfma_f32_16x16x32_bf16 v[60:63], a[152:155], a[44:47], v[60:63]
  s_waitcnt lgkmcnt(4)
  v_mfma_f32_16x16x32_bf16 v[64:67], a[128:131], a[32:35], v[64:67]
  ds_read_b128 a[152:155], v10 offset:30976
  v_mfma_f32_16x16x32_bf16 v[64:67], a[132:135], a[48:51], v[64:67]
  ds_read_b128 a[156:159], v10 offset:45312
  v_mfma_f32_16x16x32_bf16 v[68:71], a[132:135], a[52:55], v[68:71]
  buffer_load_dwordx4 a[16:19], v12, s[8:11], s33 offen offset:2048
  v_mfma_f32_16x16x32_bf16 v[68:71], a[128:131], a[36:39], v[68:71]
  v_mfma_f32_16x16x32_bf16 v[72:75], a[128:131], a[40:43], v[72:75]
  v_mfma_f32_16x16x32_bf16 v[72:75], a[132:135], a[56:59], v[72:75]
  buffer_load_dwordx4 a[20:23], v12, s[8:11], s33 offen offset:2304
  v_mfma_f32_16x16x32_bf16 v[76:79], a[132:135], a[60:63], v[76:79]
  v_mfma_f32_16x16x32_bf16 v[76:79], a[128:131], a[44:47], v[76:79]
  s_waitcnt lgkmcnt(4)
  v_mfma_f32_16x16x32_bf16 v[80:83], a[136:139], a[32:35], v[80:83]
  ds_read_b128 a[128:131], v10 offset:31744
  v_mfma_f32_16x16x32_bf16 v[80:83], a[140:143], a[48:51], v[80:83]
  ds_read_b128 a[132:135], v10 offset:46080
  v_mfma_f32_16x16x32_bf16 v[84:87], a[140:143], a[52:55], v[84:87]
  buffer_load_dwordx4 a[24:27], v12, s[12:15], s33 offen offset:2048
  v_mfma_f32_16x16x32_bf16 v[84:87], a[136:139], a[36:39], v[84:87]
  v_mfma_f32_16x16x32_bf16 v[88:91], a[136:139], a[40:43], v[88:91]
  v_mfma_f32_16x16x32_bf16 v[88:91], a[140:143], a[56:59], v[88:91]
  buffer_load_dwordx4 a[28:31], v12, s[12:15], s33 offen offset:2304
  v_mfma_f32_16x16x32_bf16 v[92:95], a[140:143], a[60:63], v[92:95]
  v_mfma_f32_16x16x32_bf16 v[92:95], a[136:139], a[44:47], v[92:95]
  s_waitcnt lgkmcnt(4)
  s_cmp_eq_u32 s38, s46
  s_cbranch_scc1 bg_a1
bg_a1_r:
  v_mfma_f32_16x16x32_bf16 v[96:99], a[144:147], a[32:35], v[96:99]
  ds_read_b128 a[136:139], v10 offset:32000
  v_mfma_f32_16x16x32_bf16 v[96:99], a[148:151], a[48:51], v[96:99]
  ds_read_b128 a[140:143], v10 offset:46336
  v_mfma_f32_16x16x32_bf16 v[100:103], a[148:151], a[52:55], v[100:103]
  s_add_u32 m0, s35, 0
  s_nop 0
  buffer_load_dwordx4 v2, s[16:19], s34 offen offset:0 lds
  v_mfma_f32_16x16x32_bf16 v[100:103], a[144:147], a[36:39], v[100:103]
  v_mfma_f32_16x16x32_bf16 v[104:107], a[144:147], a[40:43], v[104:107]
  v_mfma_f32_16x16x32_bf16 v[104:107], a[148:151], a[56:59], v[104:107]
  v_mfma_f32_16x16x32_bf16 v[108:111], a[148:151], a[60:63], v[108:111]
  v_mfma_f32_16x16x32_bf16 v[108:111], a[144:147], a[44:47], v[108:111]
  s_waitcnt lgkmcnt(4)
  s_cmp_eq_u32 s38, s47
  s_cbranch_scc1 bg_c1
bg_c1_r:
  v_mfma_f32_16x16x32_bf16 v[112:115], a[152:155], a[32:35], v[112:115]
  ds_read_b128 a[144:147], v10 offset:32768
  v_mfma_f32_16x16x32_bf16 v[112:115], a[156:159], a[48:51], v[112:115]
  ds_read_b128 a[148:151], v10 offset:47104
  v_mfma_f32_16x16x32_bf16 v[116:119], a[156:159], a[52:55], v[116:119]
  buffer_load_dwordx4 v2, s[16:19], s34 offen offset:1024 lds
  v_mfma_f32_16x16x32_bf16 v[116:119], a[152:155], a[36:39], v[116:119]
  v_mfma_f32_16x16x32_bf16 v[120:123], a[152:155], a[40:43], v[120:123]
  v_mfma_f32_16x16x32_bf16 v[120:123], a[156:159], a[56:59], v[120:123]
  v_mfma_f32_16x16x32_bf16 v[124:127], a[156:159], a[60:63], v[124:127]
  v_mfma_f32_16x16x32_bf16 v[124:127], a[152:155], a[44:47], v[124:127]
  s_waitcnt lgkmcnt(4)
  v_mfma_f32_16x16x32_bf16 v[128:131], a[128:131], a[32:35], v[128:131]
  ds_read_b128 a[152:155], v10 offset:33024
  v_mfma_f32_16x16x32_bf16 v[128:131], a[132:135], a[48:51], v[128:131]
  ds_read_b128 a[156:159], v10 offset:47360
  v_mfma_f32_16x16x32_bf16 v[132:135], a[132:135], a[52:55], v[132:135]
  buffer_load_dwordx4 v2, s[16:19], s34 offen offset:2048 lds
  v_mfma_f32_16x16x32_bf16 v[132:135], a[128:131], a[36:39], v[132:135]
  v_mfma_f32_16x16x32_bf16 v[136:139], a[128:131], a[40:43], v[136:139]
  v_mfma_f32_16x16x32_bf16 v[136:139], a[132:135], a[56:59], v[136:139]
  v_mfma_f32_16x16x32_bf16 v[140:143], a[132:135], a[60:63], v[140:143]
  v_mfma_f32_16x16x32_bf16 v[140:143], a[128:131], a[44:47], v[140:143]
  s_waitcnt lgkmcnt(4)
  v_mfma_f32_16x16x32_bf16 v[144:147], a[136:139], a[32:35], v[144:147]
  ds_read_b128 a[128:131], v10 offset:33792
  v_mfma_f32_16x16x32_bf16 v[144:147], a[140:143], a[48:51], v[144:147]
  ds_read_b128 a[132:135], v10 offset:48128
  v_mfma_f32_16x16x32_bf16 v[148:151], a[140:143], a[52:55], v[148:151]
  buffer_load_dwordx4 v2, s[16:19], s34 offen offset:3072 lds
  v_mfma_f32_16x16x32_bf16 v[148:151], a[136:139], a[36:39], v[148:151]
  v_mfma_f32_16x16x32_bf16 v[152:155], a[136:139], a[40:43], v[152:155]
  v_mfma_f32_16x16x32_bf16 v[152:155], a[140:143], a[56:59], v[152:155]
  v_mfma_f32_16x16x32_bf16 v[156:159], a[140:143], a[60:63], v[156:159]
  v_mfma_f32_16x16x32_bf16 v[156:159], a[136:139], a[44:47], v[156:159]
  s_waitcnt lgkmcnt(4)
  v_mfma_f32_16x16x32_bf16 v[160:163], a[144:147], a[32:35], v[160:163]
  ds_read_b128 a[136:139], v10 offset:34048
  v_mfma_f32_16x16x32_bf16 v[160:163], a[148:151], a[48:51], v[160:163]
  ds_read_b128 a[140:143], v10 offset:48384
  v_mfma_f32_16x16x32_bf16 v[164:167], a[148:151], a[52:55], v[164:167]
  s_add_u32 m0, s35, 4096
  s_nop 0
  buffer_load_dwordx4 v3, s[16:19], s34 offen offset:0 lds
  v_mfma_f32_16x16x32_bf16 v[164:167], a[144:147], a[36:39], v[164:167]
  v_mfma_f32_16x16x32_bf16 v[168:171], a[144:147], a[40:43], v[168:171]
  v_mfma_f32_16x16x32_bf16 v[168:171], a[148:151], a[56:59], v[168:171]
  v_mfma_f32_16x16x32_bf16 v[172:175], a[148:151], a[60:63], v[172:175]
  v_mfma_f32_16x16x32_bf16 v[172:175], a[144:147], a[44:47], v[172:175]
  s_waitcnt lgkmcnt(4)
  v_mfma_f32_16x16x32_bf16 v[176:179], a[152:155], a[32:35], v[176:179]
  ds_read_b128 a[144:147], v10 offset:34816
  v_mfma_f32_16x16x32_bf16 v[176:179], a[156:159], a[48:51], v[176:179]
  ds_read_b128 a[148:151], v10 offset:49152
  v_mfma_f32_16x16x32_bf16 v[180:183], a[156:159], a[52:55], v[180:183]
  buffer_load_dwordx4 v3, s[16:19], s34 offen offset:1024 lds
  v_mfma_f32_16x16x32_bf16 v[180:183], a[152:155], a[36:39], v[180:183]
  v_mfma_f32_16x16x32_bf16 v[184:187], a[152:155], a[40:43], v[184:187]
  v_mfma_f32_16x16x32_bf16 v[184:187], a[156:159], a[56:59], v[184:187]
  v_mfma_f32_16x16x32_bf16 v[188:191], a[156:159], a[60:63], v[188:191]
  v_mfma_f32_16x16x32_bf16 v[188:191], a[152:155], a[44:47], v[188:191]
  s_waitcnt lgkmcnt(4)
  v_mfma_f32_16x16x32_bf16 v[192:195], a[128:131], a[32:35], v[192:195]
  ds_read_b128 a[152:155], v10 offset:35072
  v_mfma_f32_16x16x32_bf16 v[192:195], a[132:135], a[48:51], v[192:195]
  ds_read_b128 a[156:159], v10 offset:49408
  v_mfma_f32_16x16x32_bf16 v[196:199], a[132:135], a[52:55], v[196:199]
  buffer_load_dwordx4 v3, s[16:19], s34 offen offset:2048 lds
  s_add_u32 s34, s34, 28672
  v_mfma_f32_16x16x32_bf16 v[196:199], a[128:131], a[36:39], v[196:199]
  v_mfma_f32_16x16x32_bf16 v[200:203], a[128:131], a[40:43], v[200:203]
  v_mfma_f32_16x16x32_bf16 v[200:203], a[132:135], a[56:59], v[200:203]
  v_mfma_f32_16x16x32_bf16 v[204:207], a[132:135], a[60:63], v[204:207]
  v_mfma_f32_16x16x32_bf16 v[204:207], a[128:131], a[44:47], v[204:207]
  s_waitcnt vmcnt(31) lgkmcnt(0)
  s_barrier
  v_mfma_f32_16x16x32_bf16 v[208:211], a[136:139], a[32:35], v[208:211]
  ds_read_b128 a[128:131], v11 offset:0
  v_mfma_f32_16x16x32_bf16 v[208:211], a[140:143], a[48:51], v[208:211]
  ds_read_b128 a[132:135], v11 offset:14336
  v_mfma_f32_16x16x32_bf16 v[212:215], a[140:143], a[52:55], v[212:215]
  buffer_store_dwordx4 a[248:251], v1, s[96:99], s95 offen sc1
  s_add_u32 s95, s95, 0x400
  v_mfma_f32_16x16x32_bf16 v[212:215], a[136:139], a[36:39], v[212:215]
  v_mfma_f32_16x16x32_bf16 v[216:219], a[136:139], a[40:43], v[216:219]
  v_mfma_f32_16x16x32_bf16 v[216:219], a[140:143], a[56:59], v[216:219]
  v_mfma_f32_16x16x32_bf16 v[220:223], a[140:143], a[60:63], v[220:223]
  v_mfma_f32_16x16x32_bf16 v[220:223], a[136:139], a[44:47], v[220:223]
  s_waitcnt lgkmcnt(4)
  v_mfma_f32_16x16x32_bf16 v[224:227], a[144:147], a[32:35], v[224:227]
  ds_read_b128 a[136:139], v11 offset:256
  v_mfma_f32_16x16x32_bf16 v[224:227], a[148:151], a[48:51], v[224:227]
  ds_read_b128 a[140:143], v11 offset:14592
  v_mfma_f32_16x16x32_bf16 v[228:231], a[148:151], a[52:55], v[228:231]
  v_mfma_f32_16x16x32_bf16 v[228:231], a[144:147], a[36:39], v[228:231]
  v_mfma_f32_16x16x32_bf16 v[232:235], a[144:147], a[40:43], v[232:235]
  v_mfma_f32_16x16x32_bf16 v[232:235], a[148:151], a[56:59], v[232:235]
  v_mfma_f32_16x16x32_bf16 v[236:239], a[148:151], a[60:63], v[236:239]
  v_mfma_f32_16x16x32_bf16 v[236:239], a[144:147], a[44:47], v[236:239]
  s_waitcnt lgkmcnt(4)
  v_mfma_f32_16x16x32_bf16 v[240:243], a[152:155], a[32:35], v[240:243]
  ds_read_b128 a[144:147], v11 offset:1024
  v_mfma_f32_16x16x32_bf16 v[240:243], a[156:159], a[48:51], v[240:243]
  ds_read_b128 a[148:151], v11 offset:15360
  v_mfma_f32_16x16x32_bf16 v[244:247], a[156:159], a[52:55], v[244:247]
  v_mfma_f32_16x16x32_bf16 v[244:247], a[152:155], a[36:39], v[244:247]
  v_mfma_f32_16x16x32_bf16 v[248:251], a[152:155], a[40:43], v[248:251]
  v_mfma_f32_16x16x32_bf16 v[248:251], a[156:159], a[56:59], v[248:251]
  v_mfma_f32_16x16x32_bf16 v[252:255], a[156:159], a[60:63], v[252:255]
  v_mfma_f32_16x16x32_bf16 v[252:255], a[152:155], a[44:47], v[252:255]
  v_swap_b32 v10, v11
  s_mov_b32 s39, s35
  s_mov_b32 s35, s36
  s_mov_b32 s36, s39
  s_sub_u32 s38, s38, 1
  s_cmp_lg_u32 s38, 0
  s_cbranch_scc1 g3_loop
  s_waitcnt vmcnt(8) lgkmcnt(4)
  v_mfma_f32_16x16x32_bf16 v[32:35], a[128:131], a[0:3], v[32:35]
  ds_read_b128 a[152:155], v10 offset:1280
  v_mul_f32 v16, 981467136, v16
  v_mul_f32 v20, 981467136, v20
  v_fma_f32 v20, -v16, v16, v20
  v_mfma_f32_16x16x32_bf16 v[32:35], a[132:135], a[16:19], v[32:35]
  ds_read_b128 a[156:159], v10 offset:15616
  v_max_f32 v20, 0, v20
  v_cvt_pk_bf16_f32 v9, v16, v20
  v_mfma_f32_16x16x32_bf16 v[36:39], a[132:135], a[20:23], v[36:39]
  s_add_u32 s33, s33, 0x1000
  buffer_load_dwordx4 a[32:35], v12, s[8:11], s33 offen offset:0
  v_lshlrev_b32 v16, 16, v9
  v_and_b32 v20, 0xffff0000, v9
  v_mfma_f32_16x16x32_bf16 v[36:39], a[128:131], a[4:7], v[36:39]
  v_add_f32 v20, 925353388, v20
  v_cvt_pk_bf16_f32 v9, v20, v20
  v_mfma_f32_16x16x32_bf16 v[40:43], a[128:131], a[8:11], v[40:43]
  v_lshlrev_b32 v20, 16, v9
  v_sqrt_f32 v20, v20
  v_mfma_f32_16x16x32_bf16 v[40:43], a[132:135], a[24:27], v[40:43]
  buffer_load_dwordx4 a[36:39], v12, s[8:11], s33 offen offset:256
  v_cvt_pk_bf16_f32 v9, v20, v20
  v_lshlrev_b32 v20, 16, v9
  v_mfma_f32_16x16x32_bf16 v[44:47], a[132:135], a[28:31], v[44:47]
  v_rcp_f32 v24, v20
  v_sub_f32 v16, 0, v16
  v_mfma_f32_16x16x32_bf16 v[44:47], a[128:131], a[12:15], v[44:47]
  v_mul_f32 v20, v20, v20
  v_mul_f32 v24, 3216550459, v24
  s_waitcnt lgkmcnt(4)
  v_mfma_f32_16x16x32_bf16 v[48:51], a[136:139], a[0:3], v[48:51]
  ds_read_b128 a[128:131], v10 offset:2048
  v_mul_f32 v17, 981467136, v17
  v_mul_f32 v21, 981467136, v21
  v_fma_f32 v21, -v17, v17, v21
  v_mfma_f32_16x16x32_bf16 v[48:51], a[140:143], a[16:19], v[48:51]
  ds_read_b128 a[132:135], v10 offset:16384
  v_max_f32 v21, 0, v21
  v_cvt_pk_bf16_f32 v9, v17, v21
  v_mfma_f32_16x16x32_bf16 v[52:55], a[140:143], a[20:23], v[52:55]
  buffer_load_dwordx4 a[40:43], v12, s[12:15], s33 offen offset:0
  v_lshlrev_b32 v17, 16, v9
  v_and_b32 v21, 0xffff0000, v9
  v_mfma_f32_16x16x32_bf16 v[52:55], a[136:139], a[4:7], v[52:55]
  v_add_f32 v21, 925353388, v21
  v_cvt_pk_bf16_f32 v9, v21, v21
  v_mfma_f32_16x16x32_bf16 v[56:59], a[136:139], a[8:11], v[56:59]
  v_lshlrev_b32 v21, 16, v9
  v_sqrt_f32 v21, v21
  v_mfma_f32_16x16x32_bf16 v[56:59], a[140:143], a[24:27], v[56:59]
  buffer_load_dwordx4 a[44:47], v12, s[12:15], s33 offen offset:256
  v_cvt_pk_bf16_f32 v9, v21, v21
  v_lshlrev_b32 v21, 16, v9
  v_mfma_f32_16x16x32_bf16 v[60:63], a[140:143], a[28:31], v[60:63]
  v_rcp_f32 v25, v21
  v_sub_f32 v17, 0, v17
  v_mfma_f32_16x16x32_bf16 v[60:63], a[136:139], a[12:15], v[60:63]
  v_mul_f32 v21, v21, v21
  v_mul_f32 v25, 3216550459, v25
  s_waitcnt lgkmcnt(4)
  v_mfma_f32_16x16x32_bf16 v[64:67], a[144:147], a[0:3], v[64:67]
  ds_read_b128 a[136:139], v10 offset:2304
  v_mul_f32 v18, 981467136, v18
  v_mul_f32 v22, 981467136, v22
  v_fma_f32 v22, -v18, v18, v22
  v_mfma_f32_16x16x32_bf16 v[64:67], a[148:151], a[16:19], v[64:67]
  ds_read_b128 a[140:143], v10 offset:16640
  v_max_f32 v22, 0, v22
  v_cvt_pk_bf16_f32 v9, v18, v22
  v_mfma_f32_16x16x32_bf16 v[68:71], a[148:151], a[20:23], v[68:71]
  buffer_load_dwordx4 a[48:51], v12, s[8:11], s33 offen offset:2048
  v_lshlrev_b32 v18, 16, v9
  v_and_b32 v22, 0xffff0000, v9
  ds_read_b128 v[4:7], v14 offset:3776
  v_mfma_f32_16x16x32_bf16 v[68:71], a[144:147], a[4:7], v[68:71]
  v_add_f32 v22, 925353388, v22
  v_cvt_pk_bf16_f32 v9, v22, v22
  v_mfma_f32_16x16x32_bf16 v[72:75], a[144:147], a[8:11], v[72:75]
  v_lshlrev_b32 v22, 16, v9
  v_sqrt_f32 v22, v22
  v_mfma_f32_16x16x32_bf16 v[72:75], a[148:151], a[24:27], v[72:75]
  buffer_load_dwordx4 a[52:55], v12, s[8:11], s33 offen offset:2304
  v_cvt_pk_bf16_f32 v9, v22, v22
  v_lshlrev_b32 v22, 16, v9
  v_mfma_f32_16x16x32_bf16 v[76:79], a[148:151], a[28:31], v[76:79]
  v_rcp_f32 v26, v22
  v_sub_f32 v18, 0, v18
  v_mfma_f32_16x16x32_bf16 v[76:79], a[144:147], a[12:15], v[76:79]
  v_mul_f32 v22, v22, v22
  v_mul_f32 v26, 3216550459, v26
  s_waitcnt lgkmcnt(5)
  v_mfma_f32_16x16x32_bf16 v[80:83], a[152:155], a[0:3], v[80:83]
  ds_read_b128 a[144:147], v10 offset:3072
  v_mul_f32 v19, 981467136, v19
  v_mul_f32 v23, 981467136, v23
  v_fma_f32 v23, -v19, v19, v23
  v_mfma_f32_16x16x32_bf16 v[80:83], a[156:159], a[16:19], v[80:83]
  ds_read_b128 a[148:151], v10 offset:17408
  v_max_f32 v23, 0, v23
  v_cvt_pk_bf16_f32 v9, v19, v23
  v_mfma_f32_16x16x32_bf16 v[84:87], a[156:159], a[20:23], v[84:87]
  buffer_load_dwordx4 a[56:59], v12, s[12:15], s33 offen offset:2048
  v_lshlrev_b32 v19, 16, v9
  v_and_b32 v23, 0xffff0000, v9
  v_mfma_f32_16x16x32_bf16 v[84:87], a[152:155], a[4:7], v[84:87]
  v_add_f32 v23, 925353388, v23
  v_cvt_pk_bf16_f32 v9, v23, v23
  v_mfma_f32_16x16x32_bf16 v[88:91], a[152:155], a[8:11], v[88:91]
  v_lshlrev_b32 v23, 16, v9
  v_sqrt_f32 v23, v23
  v_mfma_f32_16x16x32_bf16 v[88:91], a[156:159], a[24:27], v[88:91]
  buffer_load_dwordx4 a[60:63], v12, s[12:15], s33 offen offset:2304
  v_cvt_pk_bf16_f32 v9, v23, v23
  v_lshlrev_b32 v23, 16, v9
  v_mfma_f32_16x16x32_bf16 v[92:95], a[156:159], a[28:31], v[92:95]
  v_rcp_f32 v27, v23
  v_sub_f32 v19, 0, v19
  v_mfma_f32_16x16x32_bf16 v[92:95], a[152:155], a[12:15], v[92:95]
  v_mul_f32 v23, v23, v23
  v_mul_f32 v27, 3216550459, v27
  s_waitcnt lgkmcnt(5)
  v_mfma_f32_16x16x32_bf16 v[96:99], a[128:131], a[0:3], v[96:99]
  s_waitcnt lgkmcnt(2)
  ds_read_b128 a[152:155], v10 offset:3328
  v_fmac_f32 v208, v16, v4
  v_mfma_f32_16x16x32_bf16 v[96:99], a[132:135], a[16:19], v[96:99]
  ds_read_b128 a[156:159], v10 offset:17664
  v_fmac_f32 v209, v16, v5
  v_mfma_f32_16x16x32_bf16 v[100:103], a[132:135], a[20:23], v[100:103]
  s_add_u32 m0, s36, 28672
  s_nop 0
  buffer_load_dwordx4 v2, s[16:19], s34 offen offset:0 lds
  v_fmac_f32 v210, v16, v6
  ds_read_b128 v[28:31], v14 offset:3904
  v_mfma_f32_16x16x32_bf16 v[100:103], a[128:131], a[4:7], v[100:103]
  v_fmac_f32 v211, v16, v7
  v_mfma_f32_16x16x32_bf16 v[104:107], a[128:131], a[8:11], v[104:107]
  v_fmac_f32 v212, v17, v4
  v_mfma_f32_16x16x32_bf16 v[104:107], a[132:135], a[24:27], v[104:107]
  buffer_load_dwordx4 v2, s[16:19], s34 offen offset:1024 lds
  v_fmac_f32 v213, v17, v5
  v_mfma_f32_16x16x32_bf16 v[108:111], a[132:135], a[28:31], v[108:111]
  v_fmac_f32 v214, v17, v6
  v_mfma_f32_16x16x32_bf16 v[108:111], a[128:131], a[12:15], v[108:111]
  v_fmac_f32 v215, v17, v7
  s_waitcnt lgkmcnt(6)
  v_mfma_f32_16x16x32_bf16 v[112:115], a[136:139], a[0:3], v[112:115]
  ds_read_b128 a[128:131], v10 offset:4096
  v_fmac_f32 v216, v18, v4
  v_mfma_f32_16x16x32_bf16 v[112:115], a[140:143], a[16:19], v[112:115]
  ds_read_b128 a[132:135], v10 offset:18432
  v_fmac_f32 v217, v18, v5
  v_mfma_f32_16x16x32_bf16 v[116:119], a[140:143], a[20:23], v[116:119]
  buffer_load_dwordx4 v2, s[16:19], s34 offen offset:2048 lds
  v_fmac_f32 v218, v18, v6
  v_mfma_f32_16x16x32_bf16 v[116:119], a[136:139], a[4:7], v[116:119]
  v_fmac_f32 v219, v18, v7
  v_mfma_f32_16x16x32_bf16 v[120:123], a[136:139], a[8:11], v[120:123]
  v_fmac_f32 v220, v19, v4
  v_mfma_f32_16x16x32_bf16 v[120:123], a[140:143], a[24:27], v[120:123]
  buffer_load_dwordx4 v2, s[16:19], s34 offen offset:3072 lds
  v_fmac_f32 v221, v19, v5
  v_mfma_f32_16x16x32_bf16 v[124:127], a[140:143], a[28:31], v[124:127]
  v_fmac_f32 v222, v19, v6
  v_mfma_f32_16x16x32_bf16 v[124:127], a[136:139], a[12:15], v[124:127]
  v_fmac_f32 v223, v19, v7
  s_waitcnt lgkmcnt(5)
  v_mfma_f32_16x16x32_bf16 v[128:131], a[144:147], a[0:3], v[128:131]
  s_waitcnt lgkmcnt(2)
  ds_read_b128 a[136:139], v10 offset:4352
  v_fmac_f32 v240, v16, v28
  v_mfma_f32_16x16x32_bf16 v[128:131], a[148:151], a[16:19], v[128:131]
  ds_read_b128 a[140:143], v10 offset:18688
  v_fmac_f32 v241, v16, v29
  v_mfma_f32_16x16x32_bf16 v[132:135], a[148:151], a[20:23], v[132:135]
  s_add_u32 m0, s36, 32768
  s_nop 0
  buffer_load_dwordx4 v3, s[16:19], s34 offen offset:0 lds
  v_fmac_f32 v242, v16, v30
  ds_read_b128 v[4:7], v14 offset:3136
  v_mfma_f32_16x16x32_bf16 v[132:135], a[144:147], a[4:7], v[132:135]
  v_fmac_f32 v243, v16, v31
  v_mfma_f32_16x16x32_bf16 v[136:139], a[144:147], a[8:11], v[136:139]
  v_fmac_f32 v244, v17, v28
  v_mfma_f32_16x16x32_bf16 v[136:139], a[148:151], a[24:27], v[136:139]
  buffer_load_dwordx4 v3, s[16:19], s34 offen offset:1024 lds
  v_fmac_f32 v245, v17, v29
  v_mfma_f32_16x16x32_bf16 v[140:143], a[148:151], a[28:31], v[140:143]
  v_fmac_f32 v246, v17, v30
  v_mfma_f32_16x16x32_bf16 v[140:143], a[144:147], a[12:15], v[140:143]
  v_fmac_f32 v247, v17, v31
  s_waitcnt lgkmcnt(6)
  v_mfma_f32_16x16x32_bf16 v[144:147], a[152:155], a[0:3], v[144:147]
  ds_read_b128 a[144:147], v10 offset:5120
  v_fmac_f32 v248, v18, v28
  v_mfma_f32_16x16x32_bf16 v[144:147], a[156:159], a[16:19], v[144:147]
  ds_read_b128 a[148:151], v10 offset:19456
  v_fmac_f32 v249, v18, v29
  v_mfma_f32_16x16x32_bf16 v[148:151], a[156:159], a[20:23], v[148:151]
  buffer_load_dwordx4 v3, s[16:19], s34 offen offset:2048 lds
  s_add_u32 s34, s34, 28672
  v_fmac_f32 v250, v18, v30
  v_mfma_f32_16x16x32_bf16 v[148:151], a[152:155], a[4:7], v[148:151]
  v_fmac_f32 v251, v18, v31
  v_mfma_f32_16x16x32_bf16 v[152:155], a[152:155], a[8:11], v[152:155]
  v_fmac_f32 v252, v19, v28
  v_mfma_f32_16x16x32_bf16 v[152:155], a[156:159], a[24:27], v[152:155]
  v_fmac_f32 v253, v19, v29
  v_mfma_f32_16x16x32_bf16 v[156:159], a[156:159], a[28:31], v[156:159]
  v_fmac_f32 v254, v19, v30
  v_mfma_f32_16x16x32_bf16 v[156:159], a[152:155], a[12:15], v[156:159]
  v_fmac_f32 v255, v19, v31
  s_waitcnt lgkmcnt(5)
  v_mfma_f32_16x16x32_bf16 v[160:163], a[128:131], a[0:3], v[160:163]
  s_waitcnt lgkmcnt(2)
  ds_read_b128 a[152:155], v10 offset:5376
  v_fmac_f32 v48, v16, v4
  v_mfma_f32_16x16x32_bf16 v[160:163], a[132:135], a[16:19], v[160:163]
  ds_read_b128 a[156:159], v10 offset:19712
  v_fmac_f32 v49, v16, v5
  v_mfma_f32_16x16x32_bf16 v[164:167], a[132:135], a[20:23], v[164:167]
  s_add_u32 s33, s33, 0x1000
  buffer_load_dwordx4 a[64:67], v12, s[8:11], s33 offen offset:0
  v_fmac_f32 v50, v16, v6
  ds_read_b128 v[28:31], v14 offset:3264
  v_mfma_f32_16x16x32_bf16 v[164:167], a[128:131], a[4:7], v[164:167]
  v_fmac_f32 v51, v16, v7
  v_mfma_f32_16x16x32_bf16 v[168:171], a[128:131], a[8:11], v[168:171]
  buffer_load_dwordx4 a[68:71], v12, s[8:11], s33 offen offset:256
  v_fmac_f32 v52, v17, v4
  v_mfma_f32_16x16x32_bf16 v[168:171], a[132:135], a[24:27], v[168:171]
  v_fmac_f32 v53, v17, v5
  v_mfma_f32_16x16x32_bf16 v[172:175], a[132:135], a[28:31], v[172:175]
  buffer_load_dwordx4 a[72:75], v12, s[12:15], s33 offen offset:0
  v_fmac_f32 v54, v17, v6
  v_mfma_f32_16x16x32_bf16 v[172:175], a[128:131], a[12:15], v[172:175]
  v_fmac_f32 v55, v17, v7
  s_waitcnt lgkmcnt(6)
  v_mfma_f32_16x16x32_bf16 v[176:179], a[136:139], a[0:3], v[176:179]
  ds_read_b128 a[128:131], v10 offset:6144
  v_fmac_f32 v56, v18, v4
  v_mfma_f32_16x16x32_bf16 v[176:179], a[140:143], a[16:19], v[176:179]
  ds_read_b128 a[132:135], v10 offset:20480
  v_fmac_f32 v57, v18, v5
  v_mfma_f32_16x16x32_bf16 v[180:183], a[140:143], a[20:23], v[180:183]
  buffer_load_dwordx4 a[76:79], v12, s[12:15], s33 offen offset:256
  v_fmac_f32 v58, v18, v6
  v_mfma_f32_16x16x32_bf16 v[180:183], a[136:139], a[4:7], v[180:183]
  v_fmac_f32 v59, v18, v7
  v_mfma_f32_16x16x32_bf16 v[184:187], a[136:139], a[8:11], v[184:187]
  buffer_load_dwordx4 a[80:83], v12, s[8:11], s33 offen offset:2048
  v_fmac_f32 v60, v19, v4
  v_mfma_f32_16x16x32_bf16 v[184:187], a[140:143], a[24:27], v[184:187]
  v_fmac_f32 v61, v19, v5
  v_mfma_f32_16x16x32_bf16 v[188:191], a[140:143], a[28:31], v[188:191]
  buffer_load_dwordx4 a[84:87], v12, s[8:11], s33 offen offset:2304
  v_fmac_f32 v62, v19, v6
  v_mfma_f32_16x16x32_bf16 v[188:191], a[136:139], a[12:15], v[188:191]
  v_fmac_f32 v63, v19, v7
  s_waitcnt lgkmcnt(5)
  v_mfma_f32_16x16x32_bf16 v[192:195], a[144:147], a[0:3], v[192:195]
  s_waitcnt lgkmcnt(2)
  ds_read_b128 a[136:139], v10 offset:6400
  v_fmac_f32 v80, v16, v28
  v_mfma_f32_16x16x32_bf16 v[192:195], a[148:151], a[16:19], v[192:195]
  ds_read_b128 a[140:143], v10 offset:20736
  v_fmac_f32 v81, v16, v29
  v_mfma_f32_16x16x32_bf16 v[196:199], a[148:151], a[20:23], v[196:199]
  buffer_load_dwordx4 a[88:91], v12, s[12:15], s33 offen offset:2048
  v_fmac_f32 v82, v16, v30
  ds_read_b128 v[4:7], v14 offset:3392
  v_mfma_f32_16x16x32_bf16 v[196:199], a[144:147], a[4:7], v[196:199]
  v_fmac_f32 v83, v16, v31
  v_mfma_f32_16x16x32_bf16 v[200:203], a[144:147], a[8:11], v[200:203]
  v_fmac_f32 v84, v17, v28
  v_mfma_f32_16x16x32_bf16 v[200:203], a[148:151], a[24:27], v[200:203]
  buffer_load_dwordx4 a[92:95], v12, s[12:15], s33 offen offset:2304
  v_fmac_f32 v85, v17, v29
  v_mfma_f32_16x16x32_bf16 v[204:207], a[148:151], a[28:31], v[204:207]
  v_fmac_f32 v86, v17, v30
  v_mfma_f32_16x16x32_bf16 v[204:207], a[144:147], a[12:15], v[204:207]
  v_fmac_f32 v87, v17, v31
  s_waitcnt vmcnt(40) lgkmcnt(0)
  s_barrier
  v_mfma_f32_16x16x32_bf16 v[208:211], a[152:155], a[0:3], v[208:211]
  ds_read_b128 a[144:147], v10 offset:28672
  v_fmac_f32 v88, v18, v28
  v_mfma_f32_16x16x32_bf16 v[208:211], a[156:159], a[16:19], v[208:211]
  ds_read_b128 a[148:151], v10 offset:43008
  v_fmac_f32 v89, v18, v29
  v_mfma_f32_16x16x32_bf16 v[212:215], a[156:159], a[20:23], v[212:215]
  s_add_u32 m0, s35, 0
  s_nop 0
  buffer_load_dwordx4 v2, s[16:19], s34 offen offset:0 lds
  v_fmac_f32 v90, v18, v30
  v_mfma_f32_16x16x32_bf16 v[212:215], a[152:155], a[4:7], v[212:215]
  v_fmac_f32 v91, v18, v31
  v_mfma_f32_16x16x32_bf16 v[216:219], a[152:155], a[8:11], v[216:219]
  v_fmac_f32 v92, v19, v28
  v_mfma_f32_16x16x32_bf16 v[216:219], a[156:159], a[24:27], v[216:219]
  buffer_load_dwordx4 v2, s[16:19], s34 offen offset:1024 lds
  v_fmac_f32 v93, v19, v29
  v_mfma_f32_16x16x32_bf16 v[220:223], a[156:159], a[28:31], v[220:223]
  v_fmac_f32 v94, v19, v30
  v_mfma_f32_16x16x32_bf16 v[220:223], a[152:155], a[12:15], v[220:223]
  v_fmac_f32 v95, v19, v31
  s_waitcnt lgkmcnt(5)
  v_mfma_f32_16x16x32_bf16 v[224:227], a[128:131], a[0:3], v[224:227]
  s_waitcnt lgkmcnt(2)
  ds_read_b128 a[152:155], v10 offset:28928
  v_fmac_f32 v112, v16, v4
  v_mfma_f32_16x16x32_bf16 v[224:227], a[132:135], a[16:19], v[224:227]
  ds_read_b128 a[156:159], v10 offset:43264
  v_fmac_f32 v113, v16, v5
  v_mfma_f32_16x16x32_bf16 v[228:231], a[132:135], a[20:23], v[228:231]
  buffer_load_dwordx4 v2, s[16:19], s34 offen offset:2048 lds
  v_fmac_f32 v114, v16, v6
  ds_read_b128 v[28:31], v14 offset:3520
  v_mfma_f32_16x16x32_bf16 v[228:231], a[128:131], a[4:7], v[228:231]
  v_fmac_f32 v115, v16, v7
  v_mfma_f32_16x16x32_bf16 v[232:235], a[128:131], a[8:11], v[232:235]
  v_fmac_f32 v116, v17, v4
  v_mfma_f32_16x16x32_bf16 v[232:235], a[132:135], a[24:27], v[232:235]
  buffer_load_dwordx4 v2, s[16:19], s34 offen offset:3072 lds
  v_fmac_f32 v117, v17, v5
  v_mfma_f32_16x16x32_bf16 v[236:239], a[132:135], a[28:31], v[236:239]
  v_fmac_f32 v118, v17, v6
  v_mfma_f32_16x16x32_bf16 v[236:239], a[128:131], a[12:15], v[236:239]
  v_fmac_f32 v119, v17, v7
  s_waitcnt lgkmcnt(6)
  v_mfma_f32_16x16x32_bf16 v[240:243], a[136:139], a[0:3], v[240:243]
  ds_read_b128 a[128:131], v10 offset:29696
  v_fmac_f32 v120, v18, v4
  v_mfma_f32_16x16x32_bf16 v[240:243], a[140:143], a[16:19], v[240:243]
  ds_read_b128 a[132:135], v10 offset:44032
  v_fmac_f32 v121, v18, v5
  v_mfma_f32_16x16x32_bf16 v[244:247], a[140:143], a[20:23], v[244:247]
  s_add_u32 m0, s35, 4096
  s_nop 0
  buffer_load_dwordx4 v3, s[16:19], s34 offen offset:0 lds
  v_fmac_f32 v122, v18, v6
  v_mfma_f32_16x16x32_bf16 v[244:247], a[136:139], a[4:7], v[244:247]
  v_fmac_f32 v123, v18, v7
  v_mfma_f32_16x16x32_bf16 v[248:251], a[136:139], a[8:11], v[248:251]
  v_fmac_f32 v124, v19, v4
  v_mfma_f32_16x16x32_bf16 v[248:251], a[140:143], a[24:27], v[248:251]
  buffer_load_dwordx4 v3, s[16:19], s34 offen offset:1024 lds
  v_fmac_f32 v125, v19, v5
  v_mfma_f32_16x16x32_bf16 v[252:255], a[140:143], a[28:31], v[252:255]
  v_fmac_f32 v126, v19, v6
  v_mfma_f32_16x16x32_bf16 v[252:255], a[136:139], a[12:15], v[252:255]
  v_fmac_f32 v127, v19, v7
  s_waitcnt vmcnt(21) lgkmcnt(5)
  v_mfma_f32_16x16x32_bf16 v[32:35], a[144:147], a[32:35], v[32:35]
  s_waitcnt lgkmcnt(2)
  ds_read_b128 a[136:139], v10 offset:29952
  v_fmac_f32 v144, v16, v28
  v_mfma_f32_16x16x32_bf16 v[32:35], a[148:151], a[48:51], v[32:35]
  ds_read_b128 a[140:143], v10 offset:44288
  v_fmac_f32 v145, v16, v29
  v_mfma_f32_16x16x32_bf16 v[36:39], a[148:151], a[52:55], v[36:39]
  buffer_load_dwordx4 v3, s[16:19], s34 offen offset:2048 lds
  s_add_u32 s34, s34, 28672
  v_fmac_f32 v146, v16, v30
  ds_read_b128 v[4:7], v14 offset:3648
  v_mfma_f32_16x16x32_bf16 v[36:39], a[144:147], a[36:39], v[36:39]
  v_fmac_f32 v147, v16, v31
  v_mfma_f32_16x16x32_bf16 v[40:43], a[144:147], a[40:43], v[40:43]
  v_fmac_f32 v148, v17, v28
  v_mfma_f32_16x16x32_bf16 v[40:43], a[148:151], a[56:59], v[40:43]
  v_fmac_f32 v149, v17, v29
  v_mfma_f32_16x16x32_bf16 v[44:47], a[148:151], a[60:63], v[44:47]
  v_fmac_f32 v150, v17, v30
  v_mfma_f32_16x16x32_bf16 v[44:47], a[144:147], a[44:47], v[44:47]
  v_fmac_f32 v151, v17, v31
  s_waitcnt lgkmcnt(6)
  v_mfma_f32_16x16x32_bf16 v[48:51], a[152:155], a[32:35], v[48:51]
  ds_read_b128 a[144:147], v10 offset:30720
  v_fmac_f32 v152, v18, v28
  v_mfma_f32_16x16x32_bf16 v[48:51], a[156:159], a[48:51], v[48:51]
  ds_read_b128 a[148:151], v10 offset:45056
  v_fmac_f32 v153, v18, v29
  v_mfma_f32_16x16x32_bf16 v[52:55], a[156:159], a[52:55], v[52:55]
  s_add_u32 s33, s33, 0x1000
  buffer_load_dwordx4 a[96:99], v12, s[8:11], s33 offen offset:0
  v_fmac_f32 v154, v18, v30
  v_mfma_f32_16x16x32_bf16 v[52:55], a[152:155], a[36:39], v[52:55]
  v_fmac_f32 v155, v18, v31
  v_mfma_f32_16x16x32_bf16 v[56:59], a[152:155], a[40:43], v[56:59]
  v_fmac_f32 v156, v19, v28
  v_mfma_f32_16x16x32_bf16 v[56:59], a[156:159], a[56:59], v[56:59]
  buffer_load_dwordx4 a[100:103], v12, s[8:11], s33 offen offset:256
  v_fmac_f32 v157, v19, v29
  v_mfma_f32_16x16x32_bf16 v[60:63], a[156:159], a[60:63], v[60:63]
  v_fmac_f32 v158, v19, v30
  v_mfma_f32_16x16x32_bf16 v[60:63], a[152:155], a[44:47], v[60:63]
  v_fmac_f32 v159, v19, v31
  s_waitcnt lgkmcnt(5)
  v_mfma_f32_16x16x32_bf16 v[64:67], a[128:131], a[32:35], v[64:67]
  s_waitcnt lgkmcnt(2)
  ds_read_b128 a[152:155], v10 offset:30976
  v_fmac_f32 v176, v16, v4
  v_mfma_f32_16x16x32_bf16 v[64:67], a[132:135], a[48:51], v[64:67]
  ds_read_b128 a[156:159], v10 offset:45312
  v_fmac_f32 v177, v16, v5
  v_mfma_f32_16x16x32_bf16 v[68:71], a[132:135], a[52:55], v[68:71]
  buffer_load_dwordx4 a[104:107], v12, s[12:15], s33 offen offset:0
  v_fmac_f32 v178, v16, v6
  ds_read_b128 v[28:31], v14 offset:3712
  v_mfma_f32_16x16x32_bf16 v[68:71], a[128:131], a[36:39], v[68:71]
  v_fmac_f32 v179, v16, v7
  v_mfma_f32_16x16x32_bf16 v[72:75], a[128:131], a[40:43], v[72:75]
  v_fmac_f32 v180, v17, v4
  v_mfma_f32_16x16x32_bf16 v[72:75], a[132:135], a[56:59], v[72:75]
  buffer_load_dwordx4 a[108:111], v12, s[12:15], s33 offen offset:256
  v_fmac_f32 v181, v17, v5
  v_mfma_f32_16x16x32_bf16 v[76:79], a[132:135], a[60:63], v[76:79]
  v_fmac_f32 v182, v17, v6
  v_mfma_f32_16x16x32_bf16 v[76:79], a[128:131], a[44:47], v[76:79]
  v_fmac_f32 v183, v17, v7
  s_waitcnt lgkmcnt(6)
  v_mfma_f32_16x16x32_bf16 v[80:83], a[136:139], a[32:35], v[80:83]
  ds_read_b128 a[128:131], v10 offset:31744
  v_fmac_f32 v184, v18, v4
  v_mfma_f32_16x16x32_bf16 v[80:83], a[140:143], a[48:51], v[80:83]
  ds_read_b128 a[132:135], v10 offset:46080
  v_fmac_f32 v185, v18, v5
  v_mfma_f32_16x16x32_bf16 v[84:87], a[140:143], a[52:55], v[84:87]
  buffer_load_dwordx4 a[112:115], v12, s[8:11], s33 offen offset:2048
  v_fmac_f32 v186, v18, v6
  v_mfma_f32_16x16x32_bf16 v[84:87], a[136:139], a[36:39], v[84:87]
  v_fmac_f32 v187, v18, v7
  v_mfma_f32_16x16x32_bf16 v[88:91], a[136:139], a[40:43], v[88:91]
  v_fmac_f32 v188, v19, v4
  v_mfma_f32_16x16x32_bf16 v[88:91], a[140:143], a[56:59], v[88:91]
  buffer_load_dwordx4 a[116:119], v12, s[8:11], s33 offen offset:2304
  v_fmac_f32 v189, v19, v5
  v_mfma_f32_16x16x32_bf16 v[92:95], a[140:143], a[60:63], v[92:95]
  v_fmac_f32 v190, v19, v6
  v_mfma_f32_16x16x32_bf16 v[92:95], a[136:139], a[44:47], v[92:95]
  v_fmac_f32 v191, v19, v7
  s_waitcnt lgkmcnt(5)
  v_mfma_f32_16x16x32_bf16 v[96:99], a[144:147], a[32:35], v[96:99]
  s_waitcnt lgkmcnt(2)
  ds_read_b128 a[136:139], v10 offset:32000
  v_fmac_f32 v192, v16, v28
  v_mfma_f32_16x16x32_bf16 v[96:99], a[148:151], a[48:51], v[96:99]
  ds_read_b128 a[140:143], v10 offset:46336
  v_fmac_f32 v193, v16, v29
  v_mfma_f32_16x16x32_bf16 v[100:103], a[148:151], a[52:55], v[100:103]
  buffer_load_dwordx4 a[120:123], v12, s[12:15], s33 offen offset:2048
  v_fmac_f32 v194, v16, v30
  ds_read_b128 v[4:7], v14 offset:3840
  v_mfma_f32_16x16x32_bf16 v[100:103], a[144:147], a[36:39], v[100:103]
  v_fmac_f32 v195, v16, v31
  v_mfma_f32_16x16x32_bf16 v[104:107], a[144:147], a[40:43], v[104:107]
  v_fmac_f32 v196, v17, v28
  v_mfma_f32_16x16x32_bf16 v[104:107], a[148:151], a[56:59], v[104:107]
  buffer_load_dwordx4 a[124:127], v12, s[12:15], s33 offen offset:2304
  v_fmac_f32 v197, v17, v29
  v_mfma_f32_16x16x32_bf16 v[108:111], a[148:151], a[60:63], v[108:111]
  v_fmac_f32 v198, v17, v30
  v_mfma_f32_16x16x32_bf16 v[108:111], a[144:147], a[44:47], v[108:111]
  v_fmac_f32 v199, v17, v31
  s_waitcnt lgkmcnt(6)
  v_mfma_f32_16x16x32_bf16 v[112:115], a[152:155], a[32:35], v[112:115]
  ds_read_b128 a[144:147], v10 offset:32768
  v_fmac_f32 v200, v18, v28
  v_mfma_f32_16x16x32_bf16 v[112:115], a[156:159], a[48:51], v[112:115]
  ds_read_b128 a[148:151], v10 offset:47104
  v_fmac_f32 v201, v18, v29
  v_mfma_f32_16x16x32_bf16 v[116:119], a[156:159], a[52:55], v[116:119]
  s_add_u32 s33, s33, 0x1000
  buffer_load_dwordx4 a[0:3], v12, s[8:11], s33 offen offset:0
  v_fmac_f32 v202, v18, v30
  v_mfma_f32_16x16x32_bf16 v[116:119], a[152:155], a[36:39], v[116:119]
  v_fmac_f32 v203, v18, v31
  v_mfma_f32_16x16x32_bf16 v[120:123], a[152:155], a[40:43], v[120:123]
  v_fmac_f32 v204, v19, v28
  v_mfma_f32_16x16x32_bf16 v[120:123], a[156:159], a[56:59], v[120:123]
  buffer_load_dwordx4 a[4:7], v12, s[8:11], s33 offen offset:256
  v_fmac_f32 v205, v19, v29
  v_mfma_f32_16x16x32_bf16 v[124:127], a[156:159], a[60:63], v[124:127]
  v_fmac_f32 v206, v19, v30
  v_mfma_f32_16x16x32_bf16 v[124:127], a[152:155], a[44:47], v[124:127]
  v_fmac_f32 v207, v19, v31
  s_waitcnt lgkmcnt(5)
  v_mfma_f32_16x16x32_bf16 v[128:131], a[128:131], a[32:35], v[128:131]
  s_waitcnt lgkmcnt(2)
  ds_read_b128 a[152:155], v10 offset:33024
  v_fmac_f32 v224, v16, v4
  v_mfma_f32_16x16x32_bf16 v[128:131], a[132:135], a[48:51], v[128:131]
  ds_read_b128 a[156:159], v10 offset:47360
  v_fmac_f32 v225, v16, v5
  v_mfma_f32_16x16x32_bf16 v[132:135], a[132:135], a[52:55], v[132:135]
  buffer_load_dwordx4 a[8:11], v12, s[12:15], s33 offen offset:0
  v_fmac_f32 v226, v16, v6
  ds_read_b128 v[28:31], v14 offset:3072
  v_mfma_f32_16x16x32_bf16 v[132:135], a[128:131], a[36:39], v[132:135]
  v_fmac_f32 v227, v16, v7
  v_mfma_f32_16x16x32_bf16 v[136:139], a[128:131], a[40:43], v[136:139]
  v_fmac_f32 v228, v17, v4
  v_mfma_f32_16x16x32_bf16 v[136:139], a[132:135], a[56:59], v[136:139]
  buffer_load_dwordx4 a[12:15], v12, s[12:15], s33 offen offset:256
  v_fmac_f32 v229, v17, v5
  v_mfma_f32_16x16x32_bf16 v[140:143], a[132:135], a[60:63], v[140:143]
  v_fmac_f32 v230, v17, v6
  v_mfma_f32_16x16x32_bf16 v[140:143], a[128:131], a[44:47], v[140:143]
  v_fmac_f32 v231, v17, v7
  s_waitcnt lgkmcnt(6)
  v_mfma_f32_16x16x32_bf16 v[144:147], a[136:139], a[32:35], v[144:147]
  ds_read_b128 a[128:131], v10 offset:33792
  v_fmac_f32 v232, v18, v4
  v_mfma_f32_16x16x32_bf16 v[144:147], a[140:143], a[48:51], v[144:147]
  ds_read_b128 a[132:135], v10 offset:48128
  v_fmac_f32 v233, v18, v5
  v_mfma_f32_16x16x32_bf16 v[148:151], a[140:143], a[52:55], v[148:151]
  buffer_load_dwordx4 a[16:19], v12, s[8:11], s33 offen offset:2048
  v_fmac_f32 v234, v18, v6
  v_mfma_f32_16x16x32_bf16 v[148:151], a[136:139], a[36:39], v[148:151]
  v_fmac_f32 v235, v18, v7
  v_mfma_f32_16x16x32_bf16 v[152:155], a[136:139], a[40:43], v[152:155]
  v_fmac_f32 v236, v19, v4
  v_mfma_f32_16x16x32_bf16 v[152:155], a[140:143], a[56:59], v[152:155]
  buffer_load_dwordx4 a[20:23], v12, s[8:11], s33 offen offset:2304
  v_fmac_f32 v237, v19, v5
  v_mfma_f32_16x16x32_bf16 v[156:159], a[140:143], a[60:63], v[156:159]
  v_fmac_f32 v238, v19, v6
  v_mfma_f32_16x16x32_bf16 v[156:159], a[136:139], a[44:47], v[156:159]
  v_fmac_f32 v239, v19, v7
  s_waitcnt lgkmcnt(5)
  v_mfma_f32_16x16x32_bf16 v[160:163], a[144:147], a[32:35], v[160:163]
  s_waitcnt lgkmcnt(2)
  ds_read_b128 a[136:139], v10 offset:34048
  v_fmac_f32 v32, v16, v28
  v_mfma_f32_16x16x32_bf16 v[160:163], a[148:151], a[48:51], v[160:163]
  ds_read_b128 a[140:143], v10 offset:48384
  v_fmac_f32 v33, v16, v29
  v_mfma_f32_16x16x32_bf16 v[164:167], a[148:151], a[52:55], v[164:167]
  buffer_load_dwordx4 a[24:27], v12, s[12:15], s33 offen offset:2048
  v_fmac_f32 v34, v16, v30
  ds_read_b128 v[4:7], v14 offset:3200
  v_mfma_f32_16x16x32_bf16 v[164:167], a[144:147], a[36:39], v[164:167]
  v_fmac_f32 v35, v16, v31
  v_mfma_f32_16x16x32_bf16 v[168:171], a[144:147], a[40:43], v[168:171]
  v_fmac_f32 v36, v17, v28
  v_mfma_f32_16x16x32_bf16 v[168:171], a[148:151], a[56:59], v[168:171]
  buffer_load_dwordx4 a[28:31], v12, s[12:15], s33 offen offset:2304
  v_fmac_f32 v37, v17, v29
  v_mfma_f32_16x16x32_bf16 v[172:175], a[148:151], a[60:63], v[172:175]
  v_fmac_f32 v38, v17, v30
  v_mfma_f32_16x16x32_bf16 v[172:175], a[144:147], a[44:47], v[172:175]
  v_fmac_f32 v39, v17, v31
  s_waitcnt lgkmcnt(6)
  v_mfma_f32_16x16x32_bf16 v[176:179], a[152:155], a[32:35], v[176:179]
  ds_read_b128 a[144:147], v10 offset:34816
  v_fmac_f32 v40, v18, v28
  v_mfma_f32_16x16x32_bf16 v[176:179], a[156:159], a[48:51], v[176:179]
  ds_read_b128 a[148:151], v10 offset:49152
  v_fmac_f32 v41, v18, v29
  v_mfma_f32_16x16x32_bf16 v[180:183], a[156:159], a[52:55], v[180:183]
  v_fmac_f32 v42, v18, v30
  v_mfma_f32_16x16x32_bf16 v[180:183], a[152:155], a[36:39], v[180:183]
  v_fmac_f32 v43, v18, v31
  v_mfma_f32_16x16x32_bf16 v[184:187], a[152:155], a[40:43], v[184:187]
  v_fmac_f32 v44, v19, v28
  v_mfma_f32_16x16x32_bf16 v[184:187], a[156:159], a[56:59], v[184:187]
  v_fmac_f32 v45, v19, v29
  v_mfma_f32_16x16x32_bf16 v[188:191], a[156:159], a[60:63], v[188:191]
  v_fmac_f32 v46, v19, v30
  v_mfma_f32_16x16x32_bf16 v[188:191], a[152:155], a[44:47], v[188:191]
  v_fmac_f32 v47, v19, v31
  s_waitcnt lgkmcnt(5)
  v_mfma_f32_16x16x32_bf16 v[192:195], a[128:131], a[32:35], v[192:195]
  s_waitcnt lgkmcnt(2)
  ds_read_b128 a[152:155], v10 offset:35072
  v_fmac_f32 v64, v16, v4
  v_mfma_f32_16x16x32_bf16 v[192:195], a[132:135], a[48:51], v[192:195]
  ds_read_b128 a[156:159], v10 offset:49408
  v_fmac_f32 v65, v16, v5
  v_mfma_f32_16x16x32_bf16 v[196:199], a[132:135], a[52:55], v[196:199]
  v_fmac_f32 v66, v16, v6
  ds_read_b128 v[28:31], v14 offset:3328
  v_mfma_f32_16x16x32_bf16 v[196:199], a[128:131], a[36:39], v[196:199]
  v_fmac_f32 v67, v16, v7
  v_mfma_f32_16x16x32_bf16 v[200:203], a[128:131], a[40:43], v[200:203]
  v_fmac_f32 v68, v17, v4
  v_mfma_f32_16x16x32_bf16 v[200:203], a[132:135], a[56:59], v[200:203]
  v_fmac_f32 v69, v17, v5
  v_mfma_f32_16x16x32_bf16 v[204:207], a[132:135], a[60:63], v[204:207]
  v_fmac_f32 v70, v17, v6
  v_mfma_f32_16x16x32_bf16 v[204:207], a[128:131], a[44:47], v[204:207]
  v_fmac_f32 v71, v17, v7
  s_waitcnt vmcnt(16) lgkmcnt(0)
  s_barrier
  v_mfma_f32_16x16x32_bf16 v[208:211], a[136:139], a[32:35], v[208:211]
  ds_read_b128 a[128:131], v11 offset:0
  v_fmac_f32 v72, v18, v4
  v_mfma_f32_16x16x32_bf16 v[208:211], a[140:143], a[48:51], v[208:211]
  ds_read_b128 a[132:135], v11 offset:14336
  v_fmac_f32 v73, v18, v5
  v_mfma_f32_16x16x32_bf16 v[212:215], a[140:143], a[52:55], v[212:215]
  s_add_u32 m0, s35, 28672
  s_nop 0
  buffer_load_dwordx4 v2, s[16:19], s34 offen offset:0 lds
  v_fmac_f32 v74, v18, v6
  v_mfma_f32_16x16x32_bf16 v[212:215], a[136:139], a[36:39], v[212:215]
  v_fmac_f32 v75, v18, v7
  v_mfma_f32_16x16x32_bf16 v[216:219], a[136:139], a[40:43], v[216:219]
  v_fmac_f32 v76, v19, v4
  v_mfma_f32_16x16x32_bf16 v[216:219], a[140:143], a[56:59], v[216:219]
  buffer_load_dwordx4 v2, s[16:19], s34 offen offset:1024 lds
  v_fmac_f32 v77, v19, v5
  v_mfma_f32_16x16x32_bf16 v[220:223], a[140:143], a[60:63], v[220:223]
  v_fmac_f32 v78, v19, v6
  v_mfma_f32_16x16x32_bf16 v[220:223], a[136:139], a[44:47], v[220:223]
  v_fmac_f32 v79, v19, v7
  s_waitcnt lgkmcnt(5)
  v_mfma_f32_16x16x32_bf16 v[224:227], a[144:147], a[32:35], v[224:227]
  s_waitcnt lgkmcnt(2)
  ds_read_b128 a[136:139], v11 offset:28672
  v_fmac_f32 v96, v16, v28
  v_mfma_f32_16x16x32_bf16 v[224:227], a[148:151], a[48:51], v[224:227]
  ds_read_b128 a[140:143], v11 offset:43008
  v_fmac_f32 v97, v16, v29
  v_mfma_f32_16x16x32_bf16 v[228:231], a[148:151], a[52:55], v[228:231]
  buffer_load_dwordx4 v2, s[16:19], s34 offen offset:2048 lds
  v_fmac_f32 v98, v16, v30
  ds_read_b128 v[4:7], v14 offset:3456
  s_lshl_b32 s41, s101, 8
  s_add_u32 s41, s41, 491520
  buffer_load_dword v9, v8, s[24:27], s41 offen sc1
  v_mfma_f32_16x16x32_bf16 v[228:231], a[144:147], a[36:39], v[228:231]
  v_fmac_f32 v99, v16, v31
  v_mfma_f32_16x16x32_bf16 v[232:235], a[144:147], a[40:43], v[232:235]
  v_fmac_f32 v100, v17, v28
  v_mfma_f32_16x16x32_bf16 v[232:235], a[148:151], a[56:59], v[232:235]
  buffer_load_dwordx4 v2, s[16:19], s34 offen offset:3072 lds
  v_fmac_f32 v101, v17, v29
  v_mfma_f32_16x16x32_bf16 v[236:239], a[148:151], a[60:63], v[236:239]
  v_fmac_f32 v102, v17, v30
  v_mfma_f32_16x16x32_bf16 v[236:239], a[144:147], a[44:47], v[236:239]
  v_fmac_f32 v103, v17, v31
  s_waitcnt lgkmcnt(6)
  v_mfma_f32_16x16x32_bf16 v[240:243], a[152:155], a[32:35], v[240:243]
  ds_read_b128 a[144:147], v10 offset:0
  v_fmac_f32 v104, v18, v28
  v_mfma_f32_16x16x32_bf16 v[240:243], a[156:159], a[48:51], v[240:243]
  ds_read_b128 a[148:151], v10 offset:14336
  v_fmac_f32 v105, v18, v29
  v_mfma_f32_16x16x32_bf16 v[244:247], a[156:159], a[52:55], v[244:247]
  s_add_u32 m0, s35, 32768
  s_nop 0
  buffer_load_dwordx4 v3, s[16:19], s34 offen offset:0 lds
  v_fmac_f32 v106, v18, v30
  v_mfma_f32_16x16x32_bf16 v[244:247], a[152:155], a[36:39], v[244:247]
  v_fmac_f32 v107, v18, v31
  v_mfma_f32_16x16x32_bf16 v[248:251], a[152:155], a[40:43], v[248:251]
  v_fmac_f32 v108, v19, v28
  v_mfma_f32_16x16x32_bf16 v[248:251], a[156:159], a[56:59], v[248:251]
  buffer_load_dwordx4 v3, s[16:19], s34 offen offset:1024 lds
  v_fmac_f32 v109, v19, v29
  v_mfma_f32_16x16x32_bf16 v[252:255], a[156:159], a[60:63], v[252:255]
  v_fmac_f32 v110, v19, v30
  v_mfma_f32_16x16x32_bf16 v[252:255], a[152:155], a[44:47], v[252:255]
  v_fmac_f32 v111, v19, v31
  s_waitcnt vmcnt(30) lgkmcnt(5)
  v_mfma_f32_16x16x32_bf16 v[32:35], a[128:131], a[64:67], v[32:35]
  s_waitcnt lgkmcnt(2)
  ds_read_b128 a[152:155], v11 offset:256
  v_fmac_f32 v128, v16, v4
  v_mfma_f32_16x16x32_bf16 v[32:35], a[132:135], a[80:83], v[32:35]
  ds_read_b128 a[156:159], v11 offset:14592
  v_fmac_f32 v129, v16, v5
  v_mfma_f32_16x16x32_bf16 v[36:39], a[132:135], a[84:87], v[36:39]
  buffer_load_dwordx4 v3, s[16:19], s34 offen offset:2048 lds
  s_add_u32 s34, s34, 28672
  v_fmac_f32 v130, v16, v6
  ds_read_b128 v[28:31], v14 offset:3584
  v_mfma_f32_16x16x32_bf16 v[36:39], a[128:131], a[68:71], v[36:39]
  v_fmac_f32 v131, v16, v7
  v_mfma_f32_16x16x32_bf16 v[40:43], a[128:131], a[72:75], v[40:43]
  v_fmac_f32 v132, v17, v4
  v_mfma_f32_16x16x32_bf16 v[40:43], a[132:135], a[88:91], v[40:43]
  v_fmac_f32 v133, v17, v5
  v_mfma_f32_16x16x32_bf16 v[44:47], a[132:135], a[92:95], v[44:47]
  v_fmac_f32 v134, v17, v6
  v_mfma_f32_16x16x32_bf16 v[44:47], a[128:131], a[76:79], v[44:47]
  v_fmac_f32 v135, v17, v7
  s_waitcnt vmcnt(16) lgkmcnt(6)
  v_mfma_f32_16x16x32_bf16 v[32:35], a[136:139], a[96:99], v[32:35]
  ds_read_b128 a[128:131], v11 offset:28928
  v_fmac_f32 v136, v18, v4
  v_mfma_f32_16x16x32_bf16 v[32:35], a[140:143], a[112:115], v[32:35]
  ds_read_b128 a[132:135], v11 offset:43264
  v_fmac_f32 v137, v18, v5
  v_mfma_f32_16x16x32_bf16 v[36:39], a[140:143], a[116:119], v[36:39]
  s_add_u32 s33, s33, 0x1000
  buffer_load_dwordx4 a[32:35], v12, s[8:11], s33 offen offset:0
  v_fmac_f32 v138, v18, v6
  v_mfma_f32_16x16x32_bf16 v[36:39], a[136:139], a[100:103], v[36:39]
  v_fmac_f32 v139, v18, v7
  v_mfma_f32_16x16x32_bf16 v[40:43], a[136:139], a[104:107], v[40:43]
  v_fmac_f32 v140, v19, v4
  v_mfma_f32_16x16x32_bf16 v[40:43], a[140:143], a[120:123], v[40:43]
  buffer_load_dwordx4 a[36:39], v12, s[8:11], s33 offen offset:256
  v_fmac_f32 v141, v19, v5
  v_mfma_f32_16x16x32_bf16 v[44:47], a[140:143], a[124:127], v[44:47]
  v_fmac_f32 v142, v19, v6
  v_mfma_f32_16x16x32_bf16 v[44:47], a[136:139], a[108:111], v[44:47]
  v_fmac_f32 v143, v19, v7
  s_waitcnt vmcnt(10) lgkmcnt(5)
  v_mfma_f32_16x16x32_bf16 v[32:35], a[144:147], a[0:3], v[32:35]
  s_waitcnt lgkmcnt(2)
  ds_read_b128 a[136:139], v10 offset:256
  v_fmac_f32 v160, v16, v28
  v_mfma_f32_16x16x32_bf16 v[32:35], a[148:151], a[16:19], v[32:35]
  ds_read_b128 a[140:143], v10 offset:14592
  v_fmac_f32 v161, v16, v29
  v_mfma_f32_16x16x32_bf16 v[36:39], a[148:151], a[20:23], v[36:39]
  buffer_load_dwordx4 a[40:43], v12, s[12:15], s33 offen offset:0
  v_fmac_f32 v162, v16, v30
  v_mfma_f32_16x16x32_bf16 v[36:39], a[144:147], a[4:7], v[36:39]
  v_fmac_f32 v163, v16, v31
  v_mfma_f32_16x16x32_bf16 v[40:43], a[144:147], a[8:11], v[40:43]
  v_fmac_f32 v164, v17, v28
  v_mfma_f32_16x16x32_bf16 v[40:43], a[148:151], a[24:27], v[40:43]
  buffer_load_dwordx4 a[44:47], v12, s[12:15], s33 offen offset:256
  v_fmac_f32 v165, v17, v29
  v_mfma_f32_16x16x32_bf16 v[44:47], a[148:151], a[28:31], v[44:47]
  v_fmac_f32 v166, v17, v30
  v_mfma_f32_16x16x32_bf16 v[44:47], a[144:147], a[12:15], v[44:47]
  v_fmac_f32 v167, v17, v31
  s_waitcnt lgkmcnt(5)
  v_mfma_f32_16x16x32_bf16 v[48:51], a[152:155], a[64:67], v[48:51]
  ds_read_b128 a[144:147], v11 offset:1024
  v_fmac_f32 v168, v18, v28
  v_mfma_f32_16x16x32_bf16 v[48:51], a[156:159], a[80:83], v[48:51]
  ds_read_b128 a[148:151], v11 offset:15360
  v_fmac_f32 v169, v18, v29
  v_mfma_f32_16x16x32_bf16 v[52:55], a[156:159], a[84:87], v[52:55]
  buffer_load_dwordx4 a[48:51], v12, s[8:11], s33 offen offset:2048
  v_fmac_f32 v170, v18, v30
  v_mfma_f32_16x16x32_bf16 v[52:55], a[152:155], a[68:71], v[52:55]
  v_fmac_f32 v171, v18, v31
  v_mfma_f32_16x16x32_bf16 v[56:59], a[152:155], a[72:75], v[56:59]
  v_fmac_f32 v172, v19, v28
  v_mfma_f32_16x16x32_bf16 v[56:59], a[156:159], a[88:91], v[56:59]
  buffer_load_dwordx4 a[52:55], v12, s[8:11], s33 offen offset:2304
  v_fmac_f32 v173, v19, v29
  v_mfma_f32_16x16x32_bf16 v[60:63], a[156:159], a[92:95], v[60:63]
  v_fmac_f32 v174, v19, v30
  v_mfma_f32_16x16x32_bf16 v[60:63], a[152:155], a[76:79], v[60:63]
  v_fmac_f32 v175, v19, v31
  s_waitcnt lgkmcnt(4)
  v_mfma_f32_16x16x32_bf16 v[48:51], a[128:131], a[96:99], v[48:51]
  ds_read_b128 a[152:155], v11 offset:29696
  v_mfma_f32_16x16x32_bf16 v[48:51], a[132:135], a[112:115], v[48:51]
  ds_read_b128 a[156:159], v11 offset:44032
  v_mfma_f32_16x16x32_bf16 v[52:55], a[132:135], a[116:119], v[52:55]
  buffer_load_dwordx4 a[56:59], v12, s[12:15], s33 offen offset:2048
  v_mfma_f32_16x16x32_bf16 v[52:55], a[128:131], a[100:103], v[52:55]
  v_mfma_f32_16x16x32_bf16 v[56:59], a[128:131], a[104:107], v[56:59]
  v_mfma_f32_16x16x32_bf16 v[56:59], a[132:135], a[120:123], v[56:59]
  buffer_load_dwordx4 a[60:63], v12, s[12:15], s33 offen offset:2304
  v_mfma_f32_16x16x32_bf16 v[60:63], a[132:135], a[124:127], v[60:63]
  v_mfma_f32_16x16x32_bf16 v[60:63], a[128:131], a[108:111], v[60:63]
  s_waitcnt lgkmcnt(4)
  v_mfma_f32_16x16x32_bf16 v[48:51], a[136:139], a[0:3], v[48:51]
  ds_read_b128 a[128:131], v10 offset:1024
  v_mfma_f32_16x16x32_bf16 v[48:51], a[140:143], a[16:19], v[48:51]
  ds_read_b128 a[132:135], v10 offset:15360
  v_mfma_f32_16x16x32_bf16 v[52:55], a[140:143], a[20:23], v[52:55]
  v_mfma_f32_16x16x32_bf16 v[52:55], a[136:139], a[4:7], v[52:55]
  v_mfma_f32_16x16x32_bf16 v[56:59], a[136:139], a[8:11], v[56:59]
  v_mfma_f32_16x16x32_bf16 v[56:59], a[140:143], a[24:27], v[56:59]
  v_mfma_f32_16x16x32_bf16 v[60:63], a[140:143], a[28:31], v[60:63]
  v_mfma_f32_16x16x32_bf16 v[60:63], a[136:139], a[12:15], v[60:63]
  s_waitcnt lgkmcnt(4)
  v_mfma_f32_16x16x32_bf16 v[64:67], a[144:147], a[64:67], v[64:67]
  ds_read_b128 a[136:139], v11 offset:1280
  v_mfma_f32_16x16x32_bf16 v[64:67], a[148:151], a[80:83], v[64:67]
  ds_read_b128 a[140:143], v11 offset:15616
  v_mfma_f32_16x16x32_bf16 v[68:71], a[148:151], a[84:87], v[68:71]
  s_waitcnt vmcnt(12)
  s_mov_b32 s40, 200000
cvd_chk:
  v_cmp_gt_u32 vcc, 14, v9
  s_nop 4
  s_cbranch_vccz cvd_ok
  s_sleep 1
  buffer_load_dword v9, v8, s[24:27], s41 offen sc1
  s_sub_u32 s40, s40, 1
  s_cmp_lg_u32 s40, 0
  s_waitcnt vmcnt(0)
  s_cbranch_scc1 cvd_chk
cvd_ok:
  v_mfma_f32_16x16x32_bf16 v[68:71], a[144:147], a[68:71], v[68:71]
  s_mul_i32 s39, s101, 458752
  v_mfma_f32_16x16x32_bf16 v[72:75], a[144:147], a[72:75], v[72:75]
  s_add_u32 s39, s39, 56623104
  v_mfma_f32_16x16x32_bf16 v[72:75], a[148:151], a[88:91], v[72:75]
  s_add_u32 s16, s6, s39
  v_mfma_f32_16x16x32_bf16 v[76:79], a[148:151], a[92:95], v[76:79]
  s_addc_u32 s17, s7, 0
  v_mfma_f32_16x16x32_bf16 v[76:79], a[144:147], a[76:79], v[76:79]
  s_mov_b32 s18, 458752
  s_waitcnt lgkmcnt(4)
  v_mfma_f32_16x16x32_bf16 v[64:67], a[152:155], a[96:99], v[64:67]
  ds_read_b128 a[144:147], v11 offset:29952
  v_mfma_f32_16x16x32_bf16 v[64:67], a[156:159], a[112:115], v[64:67]
  ds_read_b128 a[148:151], v11 offset:44288
  v_mfma_f32_16x16x32_bf16 v[68:71], a[156:159], a[116:119], v[68:71]
  s_mov_b32 s19, 0x20000
  v_mfma_f32_16x16x32_bf16 v[68:71], a[152:155], a[100:103], v[68:71]
  s_mul_i32 s39, s30, 8192
  v_mfma_f32_16x16x32_bf16 v[72:75], a[152:155], a[104:107], v[72:75]
  v_add_u32 v2, s39, v1
  v_mfma_f32_16x16x32_bf16 v[72:75], a[156:159], a[120:123], v[72:75]
  v_add_u32 v3, 0x1000, v2
  v_mfma_f32_16x16x32_bf16 v[76:79], a[156:159], a[124:127], v[76:79]
  s_add_u32 s35, s39, 98304
  v_mfma_f32_16x16x32_bf16 v[76:79], a[152:155], a[108:111], v[76:79]
  s_add_u32 s36, s39, 32768
  s_waitcnt lgkmcnt(4)
  v_mfma_f32_16x16x32_bf16 v[64:67], a[128:131], a[0:3], v[64:67]
  ds_read_b128 a[152:155], v10 offset:1280
  v_mfma_f32_16x16x32_bf16 v[64:67], a[132:135], a[16:19], v[64:67]
  ds_read_b128 a[156:159], v10 offset:15616
  v_mfma_f32_16x16x32_bf16 v[68:71], a[132:135], a[20:23], v[68:71]
  s_mov_b32 s37, 4294901760
  v_mfma_f32_16x16x32_bf16 v[68:71], a[128:131], a[4:7], v[68:71]
  s_mov_b32 s33, 0
  v_mfma_f32_16x16x32_bf16 v[72:75], a[128:131], a[8:11], v[72:75]
  s_mov_b32 s34, 0
  v_mfma_f32_16x16x32_bf16 v[72:75], a[132:135], a[24:27], v[72:75]
  s_add_u32 m0, s35, 32768
  v_mfma_f32_16x16x32_bf16 v[76:79], a[132:135], a[28:31], v[76:79]
  buffer_load_dwordx4 v2, s[16:19], s34 offen offset:0 lds
  v_mfma_f32_16x16x32_bf16 v[76:79], a[128:131], a[12:15], v[76:79]
  buffer_load_dwordx4 v2, s[16:19], s34 offen offset:1024 lds
  s_waitcnt vmcnt(10) lgkmcnt(0)
  s_barrier
  v_mfma_f32_16x16x32_bf16 v[80:83], a[136:139], a[64:67], v[80:83]
  ds_read_b128 a[128:131], v10 offset:28672
  v_mfma_f32_16x16x32_bf16 v[80:83], a[140:143], a[80:83], v[80:83]
  ds_read_b128 a[132:135], v10 offset:43008
  v_mfma_f32_16x16x32_bf16 v[84:87], a[140:143], a[84:87], v[84:87]
  buffer_load_dwordx4 v2, s[16:19], s34 offen offset:2048 lds
  buffer_load_dwordx4 v2, s[16:19], s34 offen offset:3072 lds
  v_mfma_f32_16x16x32_bf16 v[84:87], a[136:139], a[68:71], v[84:87]
  s_add_u32 m0, s35, 36864
  v_mfma_f32_16x16x32_bf16 v[88:91], a[136:139], a[72:75], v[88:91]
  buffer_load_dwordx4 v3, s[16:19], s34 offen offset:0 lds
  v_mfma_f32_16x16x32_bf16 v[88:91], a[140:143], a[88:91], v[88:91]
  buffer_load_dwordx4 v3, s[16:19], s34 offen offset:1024 lds
  v_mfma_f32_16x16x32_bf16 v[92:95], a[140:143], a[92:95], v[92:95]
  buffer_load_dwordx4 v3, s[16:19], s34 offen offset:2048 lds
  v_mfma_f32_16x16x32_bf16 v[92:95], a[136:139], a[76:79], v[92:95]
  buffer_load_dwordx4 v3, s[16:19], s34 offen offset:3072 lds
  s_waitcnt lgkmcnt(4)
  v_mfma_f32_16x16x32_bf16 v[80:83], a[144:147], a[96:99], v[80:83]
  ds_read_b128 a[136:139], v10 offset:28928
  v_mfma_f32_16x16x32_bf16 v[80:83], a[148:151], a[112:115], v[80:83]
  ds_read_b128 a[140:143], v10 offset:43264
  v_mfma_f32_16x16x32_bf16 v[84:87], a[148:151], a[116:119], v[84:87]
  s_add_u32 s34, s34, 32768
  v_mfma_f32_16x16x32_bf16 v[84:87], a[144:147], a[100:103], v[84:87]
  s_lshl_b32 s89, s48, 10
  v_mfma_f32_16x16x32_bf16 v[88:91], a[144:147], a[104:107], v[88:91]
  s_add_u32 s89, s89, 24576
  v_mfma_f32_16x16x32_bf16 v[88:91], a[148:151], a[120:123], v[88:91]
  s_add_u32 s89, s89, s28
  v_mfma_f32_16x16x32_bf16 v[92:95], a[148:151], a[124:127], v[92:95]
  s_lshr_b32 s41, s49, 4
  v_mfma_f32_16x16x32_bf16 v[92:95], a[144:147], a[108:111], v[92:95]
  s_lshl_b32 s41, s41, 9
  s_waitcnt lgkmcnt(4)
  v_mfma_f32_16x16x32_bf16 v[80:83], a[152:155], a[0:3], v[80:83]
  ds_read_b128 a[144:147], v10 offset:29696
  v_mfma_f32_16x16x32_bf16 v[80:83], a[156:159], a[16:19], v[80:83]
  ds_read_b128 a[148:151], v10 offset:44032
  v_mfma_f32_16x16x32_bf16 v[84:87], a[156:159], a[20:23], v[84:87]
  s_add_u32 s89, s89, s41
  v_mfma_f32_16x16x32_bf16 v[84:87], a[152:155], a[4:7], v[84:87]
  s_and_b32 s41, s49, 1
  v_mfma_f32_16x16x32_bf16 v[88:91], a[152:155], a[8:11], v[88:91]
  s_lshl_b32 s41, s41, 8
  v_mfma_f32_16x16x32_bf16 v[88:91], a[156:159], a[24:27], v[88:91]
  s_add_u32 s43, s89, s41
  v_mfma_f32_16x16x32_bf16 v[92:95], a[156:159], a[28:31], v[92:95]
  s_add_u32 s93, s43, 16384
  v_mfma_f32_16x16x32_bf16 v[92:95], a[152:155], a[12:15], v[92:95]
  s_add_u32 s94, s89, 16384
  s_waitcnt vmcnt(8) lgkmcnt(4)
  v_mfma_f32_16x16x32_bf16 v[32:35], a[128:131], a[32:35], v[32:35]
  ds_read_b128 a[152:155], v10 offset:29952
  v_mfma_f32_16x16x32_bf16 v[32:35], a[132:135], a[48:51], v[32:35]
  ds_read_b128 a[156:159], v10 offset:44288
  v_mfma_f32_16x16x32_bf16 v[36:39], a[132:135], a[52:55], v[36:39]
  s_add_u32 s42, s43, 24576
  s_add_u32 s45, s89, 24576
  v_mfma_f32_16x16x32_bf16 v[36:39], a[128:131], a[36:39], v[36:39]
  s_xor_b32 s41, s89, 512
  v_mfma_f32_16x16x32_bf16 v[40:43], a[128:131], a[40:43], v[40:43]
  s_min_u32 s89, s89, s41
  v_mfma_f32_16x16x32_bf16 v[40:43], a[132:135], a[56:59], v[40:43]
  s_mov_b32 s90, 200000
  v_mfma_f32_16x16x32_bf16 v[44:47], a[132:135], a[60:63], v[44:47]
  v_and_b32 v8, 1, v0
  v_mfma_f32_16x16x32_bf16 v[44:47], a[128:131], a[44:47], v[44:47]
  v_lshlrev_b32 v8, 8, v8
  s_waitcnt lgkmcnt(4)
  v_mfma_f32_16x16x32_bf16 v[48:51], a[136:139], a[32:35], v[48:51]
  ds_read_b128 a[128:131], v11 offset:2048
  v_mfma_f32_16x16x32_bf16 v[48:51], a[140:143], a[48:51], v[48:51]
  ds_read_b128 a[132:135], v11 offset:16384
  v_mfma_f32_16x16x32_bf16 v[52:55], a[140:143], a[52:55], v[52:55]
  s_lshr_b32 s39, s3, 1
  v_mfma_f32_16x16x32_bf16 v[52:55], a[136:139], a[36:39], v[52:55]
  s_lshl_b32 s39, s39, 24
  v_mfma_f32_16x16x32_bf16 v[56:59], a[136:139], a[40:43], v[56:59]
  s_mul_i32 s40, s100, 229376
  v_mfma_f32_16x16x32_bf16 v[56:59], a[140:143], a[56:59], v[56:59]
  s_add_u32 s39, s39, s40
  v_mfma_f32_16x16x32_bf16 v[60:63], a[140:143], a[60:63], v[60:63]
  s_and_b32 s40, s101, 1
  v_mfma_f32_16x16x32_bf16 v[60:63], a[136:139], a[44:47], v[60:63]
  s_mul_i32 s40, s40, 114688
  s_waitcnt lgkmcnt(4)
  v_mfma_f32_16x16x32_bf16 v[64:67], a[144:147], a[32:35], v[64:67]
  ds_read_b128 a[136:139], v11 offset:30720
  v_mfma_f32_16x16x32_bf16 v[64:67], a[148:151], a[48:51], v[64:67]
  ds_read_b128 a[140:143], v11 offset:45056
  v_mfma_f32_16x16x32_bf16 v[68:71], a[148:151], a[52:55], v[68:71]
  s_add_u32 s39, s39, s40
  v_mfma_f32_16x16x32_bf16 v[68:71], a[144:147], a[36:39], v[68:71]
  s_add_u32 s39, s39, 67108864
  v_mul_f32 v48, v48, v32
  v_mul_f32 v49, v49, v33
  v_mul_f32 v50, v50, v34
  v_mul_f32 v51, v51, v35
  v_mul_f32 v32, v32, v24
  v_mul_f32 v33, v33, v24
  v_mul_f32 v34, v34, v24
  v_mfma_f32_16x16x32_bf16 v[72:75], a[144:147], a[40:43], v[72:75]
  s_add_u32 s8, s6, s39
  v_mul_f32 v35, v35, v24
  v_mul_f32 v52, v52, v36
  v_mfma_f32_16x16x32_bf16 v[72:75], a[148:151], a[56:59], v[72:75]
  s_addc_u32 s9, s7, 0
  v_mul_f32 v53, v53, v37
  v_mul_f32 v54, v54, v38
  v_mfma_f32_16x16x32_bf16 v[76:79], a[148:151], a[60:63], v[76:79]
  s_mov_b32 s10, 114688
  v_mul_f32 v55, v55, v39
  v_mul_f32 v36, v36, v25
  v_mfma_f32_16x16x32_bf16 v[76:79], a[144:147], a[44:47], v[76:79]
  s_mov_b32 s11, 0x20000
  v_mul_f32 v37, v37, v25
  v_mul_f32 v38, v38, v25
  s_waitcnt lgkmcnt(4)
  v_mfma_f32_16x16x32_bf16 v[80:83], a[152:155], a[32:35], v[80:83]
  ds_read_b128 a[144:147], v10 offset:2048
  v_mul_f32 v39, v39, v25
  v_mul_f32 v56, v56, v40
  v_mfma_f32_16x16x32_bf16 v[80:83], a[156:159], a[48:51], v[80:83]
  ds_read_b128 a[148:151], v10 offset:16384
  v_mul_f32 v57, v57, v41
  v_mfma_f32_16x16x32_bf16 v[84:87], a[156:159], a[52:55], v[84:87]
  v_mul_f32 v58, v58, v42
  v_mul_f32 v59, v59, v43
  v_mul_f32 v40, v40, v26
  v_mfma_f32_16x16x32_bf16 v[84:87], a[152:155], a[36:39], v[84:87]
  v_mul_f32 v41, v41, v26
  v_mul_f32 v42, v42, v26
  v_mul_f32 v43, v43, v26
  v_mfma_f32_16x16x32_bf16 v[88:91], a[152:155], a[40:43], v[88:91]
  v_mul_f32 v60, v60, v44
  v_mul_f32 v61, v61, v45
  v_mul_f32 v62, v62, v46
  v_mfma_f32_16x16x32_bf16 v[88:91], a[156:159], a[56:59], v[88:91]
  v_mul_f32 v63, v63, v47
  v_mul_f32 v44, v44, v27
  v_mul_f32 v45, v45, v27
  v_mfma_f32_16x16x32_bf16 v[92:95], a[156:159], a[60:63], v[92:95]
  v_mul_f32 v46, v46, v27
  v_mul_f32 v47, v47, v27
  v_mfma_f32_16x16x32_bf16 v[92:95], a[152:155], a[44:47], v[92:95]
  v_exp_f32 v32, v32
  v_exp_f32 v33, v33
  s_waitcnt lgkmcnt(4)
  v_mfma_f32_16x16x32_bf16 v[96:99], a[128:131], a[64:67], v[96:99]
  ds_read_b128 a[152:155], v10 offset:30720
  v_exp_f32 v34, v34
  v_mfma_f32_16x16x32_bf16 v[96:99], a[132:135], a[80:83], v[96:99]
  ds_read_b128 a[156:159], v10 offset:45056
  v_exp_f32 v35, v35
  v_mfma_f32_16x16x32_bf16 v[100:103], a[132:135], a[84:87], v[100:103]
  v_exp_f32 v36, v36
  v_mfma_f32_16x16x32_bf16 v[100:103], a[128:131], a[68:71], v[100:103]
  v_exp_f32 v37, v37
  v_mfma_f32_16x16x32_bf16 v[104:107], a[128:131], a[72:75], v[104:107]
  v_exp_f32 v38, v38
  v_exp_f32 v39, v39
  v_mfma_f32_16x16x32_bf16 v[104:107], a[132:135], a[88:91], v[104:107]
  v_exp_f32 v40, v40
  v_mfma_f32_16x16x32_bf16 v[108:111], a[132:135], a[92:95], v[108:111]
  v_exp_f32 v41, v41
  v_exp_f32 v42, v42
  v_mfma_f32_16x16x32_bf16 v[108:111], a[128:131], a[76:79], v[108:111]
  v_exp_f32 v43, v43
  s_waitcnt lgkmcnt(4)
  v_mfma_f32_16x16x32_bf16 v[96:99], a[136:139], a[96:99], v[96:99]
  ds_read_b128 a[128:131], v11 offset:2304
  v_exp_f32 v44, v44
  v_mfma_f32_16x16x32_bf16 v[96:99], a[140:143], a[112:115], v[96:99]
  ds_read_b128 a[132:135], v11 offset:16640
  v_exp_f32 v45, v45
  v_mfma_f32_16x16x32_bf16 v[100:103], a[140:143], a[116:119], v[100:103]
  v_exp_f32 v46, v46
  v_exp_f32 v47, v47
  v_mfma_f32_16x16x32_bf16 v[100:103], a[136:139], a[100:103], v[100:103]
  v_fma_f32 v32, v32, v20, v20
  v_fma_f32 v33, v33, v20, v20
  v_fma_f32 v34, v34, v20, v20
  v_mfma_f32_16x16x32_bf16 v[104:107], a[136:139], a[104:107], v[104:107]
  v_fma_f32 v35, v35, v20, v20
  v_fma_f32 v36, v36, v21, v21
  v_fma_f32 v37, v37, v21, v21
  v_mfma_f32_16x16x32_bf16 v[104:107], a[140:143], a[120:123], v[104:107]
  v_fma_f32 v38, v38, v21, v21
  v_fma_f32 v39, v39, v21, v21
  v_mfma_f32_16x16x32_bf16 v[108:111], a[140:143], a[124:127], v[108:111]
  v_fma_f32 v40, v40, v22, v22
  v_fma_f32 v41, v41, v22, v22
  v_fma_f32 v42, v42, v22, v22
  v_mfma_f32_16x16x32_bf16 v[108:111], a[136:139], a[108:111], v[108:111]
  v_fma_f32 v43, v43, v22, v22
  v_fma_f32 v44, v44, v23, v23
  v_fma_f32 v45, v45, v23, v23
  s_waitcnt lgkmcnt(4)
  v_mfma_f32_16x16x32_bf16 v[96:99], a[144:147], a[0:3], v[96:99]
  ds_read_b128 a[136:139], v11 offset:30976
  v_fma_f32 v46, v46, v23, v23
  v_fma_f32 v47, v47, v23, v23
  v_mfma_f32_16x16x32_bf16 v[96:99], a[148:151], a[16:19], v[96:99]
  ds_read_b128 a[140:143], v11 offset:45312
  v_rcp_f32 v32, v32
  v_mfma_f32_16x16x32_bf16 v[100:103], a[148:151], a[20:23], v[100:103]
  v_rcp_f32 v33, v33
  v_mfma_f32_16x16x32_bf16 v[100:103], a[144:147], a[4:7], v[100:103]
  v_rcp_f32 v34, v34
  v_rcp_f32 v35, v35
  v_mfma_f32_16x16x32_bf16 v[104:107], a[144:147], a[8:11], v[104:107]
  v_rcp_f32 v36, v36
  v_mfma_f32_16x16x32_bf16 v[104:107], a[148:151], a[24:27], v[104:107]
  v_rcp_f32 v37, v37
  v_rcp_f32 v38, v38
  v_mfma_f32_16x16x32_bf16 v[108:111], a[148:151], a[28:31], v[108:111]
  v_rcp_f32 v39, v39
  v_mfma_f32_16x16x32_bf16 v[108:111], a[144:147], a[12:15], v[108:111]
  v_rcp_f32 v40, v40
  s_waitcnt lgkmcnt(4)
  v_mfma_f32_16x16x32_bf16 v[96:99], a[152:155], a[32:35], v[96:99]
  ds_read_b128 a[144:147], v10 offset:2304
  v_rcp_f32 v41, v41
  v_mfma_f32_16x16x32_bf16 v[96:99], a[156:159], a[48:51], v[96:99]
  ds_read_b128 a[148:151], v10 offset:16640
  v_rcp_f32 v42, v42
  v_mfma_f32_16x16x32_bf16 v[100:103], a[156:159], a[52:55], v[100:103]
  v_rcp_f32 v43, v43
  v_rcp_f32 v44, v44
  v_mfma_f32_16x16x32_bf16 v[100:103], a[152:155], a[36:39], v[100:103]
  v_rcp_f32 v45, v45
  v_mfma_f32_16x16x32_bf16 v[104:107], a[152:155], a[40:43], v[104:107]
  v_rcp_f32 v46, v46
  v_rcp_f32 v47, v47
  v_mfma_f32_16x16x32_bf16 v[104:107], a[156:159], a[56:59], v[104:107]
  v_mul_f32 v48, v48, v32
  v_mul_f32 v49, v49, v33
  v_mul_f32 v50, v50, v34
  v_mfma_f32_16x16x32_bf16 v[108:111], a[156:159], a[60:63], v[108:111]
  v_mul_f32 v51, v51, v35
  v_mul_f32 v52, v52, v36
  v_mul_f32 v53, v53, v37
  v_mfma_f32_16x16x32_bf16 v[108:111], a[152:155], a[44:47], v[108:111]
  v_mul_f32 v54, v54, v38
  v_mul_f32 v55, v55, v39
  v_mul_f32 v56, v56, v40
  s_waitcnt lgkmcnt(4)
  v_mfma_f32_16x16x32_bf16 v[112:115], a[128:131], a[64:67], v[112:115]
  ds_read_b128 a[152:155], v10 offset:30976
  v_mul_f32 v57, v57, v41
  v_mul_f32 v58, v58, v42
  v_mfma_f32_16x16x32_bf16 v[112:115], a[132:135], a[80:83], v[112:115]
  ds_read_b128 a[156:159], v10 offset:45312
  v_mul_f32 v59, v59, v43
  v_mfma_f32_16x16x32_bf16 v[116:119], a[132:135], a[84:87], v[116:119]
  v_mul_f32 v60, v60, v44
  v_mul_f32 v61, v61, v45
  v_mul_f32 v62, v62, v46
  v_mfma_f32_16x16x32_bf16 v[116:119], a[128:131], a[68:71], v[116:119]
  v_mul_f32 v63, v63, v47
  v_cvt_pk_bf16_f32 v32, v48, v49
  v_cvt_pk_bf16_f32 v33, v50, v51
  v_mfma_f32_16x16x32_bf16 v[120:123], a[128:131], a[72:75], v[120:123]
  v_cvt_pk_bf16_f32 v34, v52, v53
  v_cvt_pk_bf16_f32 v35, v54, v55
  v_cvt_pk_bf16_f32 v36, v56, v57
  v_mfma_f32_16x16x32_bf16 v[120:123], a[132:135], a[88:91], v[120:123]
  v_cvt_pk_bf16_f32 v37, v58, v59
  v_cvt_pk_bf16_f32 v38, v60, v61
  v_cvt_pk_bf16_f32 v39, v62, v63
  v_mfma_f32_16x16x32_bf16 v[124:127], a[132:135], a[92:95], v[124:127]
  v_permlane32_swap_b32 v32, v34
  v_permlane32_swap_b32 v33, v35
  v_permlane32_swap_b32 v36, v38
  v_mfma_f32_16x16x32_bf16 v[124:127], a[128:131], a[76:79], v[124:127]
  v_permlane32_swap_b32 v37, v39
  s_add_u32 s44, s92, 0
  s_waitcnt lgkmcnt(4)
  v_mfma_f32_16x16x32_bf16 v[112:115], a[136:139], a[96:99], v[112:115]
  ds_read_b128 a[128:131], v11 offset:3072
  buffer_store_dwordx4 v[32:35], v13, s[20:23], s44 offen sc1
  s_add_u32 s44, s92, 229376
  v_mfma_f32_16x16x32_bf16 v[112:115], a[140:143], a[112:115], v[112:115]
  ds_read_b128 a[132:135], v11 offset:17408
  buffer_store_dwordx4 v[36:39], v13, s[20:23], s44 offen sc1
  v_mfma_f32_16x16x32_bf16 v[116:119], a[140:143], a[116:119], v[116:119]
  v_mul_f32 v80, v80, v64
  v_mul_f32 v81, v81, v65
  v_mul_f32 v82, v82, v66
  v_mfma_f32_16x16x32_bf16 v[116:119], a[136:139], a[100:103], v[116:119]
  v_mul_f32 v83, v83, v67
  v_mul_f32 v64, v64, v24
  v_mfma_f32_16x16x32_bf16 v[120:123], a[136:139], a[104:107], v[120:123]
  v_mul_f32 v65, v65, v24
  v_mul_f32 v66, v66, v24
  v_mul_f32 v67, v67, v24
  v_mfma_f32_16x16x32_bf16 v[120:123], a[140:143], a[120:123], v[120:123]
  v_mul_f32 v84, v84, v68
  v_mul_f32 v85, v85, v69
  v_mul_f32 v86, v86, v70
  v_mfma_f32_16x16x32_bf16 v[124:127], a[140:143], a[124:127], v[124:127]
  v_mul_f32 v87, v87, v71
  v_mul_f32 v68, v68, v25
  v_mul_f32 v69, v69, v25
  v_mfma_f32_16x16x32_bf16 v[124:127], a[136:139], a[108:111], v[124:127]
  v_mul_f32 v70, v70, v25
  v_mul_f32 v71, v71, v25
  v_mul_f32 v88, v88, v72
  s_waitcnt lgkmcnt(4)
  v_mfma_f32_16x16x32_bf16 v[112:115], a[144:147], a[0:3], v[112:115]
  ds_read_b128 a[136:139], v11 offset:31744
  v_mul_f32 v89, v89, v73
  v_mul_f32 v90, v90, v74
  v_mfma_f32_16x16x32_bf16 v[112:115], a[148:151], a[16:19], v[112:115]
  ds_read_b128 a[140:143], v11 offset:46080
  v_mul_f32 v91, v91, v75
  v_mul_f32 v72, v72, v26
  v_mfma_f32_16x16x32_bf16 v[116:119], a[148:151], a[20:23], v[116:119]
  v_mul_f32 v73, v73, v26
  v_mul_f32 v74, v74, v26
  v_mul_f32 v75, v75, v26
  v_mfma_f32_16x16x32_bf16 v[116:119], a[144:147], a[4:7], v[116:119]
  v_mul_f32 v92, v92, v76
  v_mul_f32 v93, v93, v77
  v_mul_f32 v94, v94, v78
  v_mfma_f32_16x16x32_bf16 v[120:123], a[144:147], a[8:11], v[120:123]
  v_mul_f32 v95, v95, v79
  v_mul_f32 v76, v76, v27
  v_mul_f32 v77, v77, v27
  v_mfma_f32_16x16x32_bf16 v[120:123], a[148:151], a[24:27], v[120:123]
  v_mul_f32 v78, v78, v27
  v_mul_f32 v79, v79, v27
  v_mfma_f32_16x16x32_bf16 v[124:127], a[148:151], a[28:31], v[124:127]
  v_exp_f32 v64, v64
  v_mfma_f32_16x16x32_bf16 v[124:127], a[144:147], a[12:15], v[124:127]
  v_exp_f32 v65, v65
  v_exp_f32 v66, v66
  s_waitcnt lgkmcnt(4)
  v_mfma_f32_16x16x32_bf16 v[112:115], a[152:155], a[32:35], v[112:115]
  ds_read_b128 a[144:147], v10 offset:3072
  v_exp_f32 v67, v67
  v_mfma_f32_16x16x32_bf16 v[112:115], a[156:159], a[48:51], v[112:115]
  ds_read_b128 a[148:151], v10 offset:17408
  v_exp_f32 v68, v68
  v_mfma_f32_16x16x32_bf16 v[116:119], a[156:159], a[52:55], v[116:119]
  v_exp_f32 v69, v69
  v_mfma_f32_16x16x32_bf16 v[116:119], a[152:155], a[36:39], v[116:119]
  v_exp_f32 v70, v70
  v_exp_f32 v71, v71
  v_mfma_f32_16x16x32_bf16 v[120:123], a[152:155], a[40:43], v[120:123]
  v_exp_f32 v72, v72
  v_mfma_f32_16x16x32_bf16 v[120:123], a[156:159], a[56:59], v[120:123]
  v_exp_f32 v73, v73
  v_exp_f32 v74, v74
  v_mfma_f32_16x16x32_bf16 v[124:127], a[156:159], a[60:63], v[124:127]
  v_exp_f32 v75, v75
  v_mfma_f32_16x16x32_bf16 v[124:127], a[152:155], a[44:47], v[124:127]
  v_exp_f32 v76, v76
  s_waitcnt lgkmcnt(4)
  v_mfma_f32_16x16x32_bf16 v[128:131], a[128:131], a[64:67], v[128:131]
  ds_read_b128 a[152:155], v10 offset:31744
  v_exp_f32 v77, v77
  v_mfma_f32_16x16x32_bf16 v[128:131], a[132:135], a[80:83], v[128:131]
  ds_read_b128 a[156:159], v10 offset:46080
  v_exp_f32 v78, v78
  v_mfma_f32_16x16x32_bf16 v[132:135], a[132:135], a[84:87], v[132:135]
  v_exp_f32 v79, v79
  v_fma_f32 v64, v64, v20, v20
  v_fma_f32 v65, v65, v20, v20
  v_mfma_f32_16x16x32_bf16 v[132:135], a[128:131], a[68:71], v[132:135]
  v_fma_f32 v66, v66, v20, v20
  v_fma_f32 v67, v67, v20, v20
  v_fma_f32 v68, v68, v21, v21
  v_mfma_f32_16x16x32_bf16 v[136:139], a[128:131], a[72:75], v[136:139]
  v_fma_f32 v69, v69, v21, v21
  v_fma_f32 v70, v70, v21, v21
  v_fma_f32 v71, v71, v21, v21
  v_mfma_f32_16x16x32_bf16 v[136:139], a[132:135], a[88:91], v[136:139]
  v_fma_f32 v72, v72, v22, v22
  v_fma_f32 v73, v73, v22, v22
  v_fma_f32 v74, v74, v22, v22
  v_mfma_f32_16x16x32_bf16 v[140:143], a[132:135], a[92:95], v[140:143]
  v_fma_f32 v75, v75, v22, v22
  v_fma_f32 v76, v76, v23, v23
  v_fma_f32 v77, v77, v23, v23
  v_mfma_f32_16x16x32_bf16 v[140:143], a[128:131], a[76:79], v[140:143]
  v_fma_f32 v78, v78, v23, v23
  v_fma_f32 v79, v79, v23, v23
  s_waitcnt lgkmcnt(4)
  v_mfma_f32_16x16x32_bf16 v[128:131], a[136:139], a[96:99], v[128:131]
  ds_read_b128 a[128:131], v11 offset:3328
  v_rcp_f32 v64, v64
  v_mfma_f32_16x16x32_bf16 v[128:131], a[140:143], a[112:115], v[128:131]
  ds_read_b128 a[132:135], v11 offset:17664
  v_rcp_f32 v65, v65
  v_mfma_f32_16x16x32_bf16 v[132:135], a[140:143], a[116:119], v[132:135]
  v_rcp_f32 v66, v66
  v_mfma_f32_16x16x32_bf16 v[132:135], a[136:139], a[100:103], v[132:135]
  v_rcp_f32 v67, v67
  v_rcp_f32 v68, v68
  v_mfma_f32_16x16x32_bf16 v[136:139], a[136:139], a[104:107], v[136:139]
  v_rcp_f32 v69, v69
  v_mfma_f32_16x16x32_bf16 v[136:139], a[140:143], a[120:123], v[136:139]
  v_rcp_f32 v70, v70
  v_rcp_f32 v71, v71
  v_mfma_f32_16x16x32_bf16 v[140:143], a[140:143], a[124:127], v[140:143]
  v_rcp_f32 v72, v72
  v_mfma_f32_16x16x32_bf16 v[140:143], a[136:139], a[108:111], v[140:143]
  v_rcp_f32 v73, v73
  v_rcp_f32 v74, v74
  s_waitcnt lgkmcnt(4)
  v_mfma_f32_16x16x32_bf16 v[128:131], a[144:147], a[0:3], v[128:131]
  ds_read_b128 a[136:139], v11 offset:32000
  v_rcp_f32 v75, v75
  v_mfma_f32_16x16x32_bf16 v[128:131], a[148:151], a[16:19], v[128:131]
  ds_read_b128 a[140:143], v11 offset:46336
  v_rcp_f32 v76, v76
  v_mfma_f32_16x16x32_bf16 v[132:135], a[148:151], a[20:23], v[132:135]
  v_rcp_f32 v77, v77
  v_mfma_f32_16x16x32_bf16 v[132:135], a[144:147], a[4:7], v[132:135]
  v_rcp_f32 v78, v78
  v_mfma_f32_16x16x32_bf16 v[136:139], a[144:147], a[8:11], v[136:139]
  v_rcp_f32 v79, v79
  v_mul_f32 v80, v80, v64
  v_mul_f32 v81, v81, v65
  v_mfma_f32_16x16x32_bf16 v[136:139], a[148:151], a[24:27], v[136:139]
  v_mul_f32 v82, v82, v66
  v_mul_f32 v83, v83, v67
  v_mul_f32 v84, v84, v68
  v_mfma_f32_16x16x32_bf16 v[140:143], a[148:151], a[28:31], v[140:143]
  v_mul_f32 v85, v85, v69
  v_mul_f32 v86, v86, v70
  v_mul_f32 v87, v87, v71
  v_mfma_f32_16x16x32_bf16 v[140:143], a[144:147], a[12:15], v[140:143]
  v_mul_f32 v88, v88, v72
  v_mul_f32 v89, v89, v73
  v_mul_f32 v90, v90, v74
  s_waitcnt lgkmcnt(4)
  v_mfma_f32_16x16x32_bf16 v[128:131], a[152:155], a[32:35], v[128:131]
  ds_read_b128 a[144:147], v10 offset:3328
  v_mul_f32 v91, v91, v75
  v_mul_f32 v92, v92, v76
  v_mfma_f32_16x16x32_bf16 v[128:131], a[156:159], a[48:51], v[128:131]
  ds_read_b128 a[148:151], v10 offset:17664
  v_mul_f32 v93, v93, v77
  v_mul_f32 v94, v94, v78
  v_mfma_f32_16x16x32_bf16 v[132:135], a[156:159], a[52:55], v[132:135]
  v_mul_f32 v95, v95, v79
  v_cvt_pk_bf16_f32 v64, v80, v81
  v_cvt_pk_bf16_f32 v65, v82, v83
  v_mfma_f32_16x16x32_bf16 v[132:135], a[152:155], a[36:39], v[132:135]
  v_cvt_pk_bf16_f32 v66, v84, v85
  v_cvt_pk_bf16_f32 v67, v86, v87
  v_cvt_pk_bf16_f32 v68, v88, v89
  v_mfma_f32_16x16x32_bf16 v[136:139], a[152:155], a[40:43], v[136:139]
  v_cvt_pk_bf16_f32 v69, v90, v91
  v_cvt_pk_bf16_f32 v70, v92, v93
  v_cvt_pk_bf16_f32 v71, v94, v95
  v_mfma_f32_16x16x32_bf16 v[136:139], a[156:159], a[56:59], v[136:139]
  v_permlane32_swap_b32 v64, v66
  v_permlane32_swap_b32 v65, v67
  v_mfma_f32_16x16x32_bf16 v[140:143], a[156:159], a[60:63], v[140:143]
  v_permlane32_swap_b32 v68, v70
  v_permlane32_swap_b32 v69, v71
  s_add_u32 s44, s92, 16384
  v_mfma_f32_16x16x32_bf16 v[140:143], a[152:155], a[44:47], v[140:143]
  buffer_store_dwordx4 v[64:67], v13, s[20:23], s44 offen sc1
  s_add_u32 s44, s92, 245760
  s_waitcnt lgkmcnt(4)
  v_mfma_f32_16x16x32_bf16 v[144:147], a[128:131], a[64:67], v[144:147]
  ds_read_b128 a[152:155], v10 offset:32000
  buffer_store_dwordx4 v[68:71], v13, s[20:23], s44 offen sc1
  v_mfma_f32_16x16x32_bf16 v[144:147], a[132:135], a[80:83], v[144:147]
  ds_read_b128 a[156:159], v10 offset:46336
  v_mul_f32 v112, v112, v96
  v_mul_f32 v113, v113, v97
  v_mfma_f32_16x16x32_bf16 v[148:151], a[132:135], a[84:87], v[148:151]
  v_mul_f32 v114, v114, v98
  v_mul_f32 v115, v115, v99
  v_mul_f32 v96, v96, v24
  v_mfma_f32_16x16x32_bf16 v[148:151], a[128:131], a[68:71], v[148:151]
  v_mul_f32 v97, v97, v24
  v_mul_f32 v98, v98, v24
  v_mul_f32 v99, v99, v24
  v_mfma_f32_16x16x32_bf16 v[152:155], a[128:131], a[72:75], v[152:155]
  v_mul_f32 v116, v116, v100
  v_mul_f32 v117, v117, v101
  v_mul_f32 v118, v118, v102
  v_mfma_f32_16x16x32_bf16 v[152:155], a[132:135], a[88:91], v[152:155]
  v_mul_f32 v119, v119, v103
  v_mul_f32 v100, v100, v25
  v_mul_f32 v101, v101, v25
  v_mfma_f32_16x16x32_bf16 v[156:159], a[132:135], a[92:95], v[156:159]
  v_mul_f32 v102, v102, v25
  v_mul_f32 v103, v103, v25
  v_mul_f32 v120, v120, v104
  v_mfma_f32_16x16x32_bf16 v[156:159], a[128:131], a[76:79], v[156:159]
  v_mul_f32 v121, v121, v105
  v_mul_f32 v122, v122, v106
  s_waitcnt lgkmcnt(4)
  v_mfma_f32_16x16x32_bf16 v[144:147], a[136:139], a[96:99], v[144:147]
  ds_read_b128 a[128:131], v11 offset:4096
  v_mul_f32 v123, v123, v107
  v_mul_f32 v104, v104, v26
  v_mfma_f32_16x16x32_bf16 v[144:147], a[140:143], a[112:115], v[144:147]
  ds_read_b128 a[132:135], v11 offset:18432
  v_mul_f32 v105, v105, v26
  v_mul_f32 v106, v106, v26
  v_mfma_f32_16x16x32_bf16 v[148:151], a[140:143], a[116:119], v[148:151]
  v_mul_f32 v107, v107, v26
  v_mul_f32 v124, v124, v108
  v_mul_f32 v125, v125, v109
  v_mfma_f32_16x16x32_bf16 v[148:151], a[136:139], a[100:103], v[148:151]
  v_mul_f32 v126, v126, v110
  v_mul_f32 v127, v127, v111
  v_mul_f32 v108, v108, v27
  v_mfma_f32_16x16x32_bf16 v[152:155], a[136:139], a[104:107], v[152:155]
  v_mul_f32 v109, v109, v27
  v_mul_f32 v110, v110, v27
  v_mul_f32 v111, v111, v27
  v_mfma_f32_16x16x32_bf16 v[152:155], a[140:143], a[120:123], v[152:155]
  v_exp_f32 v96, v96
  v_mfma_f32_16x16x32_bf16 v[156:159], a[140:143], a[124:127], v[156:159]
  v_exp_f32 v97, v97
  v_exp_f32 v98, v98
  v_mfma_f32_16x16x32_bf16 v[156:159], a[136:139], a[108:111], v[156:159]
  v_exp_f32 v99, v99
  s_waitcnt lgkmcnt(4)
  v_mfma_f32_16x16x32_bf16 v[144:147], a[144:147], a[0:3], v[144:147]
  ds_read_b128 a[136:139], v11 offset:32768
  v_exp_f32 v100, v100
  v_mfma_f32_16x16x32_bf16 v[144:147], a[148:151], a[16:19], v[144:147]
  ds_read_b128 a[140:143], v11 offset:47104
  v_exp_f32 v101, v101
  v_mfma_f32_16x16x32_bf16 v[148:151], a[148:151], a[20:23], v[148:151]
  v_exp_f32 v102, v102
  v_mfma_f32_16x16x32_bf16 v[148:151], a[144:147], a[4:7], v[148:151]
  v_exp_f32 v103, v103
  v_exp_f32 v104, v104
  v_mfma_f32_16x16x32_bf16 v[152:155], a[144:147], a[8:11], v[152:155]
  v_exp_f32 v105, v105
  v_mfma_f32_16x16x32_bf16 v[152:155], a[148:151], a[24:27], v[152:155]
  v_exp_f32 v106, v106
  v_exp_f32 v107, v107
  v_mfma_f32_16x16x32_bf16 v[156:159], a[148:151], a[28:31], v[156:159]
  v_exp_f32 v108, v108
  v_mfma_f32_16x16x32_bf16 v[156:159], a[144:147], a[12:15], v[156:159]
  v_exp_f32 v109, v109
  v_exp_f32 v110, v110
  s_waitcnt lgkmcnt(4)
  v_mfma_f32_16x16x32_bf16 v[144:147], a[152:155], a[32:35], v[144:147]
  ds_read_b128 a[144:147], v10 offset:4096
  v_exp_f32 v111, v111
  v_mfma_f32_16x16x32_bf16 v[144:147], a[156:159], a[48:51], v[144:147]
  ds_read_b128 a[148:151], v10 offset:18432
  v_fma_f32 v96, v96, v20, v20
  v_fma_f32 v97, v97, v20, v20
  v_mfma_f32_16x16x32_bf16 v[148:151], a[156:159], a[52:55], v[148:151]
  v_fma_f32 v98, v98, v20, v20
  v_fma_f32 v99, v99, v20, v20
  v_fma_f32 v100, v100, v21, v21
  v_mfma_f32_16x16x32_bf16 v[148:151], a[152:155], a[36:39], v[148:151]
  v_fma_f32 v101, v101, v21, v21
  v_fma_f32 v102, v102, v21, v21
  v_mfma_f32_16x16x32_bf16 v[152:155], a[152:155], a[40:43], v[152:155]
  v_fma_f32 v103, v103, v21, v21
  v_fma_f32 v104, v104, v22, v22
  v_fma_f32 v105, v105, v22, v22
  v_mfma_f32_16x16x32_bf16 v[152:155], a[156:159], a[56:59], v[152:155]
  v_fma_f32 v106, v106, v22, v22
  v_fma_f32 v107, v107, v22, v22
  v_fma_f32 v108, v108, v23, v23
  v_mfma_f32_16x16x32_bf16 v[156:159], a[156:159], a[60:63], v[156:159]
  v_fma_f32 v109, v109, v23, v23
  v_fma_f32 v110, v110, v23, v23
  v_fma_f32 v111, v111, v23, v23
  v_mfma_f32_16x16x32_bf16 v[156:159], a[152:155], a[44:47], v[156:159]
  v_rcp_f32 v96, v96
  s_waitcnt lgkmcnt(4)
  v_mfma_f32_16x16x32_bf16 v[160:163], a[128:131], a[64:67], v[160:163]
  ds_read_b128 a[152:155], v10 offset:32768
  v_rcp_f32 v97, v97
  v_mfma_f32_16x16x32_bf16 v[160:163], a[132:135], a[80:83], v[160:163]
  ds_read_b128 a[156:159], v10 offset:47104
  v_rcp_f32 v98, v98
  v_mfma_f32_16x16x32_bf16 v[164:167], a[132:135], a[84:87], v[164:167]
  v_rcp_f32 v99, v99
  v_rcp_f32 v100, v100
  v_mfma_f32_16x16x32_bf16 v[164:167], a[128:131], a[68:71], v[164:167]
  v_rcp_f32 v101, v101
  v_mfma_f32_16x16x32_bf16 v[168:171], a[128:131], a[72:75], v[168:171]
  v_rcp_f32 v102, v102
  v_rcp_f32 v103, v103
  v_mfma_f32_16x16x32_bf16 v[168:171], a[132:135], a[88:91], v[168:171]
  v_rcp_f32 v104, v104
  v_mfma_f32_16x16x32_bf16 v[172:175], a[132:135], a[92:95], v[172:175]
  v_rcp_f32 v105, v105
  v_mfma_f32_16x16x32_bf16 v[172:175], a[128:131], a[76:79], v[172:175]
  v_rcp_f32 v106, v106
  v_rcp_f32 v107, v107
  s_waitcnt lgkmcnt(4)
  v_mfma_f32_16x16x32_bf16 v[160:163], a[136:139], a[96:99], v[160:163]
  ds_read_b128 a[128:131], v11 offset:4352
  v_rcp_f32 v108, v108
  v_mfma_f32_16x16x32_bf16 v[160:163], a[140:143], a[112:115], v[160:163]
  ds_read_b128 a[132:135], v11 offset:18688
  v_rcp_f32 v109, v109
  v_mfma_f32_16x16x32_bf16 v[164:167], a[140:143], a[116:119], v[164:167]
  v_rcp_f32 v110, v110
  v_mfma_f32_16x16x32_bf16 v[164:167], a[136:139], a[100:103], v[164:167]
  v_rcp_f32 v111, v111
  v_mul_f32 v112, v112, v96
  v_mul_f32 v113, v113, v97
  v_mfma_f32_16x16x32_bf16 v[168:171], a[136:139], a[104:107], v[168:171]
  v_mul_f32 v114, v114, v98
  v_mul_f32 v115, v115, v99
  v_mul_f32 v116, v116, v100
  v_mfma_f32_16x16x32_bf16 v[168:171], a[140:143], a[120:123], v[168:171]
  v_mul_f32 v117, v117, v101
  v_mul_f32 v118, v118, v102
  v_mul_f32 v119, v119, v103
  v_mfma_f32_16x16x32_bf16 v[172:175], a[140:143], a[124:127], v[172:175]
  v_mul_f32 v120, v120, v104
  v_mul_f32 v121, v121, v105
  v_mul_f32 v122, v122, v106
  v_mfma_f32_16x16x32_bf16 v[172:175], a[136:139], a[108:111], v[172:175]
  v_mul_f32 v123, v123, v107
  v_mul_f32 v124, v124, v108
  s_waitcnt lgkmcnt(4)
  v_mfma_f32_16x16x32_bf16 v[160:163], a[144:147], a[0:3], v[160:163]
  ds_read_b128 a[136:139], v11 offset:33024
  v_mul_f32 v125, v125, v109
  v_mul_f32 v126, v126, v110
  v_mfma_f32_16x16x32_bf16 v[160:163], a[148:151], a[16:19], v[160:163]
  ds_read_b128 a[140:143], v11 offset:47360
  v_mul_f32 v127, v127, v111
  v_cvt_pk_bf16_f32 v96, v112, v113
  v_mfma_f32_16x16x32_bf16 v[164:167], a[148:151], a[20:23], v[164:167]
  v_cvt_pk_bf16_f32 v97, v114, v115
  v_cvt_pk_bf16_f32 v98, v116, v117
  v_cvt_pk_bf16_f32 v99, v118, v119
  v_mfma_f32_16x16x32_bf16 v[164:167], a[144:147], a[4:7], v[164:167]
  v_cvt_pk_bf16_f32 v100, v120, v121
  v_cvt_pk_bf16_f32 v101, v122, v123
  v_cvt_pk_bf16_f32 v102, v124, v125
  v_mfma_f32_16x16x32_bf16 v[168:171], a[144:147], a[8:11], v[168:171]
  v_cvt_pk_bf16_f32 v103, v126, v127
  v_permlane32_swap_b32 v96, v98
  v_permlane32_swap_b32 v97, v99
  v_mfma_f32_16x16x32_bf16 v[168:171], a[148:151], a[24:27], v[168:171]
  v_permlane32_swap_b32 v100, v102
  v_permlane32_swap_b32 v101, v103
  s_add_u32 s44, s92, 32768
  v_mfma_f32_16x16x32_bf16 v[172:175], a[148:151], a[28:31], v[172:175]
  buffer_store_dwordx4 v[96:99], v13, s[20:23], s44 offen sc1
  s_add_u32 s44, s92, 262144
  v_mfma_f32_16x16x32_bf16 v[172:175], a[144:147], a[12:15], v[172:175]
  buffer_store_dwordx4 v[100:103], v13, s[20:23], s44 offen sc1
  s_waitcnt vmcnt(2)
  s_barrier
  s_cmp_lg_u32 s30, 0
  s_cbranch_scc1 h1a_skip
  v_mov_b32 v7, 1
  s_mov_b64 exec, 1
  buffer_atomic_add v7, v8, s[24:27], s93 offen sc1
  s_mov_b64 exec, -1
h1a_skip:
  s_lshl_b32 s39, s100, 16
  s_waitcnt lgkmcnt(4)
  v_mfma_f32_16x16x32_bf16 v[160:163], a[152:155], a[32:35], v[160:163]
  ds_read_b128 a[144:147], v10 offset:4352
  s_lshl_b32 s40, s101, 12
  s_add_u32 s39, s39, s40
  v_mfma_f32_16x16x32_bf16 v[160:163], a[156:159], a[48:51], v[160:163]
  ds_read_b128 a[148:151], v10 offset:18688
  s_lshl_b32 s40, s3, 22
  v_mfma_f32_16x16x32_bf16 v[164:167], a[156:159], a[52:55], v[164:167]
  s_add_u32 s39, s39, s40
  s_add_u32 s56, s6, s39
  s_addc_u32 s57, s7, 0
  v_mfma_f32_16x16x32_bf16 v[164:167], a[152:155], a[36:39], v[164:167]
  s_mov_b32 s58, 4096
  s_mov_b32 s59, 0x20000
  v_mfma_f32_16x16x32_bf16 v[168:171], a[152:155], a[40:43], v[168:171]
  buffer_load_dwordx4 v[96:99], v13, s[56:59], 0 offen offset:0
  buffer_load_dwordx4 v[100:103], v13, s[56:59], 0 offen offset:1024
  v_mfma_f32_16x16x32_bf16 v[168:171], a[156:159], a[56:59], v[168:171]
  buffer_load_dwordx4 v[104:107], v13, s[56:59], 0 offen offset:2048
  v_mfma_f32_16x16x32_bf16 v[172:175], a[156:159], a[60:63], v[172:175]
  buffer_load_dwordx4 v[108:111], v13, s[56:59], 0 offen offset:3072
  v_mul_f32 v144, v144, v128
  v_mul_f32 v145, v145, v129
  v_mfma_f32_16x16x32_bf16 v[172:175], a[152:155], a[44:47], v[172:175]
  v_mul_f32 v146, v146, v130
  v_mul_f32 v147, v147, v131
  v_mul_f32 v128, v128, v24
  s_waitcnt lgkmcnt(4)
  v_mfma_f32_16x16x32_bf16 v[176:179], a[128:131], a[64:67], v[176:179]
  ds_read_b128 a[152:155], v10 offset:33024
  v_mul_f32 v129, v129, v24
  v_mul_f32 v130, v130, v24
  v_mfma_f32_16x16x32_bf16 v[176:179], a[132:135], a[80:83], v[176:179]
  ds_read_b128 a[156:159], v10 offset:47360
  v_mul_f32 v131, v131, v24
  v_mul_f32 v148, v148, v132
  v_mfma_f32_16x16x32_bf16 v[180:183], a[132:135], a[84:87], v[180:183]
  v_mul_f32 v149, v149, v133
  v_mul_f32 v150, v150, v134
  v_mul_f32 v151, v151, v135
  v_mfma_f32_16x16x32_bf16 v[180:183], a[128:131], a[68:71], v[180:183]
  v_mul_f32 v132, v132, v25
  v_mul_f32 v133, v133, v25
  v_mfma_f32_16x16x32_bf16 v[184:187], a[128:131], a[72:75], v[184:187]
  v_mul_f32 v134, v134, v25
  v_mul_f32 v135, v135, v25
  v_mul_f32 v152, v152, v136
  v_mfma_f32_16x16x32_bf16 v[184:187], a[132:135], a[88:91], v[184:187]
  v_mul_f32 v153, v153, v137
  v_mul_f32 v154, v154, v138
  v_mul_f32 v155, v155, v139
  v_mfma_f32_16x16x32_bf16 v[188:191], a[132:135], a[92:95], v[188:191]
  v_mul_f32 v136, v136, v26
  v_mul_f32 v137, v137, v26
  v_mul_f32 v138, v138, v26
  v_mfma_f32_16x16x32_bf16 v[188:191], a[128:131], a[76:79], v[188:191]
  v_mul_f32 v139, v139, v26
  v_mul_f32 v156, v156, v140
  v_mul_f32 v157, v157, v141
  s_waitcnt lgkmcnt(4)
  v_mfma_f32_16x16x32_bf16 v[176:179], a[136:139], a[96:99], v[176:179]
  ds_read_b128 a[128:131], v11 offset:5120
  v_mul_f32 v158, v158, v142
  v_mul_f32 v159, v159, v143
  v_mfma_f32_16x16x32_bf16 v[176:179], a[140:143], a[112:115], v[176:179]
  ds_read_b128 a[132:135], v11 offset:19456
  v_mul_f32 v140, v140, v27
  v_mul_f32 v141, v141, v27
  v_mfma_f32_16x16x32_bf16 v[180:183], a[140:143], a[116:119], v[180:183]
  v_mul_f32 v142, v142, v27
  v_mul_f32 v143, v143, v27
  v_mfma_f32_16x16x32_bf16 v[180:183], a[136:139], a[100:103], v[180:183]
  v_exp_f32 v128, v128
  v_exp_f32 v129, v129
  v_mfma_f32_16x16x32_bf16 v[184:187], a[136:139], a[104:107], v[184:187]
  v_exp_f32 v130, v130
  v_mfma_f32_16x16x32_bf16 v[184:187], a[140:143], a[120:123], v[184:187]
  v_exp_f32 v131, v131
  v_mfma_f32_16x16x32_bf16 v[188:191], a[140:143], a[124:127], v[188:191]
  v_exp_f32 v132, v132
  v_exp_f32 v133, v133
  v_mfma_f32_16x16x32_bf16 v[188:191], a[136:139], a[108:111], v[188:191]
  v_exp_f32 v134, v134
  s_waitcnt lgkmcnt(4)
  v_mfma_f32_16x16x32_bf16 v[176:179], a[144:147], a[0:3], v[176:179]
  ds_read_b128 a[136:139], v11 offset:33792
  v_exp_f32 v135, v135
  v_mfma_f32_16x16x32_bf16 v[176:179], a[148:151], a[16:19], v[176:179]
  ds_read_b128 a[140:143], v11 offset:48128
  v_exp_f32 v136, v136
  v_mfma_f32_16x16x32_bf16 v[180:183], a[148:151], a[20:23], v[180:183]
  v_exp_f32 v137, v137
  v_exp_f32 v138, v138
  v_mfma_f32_16x16x32_bf16 v[180:183], a[144:147], a[4:7], v[180:183]
  v_exp_f32 v139, v139
  v_mfma_f32_16x16x32_bf16 v[184:187], a[144:147], a[8:11], v[184:187]
  v_exp_f32 v140, v140
  v_exp_f32 v141, v141
  v_mfma_f32_16x16x32_bf16 v[184:187], a[148:151], a[24:27], v[184:187]
  v_exp_f32 v142, v142
  v_mfma_f32_16x16x32_bf16 v[188:191], a[148:151], a[28:31], v[188:191]
  v_exp_f32 v143, v143
  v_fma_f32 v128, v128, v20, v20
  v_fma_f32 v129, v129, v20, v20
  v_mfma_f32_16x16x32_bf16 v[188:191], a[144:147], a[12:15], v[188:191]
  v_fma_f32 v130, v130, v20, v20
  v_fma_f32 v131, v131, v20, v20
  s_waitcnt lgkmcnt(4)
  v_mfma_f32_16x16x32_bf16 v[176:179], a[152:155], a[32:35], v[176:179]
  ds_read_b128 a[144:147], v10 offset:5120
  v_fma_f32 v132, v132, v21, v21
  v_fma_f32 v133, v133, v21, v21
  v_mfma_f32_16x16x32_bf16 v[176:179], a[156:159], a[48:51], v[176:179]
  ds_read_b128 a[148:151], v10 offset:19456
  v_fma_f32 v134, v134, v21, v21
  v_fma_f32 v135, v135, v21, v21
  v_mfma_f32_16x16x32_bf16 v[180:183], a[156:159], a[52:55], v[180:183]
  v_fma_f32 v136, v136, v22, v22
  v_fma_f32 v137, v137, v22, v22
  v_fma_f32 v138, v138, v22, v22
  v_mfma_f32_16x16x32_bf16 v[180:183], a[152:155], a[36:39], v[180:183]
  v_fma_f32 v139, v139, v22, v22
  v_fma_f32 v140, v140, v23, v23
  v_fma_f32 v141, v141, v23, v23
  v_mfma_f32_16x16x32_bf16 v[184:187], a[152:155], a[40:43], v[184:187]
  v_fma_f32 v142, v142, v23, v23
  v_fma_f32 v143, v143, v23, v23
  v_mfma_f32_16x16x32_bf16 v[184:187], a[156:159], a[56:59], v[184:187]
  v_rcp_f32 v128, v128
  v_rcp_f32 v129, v129
  v_mfma_f32_16x16x32_bf16 v[188:191], a[156:159], a[60:63], v[188:191]
  v_rcp_f32 v130, v130
  v_mfma_f32_16x16x32_bf16 v[188:191], a[152:155], a[44:47], v[188:191]
  v_rcp_f32 v131, v131
  v_rcp_f32 v132, v132
  s_waitcnt lgkmcnt(4)
  v_mfma_f32_16x16x32_bf16 v[192:195], a[128:131], a[64:67], v[192:195]
  ds_read_b128 a[152:155], v10 offset:33792
  v_rcp_f32 v133, v133
  v_mfma_f32_16x16x32_bf16 v[192:195], a[132:135], a[80:83], v[192:195]
  ds_read_b128 a[156:159], v10 offset:48128
  v_mfma_f32_16x16x32_bf16 v[196:199], a[132:135], a[84:87], v[196:199]
  v_rcp_f32 v134, v134
  v_rcp_f32 v135, v135
  v_mfma_f32_16x16x32_bf16 v[196:199], a[128:131], a[68:71], v[196:199]
  v_rcp_f32 v136, v136
  v_mfma_f32_16x16x32_bf16 v[200:203], a[128:131], a[72:75], v[200:203]
  v_rcp_f32 v137, v137
  v_rcp_f32 v138, v138
  v_mfma_f32_16x16x32_bf16 v[200:203], a[132:135], a[88:91], v[200:203]
  v_rcp_f32 v139, v139
  v_mfma_f32_16x16x32_bf16 v[204:207], a[132:135], a[92:95], v[204:207]
  v_rcp_f32 v140, v140
  v_rcp_f32 v141, v141
  v_mfma_f32_16x16x32_bf16 v[204:207], a[128:131], a[76:79], v[204:207]
  v_rcp_f32 v142, v142
  s_waitcnt lgkmcnt(4)
  v_mfma_f32_16x16x32_bf16 v[192:195], a[136:139], a[96:99], v[192:195]
  ds_read_b128 a[128:131], v11 offset:5376
  v_rcp_f32 v143, v143
  v_mul_f32 v144, v144, v128
  v_mfma_f32_16x16x32_bf16 v[192:195], a[140:143], a[112:115], v[192:195]
  ds_read_b128 a[132:135], v11 offset:19712
  v_mul_f32 v145, v145, v129
  v_mul_f32 v146, v146, v130
  v_mfma_f32_16x16x32_bf16 v[196:199], a[140:143], a[116:119], v[196:199]
  v_mul_f32 v147, v147, v131
  v_mul_f32 v148, v148, v132
  v_mul_f32 v149, v149, v133
  v_mfma_f32_16x16x32_bf16 v[196:199], a[136:139], a[100:103], v[196:199]
  v_mul_f32 v150, v150, v134
  v_mul_f32 v151, v151, v135
  v_mfma_f32_16x16x32_bf16 v[200:203], a[136:139], a[104:107], v[200:203]
  v_mul_f32 v152, v152, v136
  v_mul_f32 v153, v153, v137
  v_mul_f32 v154, v154, v138
  v_mfma_f32_16x16x32_bf16 v[200:203], a[140:143], a[120:123], v[200:203]
  v_mul_f32 v155, v155, v139
  v_mul_f32 v156, v156, v140
  v_mul_f32 v157, v157, v141
  v_mfma_f32_16x16x32_bf16 v[204:207], a[140:143], a[124:127], v[204:207]
  v_mul_f32 v158, v158, v142
  v_mul_f32 v159, v159, v143
  v_cvt_pk_bf16_f32 v128, v144, v145
  v_mfma_f32_16x16x32_bf16 v[204:207], a[136:139], a[108:111], v[204:207]
  v_cvt_pk_bf16_f32 v129, v146, v147
  v_cvt_pk_bf16_f32 v130, v148, v149
  v_cvt_pk_bf16_f32 v131, v150, v151
  s_waitcnt lgkmcnt(4)
  v_mfma_f32_16x16x32_bf16 v[192:195], a[144:147], a[0:3], v[192:195]
  ds_read_b128 a[136:139], v11 offset:34048
  v_cvt_pk_bf16_f32 v132, v152, v153
  v_cvt_pk_bf16_f32 v133, v154, v155
  v_mfma_f32_16x16x32_bf16 v[192:195], a[148:151], a[16:19], v[192:195]
  ds_read_b128 a[140:143], v11 offset:48384
  v_cvt_pk_bf16_f32 v134, v156, v157
  v_cvt_pk_bf16_f32 v135, v158, v159
  v_mfma_f32_16x16x32_bf16 v[196:199], a[148:151], a[20:23], v[196:199]
  v_permlane32_swap_b32 v128, v130
  v_permlane32_swap_b32 v129, v131
  v_permlane32_swap_b32 v132, v134
  v_mfma_f32_16x16x32_bf16 v[196:199], a[144:147], a[4:7], v[196:199]
  v_permlane32_swap_b32 v133, v135
  s_add_u32 s44, s92, 49152
  v_mfma_f32_16x16x32_bf16 v[200:203], a[144:147], a[8:11], v[200:203]
  buffer_store_dwordx4 v[128:131], v13, s[20:23], s44 offen sc1
  s_add_u32 s44, s92, 278528
  v_mfma_f32_16x16x32_bf16 v[200:203], a[148:151], a[24:27], v[200:203]
  buffer_store_dwordx4 v[132:135], v13, s[20:23], s44 offen sc1
  s_waitcnt vmcnt(2)
  v_permlane32_swap_b32 v96, v98
  v_mfma_f32_16x16x32_bf16 v[204:207], a[148:151], a[28:31], v[204:207]
  v_permlane32_swap_b32 v97, v99
  v_permlane32_swap_b32 v100, v102
  v_permlane32_swap_b32 v101, v103
  v_mfma_f32_16x16x32_bf16 v[204:207], a[144:147], a[12:15], v[204:207]
  v_permlane32_swap_b32 v104, v106
  v_permlane32_swap_b32 v105, v107
  v_permlane32_swap_b32 v108, v110
  s_waitcnt lgkmcnt(4)
  v_mfma_f32_16x16x32_bf16 v[192:195], a[152:155], a[32:35], v[192:195]
  ds_read_b128 a[144:147], v10 offset:5376
  v_permlane32_swap_b32 v109, v111
  v_lshlrev_b32 v32, 16, v96
  v_mfma_f32_16x16x32_bf16 v[192:195], a[156:159], a[48:51], v[192:195]
  ds_read_b128 a[148:151], v10 offset:19712
  v_and_b32 v33, 0xffff0000, v96
  v_lshlrev_b32 v34, 16, v97
  v_mfma_f32_16x16x32_bf16 v[196:199], a[156:159], a[52:55], v[196:199]
  buffer_load_dword v9, v8, s[24:27], s94 offen sc1
  v_and_b32 v35, 0xffff0000, v97
  v_mfma_f32_16x16x32_bf16 v[196:199], a[152:155], a[36:39], v[196:199]
  v_lshlrev_b32 v36, 16, v98
  v_and_b32 v37, 0xffff0000, v98
  v_lshlrev_b32 v38, 16, v99
  v_mfma_f32_16x16x32_bf16 v[200:203], a[152:155], a[40:43], v[200:203]
  v_and_b32 v39, 0xffff0000, v99
  v_lshlrev_b32 v40, 16, v100
  v_and_b32 v41, 0xffff0000, v100
  v_mfma_f32_16x16x32_bf16 v[200:203], a[156:159], a[56:59], v[200:203]
  v_lshlrev_b32 v42, 16, v101
  v_and_b32 v43, 0xffff0000, v101
  v_lshlrev_b32 v44, 16, v102
  v_mfma_f32_16x16x32_bf16 v[204:207], a[156:159], a[60:63], v[204:207]
  v_and_b32 v45, 0xffff0000, v102
  v_lshlrev_b32 v46, 16, v103
  v_and_b32 v47, 0xffff0000, v103
  v_mfma_f32_16x16x32_bf16 v[204:207], a[152:155], a[44:47], v[204:207]
  v_lshlrev_b32 v48, 16, v104
  v_and_b32 v49, 0xffff0000, v104
  s_waitcnt lgkmcnt(4)
  v_mfma_f32_16x16x32_bf16 v[208:211], a[128:131], a[64:67], v[208:211]
  ds_read_b128 a[152:155], v10 offset:34048
  v_lshlrev_b32 v50, 16, v105
  v_and_b32 v51, 0xffff0000, v105
  v_mfma_f32_16x16x32_bf16 v[208:211], a[132:135], a[80:83], v[208:211]
  ds_read_b128 a[156:159], v10 offset:48384
  v_lshlrev_b32 v52, 16, v106
  v_and_b32 v53, 0xffff0000, v106
  v_mfma_f32_16x16x32_bf16 v[212:215], a[132:135], a[84:87], v[212:215]
  v_lshlrev_b32 v54, 16, v107
  v_and_b32 v55, 0xffff0000, v107
  v_lshlrev_b32 v56, 16, v108
  v_mfma_f32_16x16x32_bf16 v[212:215], a[128:131], a[68:71], v[212:215]
  v_and_b32 v57, 0xffff0000, v108
  v_lshlrev_b32 v58, 16, v109
  v_and_b32 v59, 0xffff0000, v109
  v_mfma_f32_16x16x32_bf16 v[216:219], a[128:131], a[72:75], v[216:219]
  v_lshlrev_b32 v60, 16, v110
  v_and_b32 v61, 0xffff0000, v110
  v_lshlrev_b32 v62, 16, v111
  v_mfma_f32_16x16x32_bf16 v[216:219], a[132:135], a[88:91], v[216:219]
  v_and_b32 v63, 0xffff0000, v111
  v_mov_b32 v64, 0
  v_mov_b32 v65, 0
  v_mfma_f32_16x16x32_bf16 v[220:223], a[132:135], a[92:95], v[220:223]
  v_mov_b32 v66, 0
  v_mov_b32 v67, 0
  v_mov_b32 v68, 0
  v_mfma_f32_16x16x32_bf16 v[220:223], a[128:131], a[76:79], v[220:223]
  v_mov_b32 v69, 0
  v_mov_b32 v70, 0
  v_mov_b32 v71, 0
  s_waitcnt lgkmcnt(4)
  v_mfma_f32_16x16x32_bf16 v[208:211], a[136:139], a[96:99], v[208:211]
  ds_read_b128 a[128:131], v11 offset:6144
  v_mov_b32 v72, 0
  v_mov_b32 v73, 0
  v_mfma_f32_16x16x32_bf16 v[208:211], a[140:143], a[112:115], v[208:211]
  ds_read_b128 a[132:135], v11 offset:20480
  v_mov_b32 v74, 0
  v_mfma_f32_16x16x32_bf16 v[212:215], a[140:143], a[116:119], v[212:215]
  v_mov_b32 v75, 0
  v_mov_b32 v76, 0
  v_mov_b32 v77, 0
  v_mfma_f32_16x16x32_bf16 v[212:215], a[136:139], a[100:103], v[212:215]
  v_mov_b32 v78, 0
  v_mov_b32 v79, 0
  v_mov_b32 v80, 0
  v_mfma_f32_16x16x32_bf16 v[216:219], a[136:139], a[104:107], v[216:219]
  v_mov_b32 v81, 0
  v_mov_b32 v82, 0
  v_mov_b32 v83, 0
  v_mfma_f32_16x16x32_bf16 v[216:219], a[140:143], a[120:123], v[216:219]
  v_mov_b32 v84, 0
  v_mov_b32 v85, 0
  v_mov_b32 v86, 0
  v_mfma_f32_16x16x32_bf16 v[220:223], a[140:143], a[124:127], v[220:223]
  v_mov_b32 v87, 0
  v_mov_b32 v88, 0
  v_mov_b32 v89, 0
  v_mfma_f32_16x16x32_bf16 v[220:223], a[136:139], a[108:111], v[220:223]
  v_mov_b32 v90, 0
  v_mov_b32 v91, 0
  v_mov_b32 v92, 0
  s_waitcnt lgkmcnt(4)
  v_mfma_f32_16x16x32_bf16 v[208:211], a[144:147], a[0:3], v[208:211]
  ds_read_b128 a[136:139], v11 offset:34816
  v_mov_b32 v93, 0
  v_mov_b32 v94, 0
  v_mfma_f32_16x16x32_bf16 v[208:211], a[148:151], a[16:19], v[208:211]
  ds_read_b128 a[140:143], v11 offset:49152
  v_mov_b32 v95, 0
  v_mul_f32 v176, v176, v160
  v_mfma_f32_16x16x32_bf16 v[212:215], a[148:151], a[20:23], v[212:215]
  s_waitcnt vmcnt(0)
h1c_chk:
  v_cmp_gt_u32 vcc, 8, v9
  s_nop 4
  s_cbranch_vccz h1c_ok
  s_sleep 1
  buffer_load_dword v9, v8, s[24:27], s94 offen sc1
  s_sub_u32 s90, s90, 1
  s_cmp_lg_u32 s90, 0
  s_waitcnt vmcnt(0)
  s_cbranch_scc1 h1c_chk
h1c_ok:
  buffer_load_dwordx4 a[160:163], v12, s[8:11], s33 offen offset:0
  v_mul_f32 v177, v177, v161
  v_mfma_f32_16x16x32_bf16 v[212:215], a[144:147], a[4:7], v[212:215]
  v_mul_f32 v178, v178, v162
  v_mul_f32 v179, v179, v163
  v_mfma_f32_16x16x32_bf16 v[216:219], a[144:147], a[8:11], v[216:219]
  v_mul_f32 v160, v160, v24
  v_mul_f32 v161, v161, v24
  v_mul_f32 v162, v162, v24
  v_mfma_f32_16x16x32_bf16 v[216:219], a[148:151], a[24:27], v[216:219]
  buffer_load_dwordx4 a[164:167], v12, s[8:11], s33 offen offset:256
  v_mul_f32 v163, v163, v24
  v_mfma_f32_16x16x32_bf16 v[220:223], a[148:151], a[28:31], v[220:223]
  v_mul_f32 v180, v180, v164
  v_mul_f32 v181, v181, v165
  v_mul_f32 v182, v182, v166
  v_mfma_f32_16x16x32_bf16 v[220:223], a[144:147], a[12:15], v[220:223]
  v_mul_f32 v183, v183, v167
  v_mul_f32 v164, v164, v25
  v_mul_f32 v165, v165, v25
  s_waitcnt lgkmcnt(4)
  v_mfma_f32_16x16x32_bf16 v[208:211], a[152:155], a[32:35], v[208:211]
  ds_read_b128 a[144:147], v10 offset:6144
  v_mul_f32 v166, v166, v25
  v_mul_f32 v167, v167, v25
  v_mfma_f32_16x16x32_bf16 v[208:211], a[156:159], a[48:51], v[208:211]
  ds_read_b128 a[148:151], v10 offset:20480
  v_mul_f32 v184, v184, v168
  v_mul_f32 v185, v185, v169
  v_mfma_f32_16x16x32_bf16 v[212:215], a[156:159], a[52:55], v[212:215]
  buffer_load_dwordx4 a[168:171], v12, s[8:11], s33 offen offset:2048
  v_mul_f32 v186, v186, v170
  v_mfma_f32_16x16x32_bf16 v[212:215], a[152:155], a[36:39], v[212:215]
  v_mul_f32 v187, v187, v171
  v_mul_f32 v168, v168, v26
  v_mul_f32 v169, v169, v26
  v_mfma_f32_16x16x32_bf16 v[216:219], a[152:155], a[40:43], v[216:219]
  v_mul_f32 v170, v170, v26
  v_mul_f32 v171, v171, v26
  v_mul_f32 v188, v188, v172
  v_mfma_f32_16x16x32_bf16 v[216:219], a[156:159], a[56:59], v[216:219]
  buffer_load_dwordx4 a[172:175], v12, s[8:11], s33 offen offset:2304
  v_mfma_f32_16x16x32_bf16 v[220:223], a[156:159], a[60:63], v[220:223]
  v_mul_f32 v189, v189, v173
  v_mul_f32 v190, v190, v174
  v_mul_f32 v191, v191, v175
  v_mfma_f32_16x16x32_bf16 v[220:223], a[152:155], a[44:47], v[220:223]
  v_mul_f32 v172, v172, v27
  v_mul_f32 v173, v173, v27
  v_mul_f32 v174, v174, v27
  s_waitcnt lgkmcnt(4)
  v_mfma_f32_16x16x32_bf16 v[224:227], a[128:131], a[64:67], v[224:227]
  ds_read_b128 a[152:155], v10 offset:34816
  v_mul_f32 v175, v175, v27
  v_mfma_f32_16x16x32_bf16 v[224:227], a[132:135], a[80:83], v[224:227]
  ds_read_b128 a[156:159], v10 offset:49152
  v_exp_f32 v160, v160
  v_mfma_f32_16x16x32_bf16 v[228:231], a[132:135], a[84:87], v[228:231]
  s_add_u32 s33, s33, 0x1000
  buffer_load_dwordx4 a[176:179], v12, s[8:11], s33 offen offset:0
  v_mfma_f32_16x16x32_bf16 v[228:231], a[128:131], a[68:71], v[228:231]
  v_exp_f32 v161, v161
  v_exp_f32 v162, v162
  v_mfma_f32_16x16x32_bf16 v[232:235], a[128:131], a[72:75], v[232:235]
  v_exp_f32 v163, v163
  v_mfma_f32_16x16x32_bf16 v[232:235], a[132:135], a[88:91], v[232:235]
  buffer_load_dwordx4 a[180:183], v12, s[8:11], s33 offen offset:256
  v_exp_f32 v164, v164
  v_mfma_f32_16x16x32_bf16 v[236:239], a[132:135], a[92:95], v[236:239]
  v_exp_f32 v165, v165
  v_mfma_f32_16x16x32_bf16 v[236:239], a[128:131], a[76:79], v[236:239]
  v_exp_f32 v166, v166
  s_waitcnt lgkmcnt(4)
  v_mfma_f32_16x16x32_bf16 v[224:227], a[136:139], a[96:99], v[224:227]
  ds_read_b128 a[128:131], v11 offset:6400
  v_exp_f32 v167, v167
  v_mfma_f32_16x16x32_bf16 v[224:227], a[140:143], a[112:115], v[224:227]
  ds_read_b128 a[132:135], v11 offset:20736
  v_exp_f32 v168, v168
  v_mfma_f32_16x16x32_bf16 v[228:231], a[140:143], a[116:119], v[228:231]
  buffer_load_dwordx4 a[184:187], v12, s[8:11], s33 offen offset:2048
  v_exp_f32 v169, v169
  v_mfma_f32_16x16x32_bf16 v[228:231], a[136:139], a[100:103], v[228:231]
  v_exp_f32 v170, v170
  v_mfma_f32_16x16x32_bf16 v[232:235], a[136:139], a[104:107], v[232:235]
  v_exp_f32 v171, v171
  v_exp_f32 v172, v172
  v_mfma_f32_16x16x32_bf16 v[232:235], a[140:143], a[120:123], v[232:235]
  buffer_load_dwordx4 a[188:191], v12, s[8:11], s33 offen offset:2304
  v_mfma_f32_16x16x32_bf16 v[236:239], a[140:143], a[124:127], v[236:239]
  v_exp_f32 v173, v173
  v_exp_f32 v174, v174
  v_mfma_f32_16x16x32_bf16 v[236:239], a[136:139], a[108:111], v[236:239]
  v_exp_f32 v175, v175
  v_fma_f32 v160, v160, v20, v20
  s_waitcnt lgkmcnt(4)
  v_mfma_f32_16x16x32_bf16 v[224:227], a[144:147], a[0:3], v[224:227]
  ds_read_b128 a[136:139], v11 offset:35072
  v_fma_f32 v161, v161, v20, v20
  v_fma_f32 v162, v162, v20, v20
  v_mfma_f32_16x16x32_bf16 v[224:227], a[148:151], a[16:19], v[224:227]
  ds_read_b128 a[140:143], v11 offset:49408
  v_fma_f32 v163, v163, v20, v20
  v_mfma_f32_16x16x32_bf16 v[228:231], a[148:151], a[20:23], v[228:231]
  s_add_u32 s33, s33, 0x1000
  buffer_load_dwordx4 a[192:195], v12, s[8:11], s33 offen offset:0
  v_mfma_f32_16x16x32_bf16 v[228:231], a[144:147], a[4:7], v[228:231]
  v_fma_f32 v164, v164, v21, v21
  v_fma_f32 v165, v165, v21, v21
  v_fma_f32 v166, v166, v21, v21
  v_mfma_f32_16x16x32_bf16 v[232:235], a[144:147], a[8:11], v[232:235]
  v_fma_f32 v167, v167, v21, v21
  v_fma_f32 v168, v168, v22, v22
  v_fma_f32 v169, v169, v22, v22
  v_mfma_f32_16x16x32_bf16 v[232:235], a[148:151], a[24:27], v[232:235]
  buffer_load_dwordx4 a[196:199], v12, s[8:11], s33 offen offset:256
  v_fma_f32 v170, v170, v22, v22
  v_mfma_f32_16x16x32_bf16 v[236:239], a[148:151], a[28:31], v[236:239]
  v_fma_f32 v171, v171, v22, v22
  v_fma_f32 v172, v172, v23, v23
  v_fma_f32 v173, v173, v23, v23
  v_mfma_f32_16x16x32_bf16 v[236:239], a[144:147], a[12:15], v[236:239]
  v_fma_f32 v174, v174, v23, v23
  v_fma_f32 v175, v175, v23, v23
  s_waitcnt lgkmcnt(4)
  v_mfma_f32_16x16x32_bf16 v[224:227], a[152:155], a[32:35], v[224:227]
  ds_read_b128 a[144:147], v10 offset:6400
  v_rcp_f32 v160, v160
  v_mfma_f32_16x16x32_bf16 v[224:227], a[156:159], a[48:51], v[224:227]
  ds_read_b128 a[148:151], v10 offset:20736
  v_rcp_f32 v161, v161
  v_mfma_f32_16x16x32_bf16 v[228:231], a[156:159], a[52:55], v[228:231]
  buffer_load_dwordx4 a[200:203], v12, s[8:11], s33 offen offset:2048
  v_rcp_f32 v162, v162
  v_mfma_f32_16x16x32_bf16 v[228:231], a[152:155], a[36:39], v[228:231]
  v_rcp_f32 v163, v163
  v_mfma_f32_16x16x32_bf16 v[232:235], a[152:155], a[40:43], v[232:235]
  v_rcp_f32 v164, v164
  v_mfma_f32_16x16x32_bf16 v[232:235], a[156:159], a[56:59], v[232:235]
  buffer_load_dwordx4 a[204:207], v12, s[8:11], s33 offen offset:2304
  v_rcp_f32 v165, v165
  v_mfma_f32_16x16x32_bf16 v[236:239], a[156:159], a[60:63], v[236:239]
  v_rcp_f32 v166, v166
  v_mfma_f32_16x16x32_bf16 v[236:239], a[152:155], a[44:47], v[236:239]
  v_rcp_f32 v167, v167
  v_rcp_f32 v168, v168
  s_waitcnt lgkmcnt(4)
  v_mfma_f32_16x16x32_bf16 v[240:243], a[128:131], a[64:67], v[240:243]
  ds_read_b128 a[152:155], v10 offset:35072
  v_rcp_f32 v169, v169
  v_mfma_f32_16x16x32_bf16 v[240:243], a[132:135], a[80:83], v[240:243]
  ds_read_b128 a[156:159], v10 offset:49408
  v_rcp_f32 v170, v170
  v_mfma_f32_16x16x32_bf16 v[244:247], a[132:135], a[84:87], v[244:247]
  s_add_u32 s33, s33, 0x1000
  buffer_load_dwordx4 a[208:211], v12, s[8:11], s33 offen offset:0
  v_mfma_f32_16x16x32_bf16 v[244:247], a[128:131], a[68:71], v[244:247]
  v_rcp_f32 v171, v171
  v_mfma_f32_16x16x32_bf16 v[248:251], a[128:131], a[72:75], v[248:251]
  v_rcp_f32 v172, v172
  v_rcp_f32 v173, v173
  v_mfma_f32_16x16x32_bf16 v[248:251], a[132:135], a[88:91], v[248:251]
  buffer_load_dwordx4 a[212:215], v12, s[8:11], s33 offen offset:256
  v_mfma_f32_16x16x32_bf16 v[252:255], a[132:135], a[92:95], v[252:255]
  v_rcp_f32 v174, v174
  v_mfma_f32_16x16x32_bf16 v[252:255], a[128:131], a[76:79], v[252:255]
  v_rcp_f32 v175, v175
  v_mul_f32 v176, v176, v160
  v_mul_f32 v177, v177, v161
  s_waitcnt lgkmcnt(4)
  v_mfma_f32_16x16x32_bf16 v[240:243], a[136:139], a[96:99], v[240:243]
  v_mul_f32 v178, v178, v162
  v_mul_f32 v179, v179, v163
  v_mul_f32 v180, v180, v164
  v_mfma_f32_16x16x32_bf16 v[240:243], a[140:143], a[112:115], v[240:243]
  v_mul_f32 v181, v181, v165
  v_mul_f32 v182, v182, v166
  v_mul_f32 v183, v183, v167
  v_mfma_f32_16x16x32_bf16 v[244:247], a[140:143], a[116:119], v[244:247]
  buffer_load_dwordx4 a[216:219], v12, s[8:11], s33 offen offset:2048
  v_mul_f32 v184, v184, v168
  v_mfma_f32_16x16x32_bf16 v[244:247], a[136:139], a[100:103], v[244:247]
  v_mul_f32 v185, v185, v169
  v_mul_f32 v186, v186, v170
  v_mul_f32 v187, v187, v171
  v_mfma_f32_16x16x32_bf16 v[248:251], a[136:139], a[104:107], v[248:251]
  v_mul_f32 v188, v188, v172
  v_mul_f32 v189, v189, v173
  v_mul_f32 v190, v190, v174
  v_mfma_f32_16x16x32_bf16 v[248:251], a[140:143], a[120:123], v[248:251]
  buffer_load_dwordx4 a[220:223], v12, s[8:11], s33 offen offset:2304
  v_mul_f32 v191, v191, v175
  v_mfma_f32_16x16x32_bf16 v[252:255], a[140:143], a[124:127], v[252:255]
  v_cvt_pk_bf16_f32 v160, v176, v177
  v_cvt_pk_bf16_f32 v161, v178, v179
  v_cvt_pk_bf16_f32 v162, v180, v181
  v_mfma_f32_16x16x32_bf16 v[252:255], a[136:139], a[108:111], v[252:255]
  v_cvt_pk_bf16_f32 v163, v182, v183
  v_cvt_pk_bf16_f32 v164, v184, v185
  s_waitcnt lgkmcnt(2)
  v_mfma_f32_16x16x32_bf16 v[240:243], a[144:147], a[0:3], v[240:243]
  v_cvt_pk_bf16_f32 v165, v186, v187
  v_cvt_pk_bf16_f32 v166, v188, v189
  v_cvt_pk_bf16_f32 v167, v190, v191
  v_mfma_f32_16x16x32_bf16 v[240:243], a[148:151], a[16:19], v[240:243]
  v_permlane32_swap_b32 v160, v162
  v_permlane32_swap_b32 v161, v163
  v_permlane32_swap_b32 v164, v166
  v_mfma_f32_16x16x32_bf16 v[244:247], a[148:151], a[20:23], v[244:247]
  s_waitcnt lgkmcnt(0)
  s_waitcnt vmcnt(17)
  s_barrier
  s_cmp_lg_u32 s30, 0
  s_cbranch_scc1 hba_skip
  v_mov_b32 v7, 1
  s_mov_b64 exec, 1
  buffer_atomic_add v7, v8, s[24:27], s42 offen sc1
  s_mov_b64 exec, -1
hba_skip:
  s_add_u32 m0, s35, 0
  s_nop 0
  buffer_load_dwordx4 v2, s[16:19], s34 offen offset:0 lds
  v_mfma_f32_16x16x32_bf16 v[244:247], a[144:147], a[4:7], v[244:247]
  buffer_load_dwordx4 v2, s[16:19], s34 offen offset:1024 lds
  v_mfma_f32_16x16x32_bf16 v[248:251], a[144:147], a[8:11], v[248:251]
  v_permlane32_swap_b32 v165, v167
  s_add_u32 s44, s92, 65536
  v_mfma_f32_16x16x32_bf16 v[248:251], a[148:151], a[24:27], v[248:251]
  buffer_load_dwordx4 v2, s[16:19], s34 offen offset:2048 lds
  buffer_store_dwordx4 v[160:163], v13, s[20:23], s44 offen sc1
  v_mfma_f32_16x16x32_bf16 v[252:255], a[148:151], a[28:31], v[252:255]
  buffer_load_dwordx4 v2, s[16:19], s34 offen offset:3072 lds
  s_add_u32 s44, s92, 294912
  v_mfma_f32_16x16x32_bf16 v[252:255], a[144:147], a[12:15], v[252:255]
  buffer_store_dwordx4 v[164:167], v13, s[20:23], s44 offen sc1
  s_waitcnt lgkmcnt(0)
  v_mfma_f32_16x16x32_bf16 v[240:243], a[152:155], a[32:35], v[240:243]
  v_mfma_f32_16x16x32_bf16 v[240:243], a[156:159], a[48:51], v[240:243]
  v_mfma_f32_16x16x32_bf16 v[244:247], a[156:159], a[52:55], v[244:247]
  s_add_u32 m0, s35, 4096
  s_nop 0
  buffer_load_dwordx4 v3, s[16:19], s34 offen offset:0 lds
  v_mfma_f32_16x16x32_bf16 v[244:247], a[152:155], a[36:39], v[244:247]
  buffer_load_dwordx4 v3, s[16:19], s34 offen offset:1024 lds
  v_mfma_f32_16x16x32_bf16 v[248:251], a[152:155], a[40:43], v[248:251]
  v_mfma_f32_16x16x32_bf16 v[248:251], a[156:159], a[56:59], v[248:251]
  buffer_load_dwordx4 v3, s[16:19], s34 offen offset:2048 lds
  v_mfma_f32_16x16x32_bf16 v[252:255], a[156:159], a[60:63], v[252:255]
  buffer_load_dwordx4 v3, s[16:19], s34 offen offset:3072 lds
  s_add_u32 s34, s34, 32768
  v_mfma_f32_16x16x32_bf16 v[252:255], a[152:155], a[44:47], v[252:255]
  v_and_b32 v4, 15, v0
  v_lshlrev_b32 v4, 4, v4
  v_bfe_u32 v5, v0, 4, 1
  v_lshl_add_u32 v4, v5, 9, v4
  v_lshl_add_u32 v12, v15, 10, v4
  v_lshl_add_u32 v13, v15, 8, v4
  v_mul_u32_u24 v5, 4096, v15
  v_add_u32 v4, v4, v5
  v_add_u32 v10, 98304, v4
  v_add_u32 v11, 32768, v4
  ds_read_b128 a[64:67], v10 offset:34816
  ds_read_b128 a[68:71], v10 offset:43008
  ds_read_b128 a[72:75], v10 offset:51200
  ds_read_b128 a[76:79], v10 offset:59392
  ds_read_b128 a[80:83], v10 offset:35072
  ds_read_b128 a[84:87], v10 offset:43264
  ds_read_b128 a[88:91], v10 offset:51456
  ds_read_b128 a[92:95], v10 offset:59648
  ds_read_b128 a[96:99], v10 offset:35840
  ds_read_b128 a[100:103], v10 offset:44032
  ds_read_b128 a[104:107], v10 offset:52224
  ds_read_b128 a[108:111], v10 offset:60416
  s_mov_b32 s38, 2
  s_waitcnt vmcnt(16) lgkmcnt(8)
  v_mfma_f32_16x16x32_bf16 v[64:67], a[64:67], a[160:163], v[64:67]
  ds_read_b128 a[112:115], v10 offset:36096
  v_mfma_f32_16x16x32_bf16 v[64:67], a[68:71], a[168:171], v[64:67]
  ds_read_b128 a[116:119], v10 offset:44288
  s_add_u32 s33, s33, 0x1000
  buffer_load_dwordx4 a[0:3], v12, s[8:11], s33 offen offset:0
  v_mfma_f32_16x16x32_bf16 v[64:67], a[72:75], a[176:179], v[64:67]
  ds_read_b128 a[120:123], v10 offset:52480
  v_mfma_f32_16x16x32_bf16 v[64:67], a[76:79], a[184:187], v[64:67]
  ds_read_b128 a[124:127], v10 offset:60672
  s_add_u32 m0, s36, 32768
  s_nop 0
  buffer_load_dwordx4 v2, s[16:19], s34 offen offset:0 lds
  v_mfma_f32_16x16x32_bf16 v[68:71], a[76:79], a[188:191], v[68:71]
  v_mfma_f32_16x16x32_bf16 v[68:71], a[72:75], a[180:183], v[68:71]
  buffer_load_dwordx4 v2, s[16:19], s34 offen offset:1024 lds
  v_mfma_f32_16x16x32_bf16 v[68:71], a[68:71], a[172:175], v[68:71]
  v_mfma_f32_16x16x32_bf16 v[68:71], a[64:67], a[164:167], v[68:71]
  s_waitcnt lgkmcnt(8)
  v_mfma_f32_16x16x32_bf16 v[72:75], a[80:83], a[160:163], v[72:75]
  ds_read_b128 a[64:67], v10 offset:32768
  v_mul_f32 v208, v208, v192
  v_mul_f32 v209, v209, v193
  v_mfma_f32_16x16x32_bf16 v[72:75], a[84:87], a[168:171], v[72:75]
  ds_read_b128 a[68:71], v10 offset:40960
  buffer_load_dwordx4 a[4:7], v12, s[8:11], s33 offen offset:256
  v_mul_f32 v210, v210, v194
  v_mul_f32 v211, v211, v195
  v_mfma_f32_16x16x32_bf16 v[72:75], a[88:91], a[176:179], v[72:75]
  ds_read_b128 a[72:75], v10 offset:49152
  v_mul_f32 v192, v192, v24
  v_mul_f32 v193, v193, v24
  v_mfma_f32_16x16x32_bf16 v[72:75], a[92:95], a[184:187], v[72:75]
  ds_read_b128 a[76:79], v10 offset:57344
  buffer_load_dwordx4 v2, s[16:19], s34 offen offset:2048 lds
  v_mul_f32 v194, v194, v24
  v_mul_f32 v195, v195, v24
  v_mfma_f32_16x16x32_bf16 v[76:79], a[92:95], a[188:191], v[76:79]
  v_mul_f32 v212, v212, v196
  v_mul_f32 v213, v213, v197
  v_mfma_f32_16x16x32_bf16 v[76:79], a[88:91], a[180:183], v[76:79]
  buffer_load_dwordx4 v2, s[16:19], s34 offen offset:3072 lds
  v_mul_f32 v214, v214, v198
  v_mul_f32 v215, v215, v199
  v_mfma_f32_16x16x32_bf16 v[76:79], a[84:87], a[172:175], v[76:79]
  v_mul_f32 v196, v196, v25
  v_mul_f32 v197, v197, v25
  v_mfma_f32_16x16x32_bf16 v[76:79], a[80:83], a[164:167], v[76:79]
  v_mul_f32 v198, v198, v25
  s_waitcnt lgkmcnt(8)
  v_mfma_f32_16x16x32_bf16 v[80:83], a[96:99], a[160:163], v[80:83]
  ds_read_b128 a[80:83], v10 offset:33024
  v_mul_f32 v199, v199, v25
  v_mul_f32 v216, v216, v200
  v_mfma_f32_16x16x32_bf16 v[80:83], a[100:103], a[168:171], v[80:83]
  ds_read_b128 a[84:87], v10 offset:41216
  buffer_load_dwordx4 a[8:11], v12, s[8:11], s33 offen offset:2048
  v_mul_f32 v217, v217, v201
  v_mul_f32 v218, v218, v202
  v_mfma_f32_16x16x32_bf16 v[80:83], a[104:107], a[176:179], v[80:83]
  ds_read_b128 a[88:91], v10 offset:49408
  v_mul_f32 v219, v219, v203
  v_mul_f32 v200, v200, v26
  v_mfma_f32_16x16x32_bf16 v[80:83], a[108:111], a[184:187], v[80:83]
  ds_read_b128 a[92:95], v10 offset:57600
  s_add_u32 m0, s36, 36864
  s_nop 0
  buffer_load_dwordx4 v3, s[16:19], s34 offen offset:0 lds
  v_mul_f32 v201, v201, v26
  v_mul_f32 v202, v202, v26
  v_mfma_f32_16x16x32_bf16 v[84:87], a[108:111], a[188:191], v[84:87]
  v_mul_f32 v203, v203, v26
  v_mul_f32 v220, v220, v204
  v_mfma_f32_16x16x32_bf16 v[84:87], a[104:107], a[180:183], v[84:87]
  buffer_load_dwordx4 v3, s[16:19], s34 offen offset:1024 lds
  v_mul_f32 v221, v221, v205
  v_mul_f32 v222, v222, v206
  v_mfma_f32_16x16x32_bf16 v[84:87], a[100:103], a[172:175], v[84:87]
  v_mul_f32 v223, v223, v207
  v_mul_f32 v204, v204, v27
  v_mfma_f32_16x16x32_bf16 v[84:87], a[96:99], a[164:167], v[84:87]
  v_mul_f32 v205, v205, v27
  s_waitcnt lgkmcnt(8)
  v_mfma_f32_16x16x32_bf16 v[88:91], a[112:115], a[160:163], v[88:91]
  ds_read_b128 a[96:99], v10 offset:33792
  v_mul_f32 v206, v206, v27
  v_mul_f32 v207, v207, v27
  v_mfma_f32_16x16x32_bf16 v[88:91], a[116:119], a[168:171], v[88:91]
  ds_read_b128 a[100:103], v10 offset:41984
  buffer_load_dwordx4 a[12:15], v12, s[8:11], s33 offen offset:2304
  v_exp_f32 v192, v192
  v_exp_f32 v193, v193
  v_mfma_f32_16x16x32_bf16 v[88:91], a[120:123], a[176:179], v[88:91]
  ds_read_b128 a[104:107], v10 offset:50176
  v_exp_f32 v194, v194
  v_exp_f32 v195, v195
  v_mfma_f32_16x16x32_bf16 v[88:91], a[124:127], a[184:187], v[88:91]
  ds_read_b128 a[108:111], v10 offset:58368
  buffer_load_dwordx4 v3, s[16:19], s34 offen offset:2048 lds
  v_exp_f32 v196, v196
  v_exp_f32 v197, v197
  v_mfma_f32_16x16x32_bf16 v[92:95], a[124:127], a[188:191], v[92:95]
  v_exp_f32 v198, v198
  v_exp_f32 v199, v199
  v_mfma_f32_16x16x32_bf16 v[92:95], a[120:123], a[180:183], v[92:95]
  buffer_load_dwordx4 v3, s[16:19], s34 offen offset:3072 lds
  s_add_u32 s34, s34, 32768
  v_exp_f32 v200, v200
  v_exp_f32 v201, v201
  v_mfma_f32_16x16x32_bf16 v[92:95], a[116:119], a[172:175], v[92:95]
  v_exp_f32 v202, v202
  v_exp_f32 v203, v203
  v_mfma_f32_16x16x32_bf16 v[92:95], a[112:115], a[164:167], v[92:95]
  v_exp_f32 v204, v204
  s_waitcnt lgkmcnt(8)
  v_mfma_f32_16x16x32_bf16 v[32:35], a[64:67], a[160:163], v[32:35]
  ds_read_b128 a[112:115], v10 offset:34048
  v_exp_f32 v205, v205
  v_exp_f32 v206, v206
  v_mfma_f32_16x16x32_bf16 v[32:35], a[68:71], a[168:171], v[32:35]
  ds_read_b128 a[116:119], v10 offset:42240
  s_add_u32 s33, s33, 0x1000
  buffer_load_dwordx4 a[16:19], v12, s[8:11], s33 offen offset:0
  v_exp_f32 v207, v207
  v_fma_f32 v192, v192, v20, v20
  v_mfma_f32_16x16x32_bf16 v[32:35], a[72:75], a[176:179], v[32:35]
  ds_read_b128 a[120:123], v10 offset:50432
  v_fma_f32 v193, v193, v20, v20
  v_fma_f32 v194, v194, v20, v20
  v_mfma_f32_16x16x32_bf16 v[32:35], a[76:79], a[184:187], v[32:35]
  ds_read_b128 a[124:127], v10 offset:58624
  s_add_u32 m0, s36, 0
  s_nop 0
  buffer_load_dwordx4 v2, s[16:19], s34 offen offset:0 lds
  v_fma_f32 v195, v195, v20, v20
  v_fma_f32 v196, v196, v21, v21
  v_mfma_f32_16x16x32_bf16 v[36:39], a[76:79], a[188:191], v[36:39]
  v_fma_f32 v197, v197, v21, v21
  v_fma_f32 v198, v198, v21, v21
  v_mfma_f32_16x16x32_bf16 v[36:39], a[72:75], a[180:183], v[36:39]
  buffer_load_dwordx4 v2, s[16:19], s34 offen offset:1024 lds
  v_fma_f32 v199, v199, v21, v21
  v_fma_f32 v200, v200, v22, v22
  v_mfma_f32_16x16x32_bf16 v[36:39], a[68:71], a[172:175], v[36:39]
  v_fma_f32 v201, v201, v22, v22
  v_fma_f32 v202, v202, v22, v22
  v_mfma_f32_16x16x32_bf16 v[36:39], a[64:67], a[164:167], v[36:39]
  v_fma_f32 v203, v203, v22, v22
  s_waitcnt vmcnt(15) lgkmcnt(0)
  s_barrier
  v_mfma_f32_16x16x32_bf16 v[40:43], a[80:83], a[160:163], v[40:43]
  ds_read_b128 a[64:67], v10 offset:2048
  v_fma_f32 v204, v204, v23, v23
  v_fma_f32 v205, v205, v23, v23
  v_mfma_f32_16x16x32_bf16 v[40:43], a[84:87], a[168:171], v[40:43]
  ds_read_b128 a[68:71], v10 offset:10240
  buffer_load_dwordx4 a[20:23], v12, s[8:11], s33 offen offset:256
  v_fma_f32 v206, v206, v23, v23
  v_fma_f32 v207, v207, v23, v23
  v_mfma_f32_16x16x32_bf16 v[40:43], a[88:91], a[176:179], v[40:43]
  ds_read_b128 a[72:75], v10 offset:18432
  v_rcp_f32 v192, v192
  v_rcp_f32 v193, v193
  v_mfma_f32_16x16x32_bf16 v[40:43], a[92:95], a[184:187], v[40:43]
  ds_read_b128 a[76:79], v10 offset:26624
  buffer_load_dwordx4 v2, s[16:19], s34 offen offset:2048 lds
  v_rcp_f32 v194, v194
  v_rcp_f32 v195, v195
  v_mfma_f32_16x16x32_bf16 v[44:47], a[92:95], a[188:191], v[44:47]
  v_rcp_f32 v196, v196
  v_rcp_f32 v197, v197
  v_mfma_f32_16x16x32_bf16 v[44:47], a[88:91], a[180:183], v[44:47]
  buffer_load_dwordx4 v2, s[16:19], s34 offen offset:3072 lds
  v_rcp_f32 v198, v198
  v_rcp_f32 v199, v199
  v_mfma_f32_16x16x32_bf16 v[44:47], a[84:87], a[172:175], v[44:47]
  v_rcp_f32 v200, v200
  v_rcp_f32 v201, v201
  v_mfma_f32_16x16x32_bf16 v[44:47], a[80:83], a[164:167], v[44:47]
  v_rcp_f32 v202, v202
  s_waitcnt lgkmcnt(8)
  v_mfma_f32_16x16x32_bf16 v[48:51], a[96:99], a[160:163], v[48:51]
  ds_read_b128 a[80:83], v10 offset:2304
  v_rcp_f32 v203, v203
  v_rcp_f32 v204, v204
  v_mfma_f32_16x16x32_bf16 v[48:51], a[100:103], a[168:171], v[48:51]
  ds_read_b128 a[84:87], v10 offset:10496
  buffer_load_dwordx4 a[24:27], v12, s[8:11], s33 offen offset:2048
  v_rcp_f32 v205, v205
  v_rcp_f32 v206, v206
  v_mfma_f32_16x16x32_bf16 v[48:51], a[104:107], a[176:179], v[48:51]
  ds_read_b128 a[88:91], v10 offset:18688
  v_rcp_f32 v207, v207
  v_mul_f32 v208, v208, v192
  v_mfma_f32_16x16x32_bf16 v[48:51], a[108:111], a[184:187], v[48:51]
  ds_read_b128 a[92:95], v10 offset:26880
  s_add_u32 m0, s36, 4096
  s_nop 0
  buffer_load_dwordx4 v3, s[16:19], s34 offen offset:0 lds
  v_mul_f32 v209, v209, v193
  v_mul_f32 v210, v210, v194
  v_mfma_f32_16x16x32_bf16 v[52:55], a[108:111], a[188:191], v[52:55]
  v_mul_f32 v211, v211, v195
  v_mul_f32 v212, v212, v196
  v_mfma_f32_16x16x32_bf16 v[52:55], a[104:107], a[180:183], v[52:55]
  buffer_load_dwordx4 v3, s[16:19], s34 offen offset:1024 lds
  v_mul_f32 v213, v213, v197
  v_mul_f32 v214, v214, v198
  v_mfma_f32_16x16x32_bf16 v[52:55], a[100:103], a[172:175], v[52:55]
  v_mul_f32 v215, v215, v199
  v_mul_f32 v216, v216, v200
  v_mfma_f32_16x16x32_bf16 v[52:55], a[96:99], a[164:167], v[52:55]
  v_mul_f32 v217, v217, v201
  s_waitcnt lgkmcnt(8)
  v_mfma_f32_16x16x32_bf16 v[56:59], a[112:115], a[160:163], v[56:59]
  ds_read_b128 a[96:99], v10 offset:3072
  v_mul_f32 v218, v218, v202
  v_mul_f32 v219, v219, v203
  v_mfma_f32_16x16x32_bf16 v[56:59], a[116:119], a[168:171], v[56:59]
  ds_read_b128 a[100:103], v10 offset:11264
  buffer_load_dwordx4 a[28:31], v12, s[8:11], s33 offen offset:2304
  v_mul_f32 v220, v220, v204
  v_mul_f32 v221, v221, v205
  v_mfma_f32_16x16x32_bf16 v[56:59], a[120:123], a[176:179], v[56:59]
  ds_read_b128 a[104:107], v10 offset:19456
  v_mul_f32 v222, v222, v206
  v_mul_f32 v223, v223, v207
  v_mfma_f32_16x16x32_bf16 v[56:59], a[124:127], a[184:187], v[56:59]
  ds_read_b128 a[108:111], v10 offset:27648
  buffer_load_dwordx4 v3, s[16:19], s34 offen offset:2048 lds
  v_cvt_pk_bf16_f32 v192, v208, v209
  v_cvt_pk_bf16_f32 v193, v210, v211
  v_mfma_f32_16x16x32_bf16 v[60:63], a[124:127], a[188:191], v[60:63]
  v_cvt_pk_bf16_f32 v194, v212, v213
  v_cvt_pk_bf16_f32 v195, v214, v215
  v_mfma_f32_16x16x32_bf16 v[60:63], a[120:123], a[180:183], v[60:63]
  buffer_load_dwordx4 v3, s[16:19], s34 offen offset:3072 lds
  s_add_u32 s34, s34, 32768
  v_cvt_pk_bf16_f32 v196, v216, v217
  v_cvt_pk_bf16_f32 v197, v218, v219
  v_mfma_f32_16x16x32_bf16 v[60:63], a[116:119], a[172:175], v[60:63]
  v_cvt_pk_bf16_f32 v198, v220, v221
  v_cvt_pk_bf16_f32 v199, v222, v223
  v_mfma_f32_16x16x32_bf16 v[60:63], a[112:115], a[164:167], v[60:63]
  v_permlane32_swap_b32 v192, v194
  buffer_load_dword v9, v8, s[24:27], s45 offen sc1
  s_waitcnt vmcnt(32) lgkmcnt(8)
  v_mfma_f32_16x16x32_bf16 v[64:67], a[64:67], a[192:195], v[64:67]
  ds_read_b128 a[112:115], v10 offset:3328
  v_permlane32_swap_b32 v193, v195
  v_permlane32_swap_b32 v196, v198
  v_mfma_f32_16x16x32_bf16 v[64:67], a[68:71], a[200:203], v[64:67]
  ds_read_b128 a[116:119], v10 offset:11520
  s_add_u32 s33, s33, 0x1000
  buffer_load_dwordx4 a[32:35], v12, s[8:11], s33 offen offset:0
  v_permlane32_swap_b32 v197, v199
  s_add_u32 s44, s92, 81920
  v_mfma_f32_16x16x32_bf16 v[64:67], a[72:75], a[208:211], v[64:67]
  ds_read_b128 a[120:123], v10 offset:19712
  buffer_store_dwordx4 v[192:195], v13, s[20:23], s44 offen sc1
  s_add_u32 s44, s92, 311296
  v_mfma_f32_16x16x32_bf16 v[64:67], a[76:79], a[216:219], v[64:67]
  ds_read_b128 a[124:127], v10 offset:27904
  s_add_u32 m0, s35, 32768
  s_nop 0
  buffer_load_dwordx4 v2, s[16:19], s34 offen offset:0 lds
  buffer_store_dwordx4 v[196:199], v13, s[20:23], s44 offen sc1
  v_mul_f32 v240, v240, v224
  v_mfma_f32_16x16x32_bf16 v[68:71], a[76:79], a[220:223], v[68:71]
  v_mul_f32 v241, v241, v225
  v_mul_f32 v242, v242, v226
  v_mfma_f32_16x16x32_bf16 v[68:71], a[72:75], a[212:215], v[68:71]
  buffer_load_dwordx4 v2, s[16:19], s34 offen offset:1024 lds
  v_mul_f32 v243, v243, v227
  v_mul_f32 v224, v224, v24
  v_mfma_f32_16x16x32_bf16 v[68:71], a[68:71], a[204:207], v[68:71]
  v_mul_f32 v225, v225, v24
  v_mul_f32 v226, v226, v24
  v_mfma_f32_16x16x32_bf16 v[68:71], a[64:67], a[196:199], v[68:71]
  v_mul_f32 v227, v227, v24
  s_waitcnt lgkmcnt(8)
  v_mfma_f32_16x16x32_bf16 v[72:75], a[80:83], a[192:195], v[72:75]
  ds_read_b128 a[64:67], v10 offset:0
  v_mul_f32 v244, v244, v228
  v_mul_f32 v245, v245, v229
  v_mfma_f32_16x16x32_bf16 v[72:75], a[84:87], a[200:203], v[72:75]
  ds_read_b128 a[68:71], v10 offset:8192
  buffer_load_dwordx4 a[36:39], v12, s[8:11], s33 offen offset:256
  v_mul_f32 v246, v246, v230
  v_mul_f32 v247, v247, v231
  v_mfma_f32_16x16x32_bf16 v[72:75], a[88:91], a[208:211], v[72:75]
  ds_read_b128 a[72:75], v10 offset:16384
  v_mul_f32 v228, v228, v25
  v_mul_f32 v229, v229, v25
  v_mfma_f32_16x16x32_bf16 v[72:75], a[92:95], a[216:219], v[72:75]
  ds_read_b128 a[76:79], v10 offset:24576
  buffer_load_dwordx4 v2, s[16:19], s34 offen offset:2048 lds
  v_mul_f32 v230, v230, v25
  v_mul_f32 v231, v231, v25
  v_mfma_f32_16x16x32_bf16 v[76:79], a[92:95], a[220:223], v[76:79]
  v_mul_f32 v248, v248, v232
  v_mul_f32 v249, v249, v233
  v_mfma_f32_16x16x32_bf16 v[76:79], a[88:91], a[212:215], v[76:79]
  buffer_load_dwordx4 v2, s[16:19], s34 offen offset:3072 lds
  v_mul_f32 v250, v250, v234
  v_mul_f32 v251, v251, v235
  v_mfma_f32_16x16x32_bf16 v[76:79], a[84:87], a[204:207], v[76:79]
  v_mul_f32 v232, v232, v26
  v_mul_f32 v233, v233, v26
  v_mfma_f32_16x16x32_bf16 v[76:79], a[80:83], a[196:199], v[76:79]
  v_mul_f32 v234, v234, v26
  s_waitcnt lgkmcnt(8)
  v_mfma_f32_16x16x32_bf16 v[80:83], a[96:99], a[192:195], v[80:83]
  ds_read_b128 a[80:83], v10 offset:256
  v_mul_f32 v235, v235, v26
  v_mul_f32 v252, v252, v236
  v_mfma_f32_16x16x32_bf16 v[80:83], a[100:103], a[200:203], v[80:83]
  ds_read_b128 a[84:87], v10 offset:8448
  buffer_load_dwordx4 a[40:43], v12, s[8:11], s33 offen offset:2048
  v_mul_f32 v253, v253, v237
  v_mul_f32 v254, v254, v238
  v_mfma_f32_16x16x32_bf16 v[80:83], a[104:107], a[208:211], v[80:83]
  ds_read_b128 a[88:91], v10 offset:16640
  v_mul_f32 v255, v255, v239
  v_mul_f32 v236, v236, v27
  v_mfma_f32_16x16x32_bf16 v[80:83], a[108:111], a[216:219], v[80:83]
  ds_read_b128 a[92:95], v10 offset:24832
  v_mul_f32 v237, v237, v27
  v_mul_f32 v238, v238, v27
  v_mfma_f32_16x16x32_bf16 v[84:87], a[108:111], a[220:223], v[84:87]
  s_add_u32 m0, s35, 36864
  s_nop 0
  buffer_load_dwordx4 v3, s[16:19], s34 offen offset:0 lds
  v_mul_f32 v239, v239, v27
  v_exp_f32 v224, v224
  v_mfma_f32_16x16x32_bf16 v[84:87], a[104:107], a[212:215], v[84:87]
  v_exp_f32 v225, v225
  v_exp_f32 v226, v226
  v_mfma_f32_16x16x32_bf16 v[84:87], a[100:103], a[204:207], v[84:87]
  v_exp_f32 v227, v227
  v_exp_f32 v228, v228
  v_mfma_f32_16x16x32_bf16 v[84:87], a[96:99], a[196:199], v[84:87]
  v_exp_f32 v229, v229
  s_waitcnt lgkmcnt(8)
  v_mfma_f32_16x16x32_bf16 v[88:91], a[112:115], a[192:195], v[88:91]
  ds_read_b128 a[96:99], v10 offset:1024
  v_exp_f32 v230, v230
  v_exp_f32 v231, v231
  v_mfma_f32_16x16x32_bf16 v[88:91], a[116:119], a[200:203], v[88:91]
  ds_read_b128 a[100:103], v10 offset:9216
  buffer_load_dwordx4 a[44:47], v12, s[8:11], s33 offen offset:2304
  v_exp_f32 v232, v232
  v_exp_f32 v233, v233
  v_mfma_f32_16x16x32_bf16 v[88:91], a[120:123], a[208:211], v[88:91]
  ds_read_b128 a[104:107], v10 offset:17408
  v_exp_f32 v234, v234
  v_exp_f32 v235, v235
  v_mfma_f32_16x16x32_bf16 v[88:91], a[124:127], a[216:219], v[88:91]
  ds_read_b128 a[108:111], v10 offset:25600
  buffer_load_dwordx4 v3, s[16:19], s34 offen offset:1024 lds
  v_exp_f32 v236, v236
  v_exp_f32 v237, v237
  v_mfma_f32_16x16x32_bf16 v[92:95], a[124:127], a[220:223], v[92:95]
  v_exp_f32 v238, v238
  v_exp_f32 v239, v239
  v_mfma_f32_16x16x32_bf16 v[92:95], a[120:123], a[212:215], v[92:95]
  buffer_load_dwordx4 v3, s[16:19], s34 offen offset:2048 lds
  v_fma_f32 v224, v224, v20, v20
  v_fma_f32 v225, v225, v20, v20
  v_mfma_f32_16x16x32_bf16 v[92:95], a[116:119], a[204:207], v[92:95]
  v_fma_f32 v226, v226, v20, v20
  v_fma_f32 v227, v227, v20, v20
  v_mfma_f32_16x16x32_bf16 v[92:95], a[112:115], a[196:199], v[92:95]
  v_fma_f32 v228, v228, v21, v21
  s_waitcnt lgkmcnt(8)
  v_mfma_f32_16x16x32_bf16 v[32:35], a[64:67], a[192:195], v[32:35]
  ds_read_b128 a[112:115], v10 offset:1280
  v_fma_f32 v229, v229, v21, v21
  v_fma_f32 v230, v230, v21, v21
  v_mfma_f32_16x16x32_bf16 v[32:35], a[68:71], a[200:203], v[32:35]
  ds_read_b128 a[116:119], v10 offset:9472
  s_add_u32 s33, s33, 0x1000
  buffer_load_dwordx4 a[48:51], v12, s[8:11], s33 offen offset:0
  v_fma_f32 v231, v231, v21, v21
  v_fma_f32 v232, v232, v22, v22
  v_mfma_f32_16x16x32_bf16 v[32:35], a[72:75], a[208:211], v[32:35]
  ds_read_b128 a[120:123], v10 offset:17664
  v_fma_f32 v233, v233, v22, v22
  v_fma_f32 v234, v234, v22, v22
  v_mfma_f32_16x16x32_bf16 v[32:35], a[76:79], a[216:219], v[32:35]
  ds_read_b128 a[124:127], v10 offset:25856
  v_fma_f32 v235, v235, v22, v22
  v_fma_f32 v236, v236, v23, v23
  v_mfma_f32_16x16x32_bf16 v[36:39], a[76:79], a[220:223], v[36:39]
  buffer_load_dwordx4 v3, s[16:19], s34 offen offset:3072 lds
  s_add_u32 s34, s34, 32768
  v_fma_f32 v237, v237, v23, v23
  v_fma_f32 v238, v238, v23, v23
  v_mfma_f32_16x16x32_bf16 v[36:39], a[72:75], a[212:215], v[36:39]
  v_fma_f32 v239, v239, v23, v23
  v_rcp_f32 v224, v224
  v_mfma_f32_16x16x32_bf16 v[36:39], a[68:71], a[204:207], v[36:39]
  v_rcp_f32 v225, v225
  v_rcp_f32 v226, v226
  v_mfma_f32_16x16x32_bf16 v[36:39], a[64:67], a[196:199], v[36:39]
  v_rcp_f32 v227, v227
  s_waitcnt vmcnt(27) lgkmcnt(0)
  s_barrier
  v_mfma_f32_16x16x32_bf16 v[40:43], a[80:83], a[192:195], v[40:43]
  ds_read_b128 a[64:67], v11 offset:34816
  v_rcp_f32 v228, v228
  v_rcp_f32 v229, v229
  v_mfma_f32_16x16x32_bf16 v[40:43], a[84:87], a[200:203], v[40:43]
  ds_read_b128 a[68:71], v11 offset:43008
  buffer_load_dwordx4 a[52:55], v12, s[8:11], s33 offen offset:256
  v_rcp_f32 v230, v230
  v_rcp_f32 v231, v231
  v_mfma_f32_16x16x32_bf16 v[40:43], a[88:91], a[208:211], v[40:43]
  ds_read_b128 a[72:75], v11 offset:51200
  v_rcp_f32 v232, v232
  v_rcp_f32 v233, v233
  v_mfma_f32_16x16x32_bf16 v[40:43], a[92:95], a[216:219], v[40:43]
  ds_read_b128 a[76:79], v11 offset:59392
  v_rcp_f32 v234, v234
  v_rcp_f32 v235, v235
  v_mfma_f32_16x16x32_bf16 v[44:47], a[92:95], a[220:223], v[44:47]
  v_rcp_f32 v236, v236
  v_rcp_f32 v237, v237
  v_mfma_f32_16x16x32_bf16 v[44:47], a[88:91], a[212:215], v[44:47]
  v_rcp_f32 v238, v238
  v_rcp_f32 v239, v239
  v_mfma_f32_16x16x32_bf16 v[44:47], a[84:87], a[204:207], v[44:47]
  v_mul_f32 v240, v240, v224
  v_mul_f32 v241, v241, v225
  v_mfma_f32_16x16x32_bf16 v[44:47], a[80:83], a[196:199], v[44:47]
  v_mul_f32 v242, v242, v226
  s_waitcnt lgkmcnt(8)
  v_mfma_f32_16x16x32_bf16 v[48:51], a[96:99], a[192:195], v[48:51]
  ds_read_b128 a[80:83], v11 offset:35072
  v_mul_f32 v243, v243, v227
  v_mul_f32 v244, v244, v228
  v_mfma_f32_16x16x32_bf16 v[48:51], a[100:103], a[200:203], v[48:51]
  ds_read_b128 a[84:87], v11 offset:43264
  buffer_load_dwordx4 a[56:59], v12, s[8:11], s33 offen offset:2048
  v_mul_f32 v245, v245, v229
  v_mul_f32 v246, v246, v230
  v_mfma_f32_16x16x32_bf16 v[48:51], a[104:107], a[208:211], v[48:51]
  ds_read_b128 a[88:91], v11 offset:51456
  v_mul_f32 v247, v247, v231
  v_mul_f32 v248, v248, v232
  v_mfma_f32_16x16x32_bf16 v[48:51], a[108:111], a[216:219], v[48:51]
  ds_read_b128 a[92:95], v11 offset:59648
  v_mul_f32 v249, v249, v233
  v_mul_f32 v250, v250, v234
  v_mfma_f32_16x16x32_bf16 v[52:55], a[108:111], a[220:223], v[52:55]
  v_mul_f32 v251, v251, v235
  v_mul_f32 v252, v252, v236
  v_mfma_f32_16x16x32_bf16 v[52:55], a[104:107], a[212:215], v[52:55]
  v_mul_f32 v253, v253, v237
  v_mul_f32 v254, v254, v238
  v_mfma_f32_16x16x32_bf16 v[52:55], a[100:103], a[204:207], v[52:55]
  v_mul_f32 v255, v255, v239
  v_cvt_pk_bf16_f32 v224, v240, v241
  v_mfma_f32_16x16x32_bf16 v[52:55], a[96:99], a[196:199], v[52:55]
  v_cvt_pk_bf16_f32 v225, v242, v243
  s_waitcnt lgkmcnt(8)
  v_mfma_f32_16x16x32_bf16 v[56:59], a[112:115], a[192:195], v[56:59]
  ds_read_b128 a[96:99], v11 offset:35840
  v_cvt_pk_bf16_f32 v226, v244, v245
  v_cvt_pk_bf16_f32 v227, v246, v247
  v_mfma_f32_16x16x32_bf16 v[56:59], a[116:119], a[200:203], v[56:59]
  ds_read_b128 a[100:103], v11 offset:44032
  buffer_load_dwordx4 a[60:63], v12, s[8:11], s33 offen offset:2304
  v_cvt_pk_bf16_f32 v228, v248, v249
  v_cvt_pk_bf16_f32 v229, v250, v251
  v_mfma_f32_16x16x32_bf16 v[56:59], a[120:123], a[208:211], v[56:59]
  ds_read_b128 a[104:107], v11 offset:52224
  v_cvt_pk_bf16_f32 v230, v252, v253
  v_cvt_pk_bf16_f32 v231, v254, v255
  v_mfma_f32_16x16x32_bf16 v[56:59], a[124:127], a[216:219], v[56:59]
  ds_read_b128 a[108:111], v11 offset:60416
  v_permlane32_swap_b32 v224, v226
  v_mfma_f32_16x16x32_bf16 v[60:63], a[124:127], a[220:223], v[60:63]
  v_permlane32_swap_b32 v225, v227
  v_permlane32_swap_b32 v228, v230
  v_mfma_f32_16x16x32_bf16 v[60:63], a[120:123], a[212:215], v[60:63]
  v_permlane32_swap_b32 v229, v231
  s_add_u32 s44, s92, 98304
  v_mfma_f32_16x16x32_bf16 v[60:63], a[116:119], a[204:207], v[60:63]
  buffer_store_dwordx4 v[224:227], v13, s[20:23], s44 offen sc1
  s_add_u32 s44, s92, 327680
  v_mfma_f32_16x16x32_bf16 v[60:63], a[112:115], a[196:199], v[60:63]
  buffer_store_dwordx4 v[228:231], v13, s[20:23], s44 offen sc1
  s_waitcnt vmcnt(14)
  v_cmp_gt_u32 vcc, 8, v9
  s_nop 4
  s_cbranch_vccnz hb_chk
hb_ok:
  s_waitcnt vmcnt(22) lgkmcnt(8)
  v_mfma_f32_16x16x32_bf16 v[64:67], a[64:67], a[0:3], v[64:67]
  ds_read_b128 a[112:115], v11 offset:36096
  v_mfma_f32_16x16x32_bf16 v[64:67], a[68:71], a[8:11], v[64:67]
  ds_read_b128 a[116:119], v11 offset:44288
  s_add_u32 s33, s33, 0x1000
  buffer_load_dwordx4 a[160:163], v12, s[8:11], s33 offen offset:0
  v_mfma_f32_16x16x32_bf16 v[64:67], a[72:75], a[16:19], v[64:67]
  ds_read_b128 a[120:123], v11 offset:52480
  v_mfma_f32_16x16x32_bf16 v[64:67], a[76:79], a[24:27], v[64:67]
  ds_read_b128 a[124:127], v11 offset:60672
  s_add_u32 m0, s35, 0
  s_nop 0
  buffer_load_dwordx4 v2, s[16:19], s34 offen offset:0 lds
  v_mfma_f32_16x16x32_bf16 v[68:71], a[76:79], a[28:31], v[68:71]
  v_mfma_f32_16x16x32_bf16 v[68:71], a[72:75], a[20:23], v[68:71]
  buffer_load_dwordx4 v2, s[16:19], s34 offen offset:1024 lds
  v_mfma_f32_16x16x32_bf16 v[68:71], a[68:71], a[12:15], v[68:71]
  v_mfma_f32_16x16x32_bf16 v[68:71], a[64:67], a[4:7], v[68:71]
  s_waitcnt lgkmcnt(8)
  v_mfma_f32_16x16x32_bf16 v[72:75], a[80:83], a[0:3], v[72:75]
  ds_read_b128 a[64:67], v11 offset:32768
  v_mfma_f32_16x16x32_bf16 v[72:75], a[84:87], a[8:11], v[72:75]
  ds_read_b128 a[68:71], v11 offset:40960
  buffer_load_dwordx4 a[164:167], v12, s[8:11], s33 offen offset:256
  v_mfma_f32_16x16x32_bf16 v[72:75], a[88:91], a[16:19], v[72:75]
  ds_read_b128 a[72:75], v11 offset:49152
  v_mfma_f32_16x16x32_bf16 v[72:75], a[92:95], a[24:27], v[72:75]
  ds_read_b128 a[76:79], v11 offset:57344
  buffer_load_dwordx4 v2, s[16:19], s34 offen offset:2048 lds
  v_mfma_f32_16x16x32_bf16 v[76:79], a[92:95], a[28:31], v[76:79]
  v_mfma_f32_16x16x32_bf16 v[76:79], a[88:91], a[20:23], v[76:79]
  buffer_load_dwordx4 v2, s[16:19], s34 offen offset:3072 lds
  v_mfma_f32_16x16x32_bf16 v[76:79], a[84:87], a[12:15], v[76:79]
  v_mfma_f32_16x16x32_bf16 v[76:79], a[80:83], a[4:7], v[76:79]
  s_waitcnt lgkmcnt(8)
  v_mfma_f32_16x16x32_bf16 v[80:83], a[96:99], a[0:3], v[80:83]
  ds_read_b128 a[80:83], v11 offset:33024
  v_mfma_f32_16x16x32_bf16 v[80:83], a[100:103], a[8:11], v[80:83]
  ds_read_b128 a[84:87], v11 offset:41216
  buffer_load_dwordx4 a[168:171], v12, s[8:11], s33 offen offset:2048
  v_mfma_f32_16x16x32_bf16 v[80:83], a[104:107], a[16:19], v[80:83]
  ds_read_b128 a[88:91], v11 offset:49408
  v_mfma_f32_16x16x32_bf16 v[80:83], a[108:111], a[24:27], v[80:83]
  ds_read_b128 a[92:95], v11 offset:57600
  v_mfma_f32_16x16x32_bf16 v[84:87], a[108:111], a[28:31], v[84:87]
  s_add_u32 m0, s35, 4096
  s_nop 0
  buffer_load_dwordx4 v3, s[16:19], s34 offen offset:0 lds
  v_mfma_f32_16x16x32_bf16 v[84:87], a[104:107], a[20:23], v[84:87]
  v_mfma_f32_16x16x32_bf16 v[84:87], a[100:103], a[12:15], v[84:87]
  v_mfma_f32_16x16x32_bf16 v[84:87], a[96:99], a[4:7], v[84:87]
  s_waitcnt lgkmcnt(8)
  v_mfma_f32_16x16x32_bf16 v[88:91], a[112:115], a[0:3], v[88:91]
  ds_read_b128 a[96:99], v11 offset:33792
  v_mfma_f32_16x16x32_bf16 v[88:91], a[116:119], a[8:11], v[88:91]
  ds_read_b128 a[100:103], v11 offset:41984
  buffer_load_dwordx4 a[172:175], v12, s[8:11], s33 offen offset:2304
  v_mfma_f32_16x16x32_bf16 v[88:91], a[120:123], a[16:19], v[88:91]
  ds_read_b128 a[104:107], v11 offset:50176
  v_mfma_f32_16x16x32_bf16 v[88:91], a[124:127], a[24:27], v[88:91]
  ds_read_b128 a[108:111], v11 offset:58368
  buffer_load_dwordx4 v3, s[16:19], s34 offen offset:1024 lds
  v_mfma_f32_16x16x32_bf16 v[92:95], a[124:127], a[28:31], v[92:95]
  v_mfma_f32_16x16x32_bf16 v[92:95], a[120:123], a[20:23], v[92:95]
  buffer_load_dwordx4 v3, s[16:19], s34 offen offset:2048 lds
  v_mfma_f32_16x16x32_bf16 v[92:95], a[116:119], a[12:15], v[92:95]
  v_mfma_f32_16x16x32_bf16 v[92:95], a[112:115], a[4:7], v[92:95]
  s_waitcnt lgkmcnt(8)
  v_mfma_f32_16x16x32_bf16 v[32:35], a[64:67], a[0:3], v[32:35]
  ds_read_b128 a[112:115], v11 offset:34048
  v_mfma_f32_16x16x32_bf16 v[32:35], a[68:71], a[8:11], v[32:35]
  ds_read_b128 a[116:119], v11 offset:42240
  s_add_u32 s33, s33, 0x1000
  buffer_load_dwordx4 a[176:179], v12, s[8:11], s33 offen offset:0
  v_mfma_f32_16x16x32_bf16 v[32:35], a[72:75], a[16:19], v[32:35]
  ds_read_b128 a[120:123], v11 offset:50432
  v_mfma_f32_16x16x32_bf16 v[32:35], a[76:79], a[24:27], v[32:35]
  ds_read_b128 a[124:127], v11 offset:58624
  v_mfma_f32_16x16x32_bf16 v[36:39], a[76:79], a[28:31], v[36:39]
  buffer_load_dwordx4 v3, s[16:19], s34 offen offset:3072 lds
  s_add_u32 s34, s34, 32768
  v_mfma_f32_16x16x32_bf16 v[36:39], a[72:75], a[20:23], v[36:39]
  v_mfma_f32_16x16x32_bf16 v[36:39], a[68:71], a[12:15], v[36:39]
  v_mfma_f32_16x16x32_bf16 v[36:39], a[64:67], a[4:7], v[36:39]
  s_waitcnt vmcnt(13) lgkmcnt(0)
  s_barrier
  s_cmp_lg_u32 s30, 0
  s_cbranch_scc1 h2a_skip
  v_mov_b32 v7, 1
  s_mov_b64 exec, 1
  buffer_atomic_add v7, v8, s[24:27], s43 offen sc1
  s_mov_b64 exec, -1
h2a_skip:
  v_and_b32 v8, 3, v0
  v_lshlrev_b32 v8, 8, v8
  s_lshl_b32 s39, s100, 16
  s_lshl_b32 s40, s101, 12
  s_add_u32 s39, s39, s40
  s_lshl_b32 s40, s3, 22
  s_add_u32 s39, s39, s40
  s_add_u32 s39, s39, 4194304
  s_add_u32 s20, s6, s39
  s_addc_u32 s21, s7, 0
  s_mov_b32 s22, 4096
  s_mov_b32 s23, 0x20000
  v_mfma_f32_16x16x32_bf16 v[40:43], a[80:83], a[0:3], v[40:43]
  ds_read_b128 a[64:67], v11 offset:2048
  v_mfma_f32_16x16x32_bf16 v[40:43], a[84:87], a[8:11], v[40:43]
  ds_read_b128 a[68:71], v11 offset:10240
  buffer_load_dwordx4 a[180:183], v12, s[8:11], s33 offen offset:256
  v_mfma_f32_16x16x32_bf16 v[40:43], a[88:91], a[16:19], v[40:43]
  ds_read_b128 a[72:75], v11 offset:18432
  v_mfma_f32_16x16x32_bf16 v[40:43], a[92:95], a[24:27], v[40:43]
  ds_read_b128 a[76:79], v11 offset:26624
  v_mfma_f32_16x16x32_bf16 v[44:47], a[92:95], a[28:31], v[44:47]
  v_mfma_f32_16x16x32_bf16 v[44:47], a[88:91], a[20:23], v[44:47]
  v_mfma_f32_16x16x32_bf16 v[44:47], a[84:87], a[12:15], v[44:47]
  v_mfma_f32_16x16x32_bf16 v[44:47], a[80:83], a[4:7], v[44:47]
  s_waitcnt lgkmcnt(8)
  v_mfma_f32_16x16x32_bf16 v[48:51], a[96:99], a[0:3], v[48:51]
  ds_read_b128 a[80:83], v11 offset:2304
  v_mfma_f32_16x16x32_bf16 v[48:51], a[100:103], a[8:11], v[48:51]
  ds_read_b128 a[84:87], v11 offset:10496
  buffer_load_dwordx4 a[184:187], v12, s[8:11], s33 offen offset:2048
  v_mfma_f32_16x16x32_bf16 v[48:51], a[104:107], a[16:19], v[48:51]
  ds_read_b128 a[88:91], v11 offset:18688
  v_mfma_f32_16x16x32_bf16 v[48:51], a[108:111], a[24:27], v[48:51]
  ds_read_b128 a[92:95], v11 offset:26880
  v_mfma_f32_16x16x32_bf16 v[52:55], a[108:111], a[28:31], v[52:55]
  v_mfma_f32_16x16x32_bf16 v[52:55], a[104:107], a[20:23], v[52:55]
  v_mfma_f32_16x16x32_bf16 v[52:55], a[100:103], a[12:15], v[52:55]
  v_mfma_f32_16x16x32_bf16 v[52:55], a[96:99], a[4:7], v[52:55]
  s_waitcnt lgkmcnt(8)
  v_mfma_f32_16x16x32_bf16 v[56:59], a[112:115], a[0:3], v[56:59]
  ds_read_b128 a[96:99], v11 offset:3072
  v_mfma_f32_16x16x32_bf16 v[56:59], a[116:119], a[8:11], v[56:59]
  ds_read_b128 a[100:103], v11 offset:11264
  buffer_load_dwordx4 a[188:191], v12, s[8:11], s33 offen offset:2304
  v_mfma_f32_16x16x32_bf16 v[56:59], a[120:123], a[16:19], v[56:59]
  ds_read_b128 a[104:107], v11 offset:19456
  v_mfma_f32_16x16x32_bf16 v[56:59], a[124:127], a[24:27], v[56:59]
  ds_read_b128 a[108:111], v11 offset:27648
  v_mfma_f32_16x16x32_bf16 v[60:63], a[124:127], a[28:31], v[60:63]
  v_mfma_f32_16x16x32_bf16 v[60:63], a[120:123], a[20:23], v[60:63]
  v_mfma_f32_16x16x32_bf16 v[60:63], a[116:119], a[12:15], v[60:63]
  v_mfma_f32_16x16x32_bf16 v[60:63], a[112:115], a[4:7], v[60:63]
  .p2align 3
g4_loop:
  s_waitcnt vmcnt(16) lgkmcnt(8)
  v_mfma_f32_16x16x32_bf16 v[64:67], a[64:67], a[32:35], v[64:67]
  ds_read_b128 a[112:115], v11 offset:3328
  v_mfma_f32_16x16x32_bf16 v[64:67], a[68:71], a[40:43], v[64:67]
  ds_read_b128 a[116:119], v11 offset:11520
  s_add_u32 s33, s33, 0x1000
  buffer_load_dwordx4 a[192:195], v12, s[8:11], s33 offen offset:0
  v_mfma_f32_16x16x32_bf16 v[64:67], a[72:75], a[48:51], v[64:67]
  ds_read_b128 a[120:123], v11 offset:19712
  v_mfma_f32_16x16x32_bf16 v[64:67], a[76:79], a[56:59], v[64:67]
  ds_read_b128 a[124:127], v11 offset:27904
  s_add_u32 m0, s36, 32768
  s_nop 0
  buffer_load_dwordx4 v2, s[16:19], s34 offen offset:0 lds
  v_mfma_f32_16x16x32_bf16 v[68:71], a[76:79], a[60:63], v[68:71]
  v_mfma_f32_16x16x32_bf16 v[68:71], a[72:75], a[52:55], v[68:71]
  buffer_load_dwordx4 v2, s[16:19], s34 offen offset:1024 lds
  v_mfma_f32_16x16x32_bf16 v[68:71], a[68:71], a[44:47], v[68:71]
  v_mfma_f32_16x16x32_bf16 v[68:71], a[64:67], a[36:39], v[68:71]
  s_waitcnt lgkmcnt(8)
  v_mfma_f32_16x16x32_bf16 v[72:75], a[80:83], a[32:35], v[72:75]
  ds_read_b128 a[64:67], v11 offset:0
  v_mfma_f32_16x16x32_bf16 v[72:75], a[84:87], a[40:43], v[72:75]
  ds_read_b128 a[68:71], v11 offset:8192
  buffer_load_dwordx4 a[196:199], v12, s[8:11], s33 offen offset:256
  v_mfma_f32_16x16x32_bf16 v[72:75], a[88:91], a[48:51], v[72:75]
  ds_read_b128 a[72:75], v11 offset:16384
  v_mfma_f32_16x16x32_bf16 v[72:75], a[92:95], a[56:59], v[72:75]
  ds_read_b128 a[76:79], v11 offset:24576
  buffer_load_dwordx4 v2, s[16:19], s34 offen offset:2048 lds
  v_mfma_f32_16x16x32_bf16 v[76:79], a[92:95], a[60:63], v[76:79]
  v_mfma_f32_16x16x32_bf16 v[76:79], a[88:91], a[52:55], v[76:79]
  buffer_load_dwordx4 v2, s[16:19], s34 offen offset:3072 lds
  v_mfma_f32_16x16x32_bf16 v[76:79], a[84:87], a[44:47], v[76:79]
  v_mfma_f32_16x16x32_bf16 v[76:79], a[80:83], a[36:39], v[76:79]
  s_waitcnt lgkmcnt(8)
  v_mfma_f32_16x16x32_bf16 v[80:83], a[96:99], a[32:35], v[80:83]
  ds_read_b128 a[80:83], v11 offset:256
  v_mfma_f32_16x16x32_bf16 v[80:83], a[100:103], a[40:43], v[80:83]
  ds_read_b128 a[84:87], v11 offset:8448
  buffer_load_dwordx4 a[200:203], v12, s[8:11], s33 offen offset:2048
  v_mfma_f32_16x16x32_bf16 v[80:83], a[104:107], a[48:51], v[80:83]
  ds_read_b128 a[88:91], v11 offset:16640
  v_mfma_f32_16x16x32_bf16 v[80:83], a[108:111], a[56:59], v[80:83]
  ds_read_b128 a[92:95], v11 offset:24832
  v_mfma_f32_16x16x32_bf16 v[84:87], a[108:111], a[60:63], v[84:87]
  s_add_u32 m0, s36, 36864
  s_nop 0
  buffer_load_dwordx4 v3, s[16:19], s34 offen offset:0 lds
  v_mfma_f32_16x16x32_bf16 v[84:87], a[104:107], a[52:55], v[84:87]
  v_mfma_f32_16x16x32_bf16 v[84:87], a[100:103], a[44:47], v[84:87]
  v_mfma_f32_16x16x32_bf16 v[84:87], a[96:99], a[36:39], v[84:87]
  s_waitcnt lgkmcnt(8)
  v_mfma_f32_16x16x32_bf16 v[88:91], a[112:115], a[32:35], v[88:91]
  ds_read_b128 a[96:99], v11 offset:1024
  v_mfma_f32_16x16x32_bf16 v[88:91], a[116:119], a[40:43], v[88:91]
  ds_read_b128 a[100:103], v11 offset:9216
  buffer_load_dwordx4 a[204:207], v12, s[8:11], s33 offen offset:2304
  v_mfma_f32_16x16x32_bf16 v[88:91], a[120:123], a[48:51], v[88:91]
  ds_read_b128 a[104:107], v11 offset:17408
  v_mfma_f32_16x16x32_bf16 v[88:91], a[124:127], a[56:59], v[88:91]
  ds_read_b128 a[108:111], v11 offset:25600
  buffer_load_dwordx4 v3, s[16:19], s34 offen offset:1024 lds
  v_mfma_f32_16x16x32_bf16 v[92:95], a[124:127], a[60:63], v[92:95]
  v_mfma_f32_16x16x32_bf16 v[92:95], a[120:123], a[52:55], v[92:95]
  buffer_load_dwordx4 v3, s[16:19], s34 offen offset:2048 lds
  v_mfma_f32_16x16x32_bf16 v[92:95], a[116:119], a[44:47], v[92:95]
  v_mfma_f32_16x16x32_bf16 v[92:95], a[112:115], a[36:39], v[92:95]
  s_waitcnt lgkmcnt(8)
  v_mfma_f32_16x16x32_bf16 v[32:35], a[64:67], a[32:35], v[32:35]
  ds_read_b128 a[112:115], v11 offset:1280
  v_mfma_f32_16x16x32_bf16 v[32:35], a[68:71], a[40:43], v[32:35]
  ds_read_b128 a[116:119], v11 offset:9472
  s_add_u32 s33, s33, 0x1000
  buffer_load_dwordx4 a[208:211], v12, s[8:11], s33 offen offset:0
  v_mfma_f32_16x16x32_bf16 v[32:35], a[72:75], a[48:51], v[32:35]
  ds_read_b128 a[120:123], v11 offset:17664
  v_mfma_f32_16x16x32_bf16 v[32:35], a[76:79], a[56:59], v[32:35]
  ds_read_b128 a[124:127], v11 offset:25856
  v_mfma_f32_16x16x32_bf16 v[36:39], a[76:79], a[60:63], v[36:39]
  buffer_load_dwordx4 v3, s[16:19], s34 offen offset:3072 lds
  s_add_u32 s34, s34, 32768
  v_mfma_f32_16x16x32_bf16 v[36:39], a[72:75], a[52:55], v[36:39]
  v_mfma_f32_16x16x32_bf16 v[36:39], a[68:71], a[44:47], v[36:39]
  v_mfma_f32_16x16x32_bf16 v[36:39], a[64:67], a[36:39], v[36:39]
  s_waitcnt vmcnt(32) lgkmcnt(0)
  s_barrier
  v_mfma_f32_16x16x32_bf16 v[40:43], a[80:83], a[32:35], v[40:43]
  ds_read_b128 a[64:67], v10 offset:34816
  v_mfma_f32_16x16x32_bf16 v[40:43], a[84:87], a[40:43], v[40:43]
  ds_read_b128 a[68:71], v10 offset:43008
  buffer_load_dwordx4 a[212:215], v12, s[8:11], s33 offen offset:256
  v_mfma_f32_16x16x32_bf16 v[40:43], a[88:91], a[48:51], v[40:43]
  ds_read_b128 a[72:75], v10 offset:51200
  v_mfma_f32_16x16x32_bf16 v[40:43], a[92:95], a[56:59], v[40:43]
  ds_read_b128 a[76:79], v10 offset:59392
  v_mfma_f32_16x16x32_bf16 v[44:47], a[92:95], a[60:63], v[44:47]
  v_mfma_f32_16x16x32_bf16 v[44:47], a[88:91], a[52:55], v[44:47]
  v_mfma_f32_16x16x32_bf16 v[44:47], a[84:87], a[44:47], v[44:47]
  v_mfma_f32_16x16x32_bf16 v[44:47], a[80:83], a[36:39], v[44:47]
  s_waitcnt lgkmcnt(8)
  v_mfma_f32_16x16x32_bf16 v[48:51], a[96:99], a[32:35], v[48:51]
  ds_read_b128 a[80:83], v10 offset:35072
  v_mfma_f32_16x16x32_bf16 v[48:51], a[100:103], a[40:43], v[48:51]
  ds_read_b128 a[84:87], v10 offset:43264
  buffer_load_dwordx4 a[216:219], v12, s[8:11], s33 offen offset:2048
  v_mfma_f32_16x16x32_bf16 v[48:51], a[104:107], a[48:51], v[48:51]
  ds_read_b128 a[88:91], v10 offset:51456
  v_mfma_f32_16x16x32_bf16 v[48:51], a[108:111], a[56:59], v[48:51]
  ds_read_b128 a[92:95], v10 offset:59648
  v_mfma_f32_16x16x32_bf16 v[52:55], a[108:111], a[60:63], v[52:55]
  v_mfma_f32_16x16x32_bf16 v[52:55], a[104:107], a[52:55], v[52:55]
  v_mfma_f32_16x16x32_bf16 v[52:55], a[100:103], a[44:47], v[52:55]
  v_mfma_f32_16x16x32_bf16 v[52:55], a[96:99], a[36:39], v[52:55]
  s_waitcnt lgkmcnt(8)
  v_mfma_f32_16x16x32_bf16 v[56:59], a[112:115], a[32:35], v[56:59]
  ds_read_b128 a[96:99], v10 offset:35840
  v_mfma_f32_16x16x32_bf16 v[56:59], a[116:119], a[40:43], v[56:59]
  ds_read_b128 a[100:103], v10 offset:44032
  buffer_load_dwordx4 a[220:223], v12, s[8:11], s33 offen offset:2304
  v_mfma_f32_16x16x32_bf16 v[56:59], a[120:123], a[48:51], v[56:59]
  ds_read_b128 a[104:107], v10 offset:52224
  v_mfma_f32_16x16x32_bf16 v[56:59], a[124:127], a[56:59], v[56:59]
  ds_read_b128 a[108:111], v10 offset:60416
  v_mfma_f32_16x16x32_bf16 v[60:63], a[124:127], a[60:63], v[60:63]
  v_mfma_f32_16x16x32_bf16 v[60:63], a[120:123], a[52:55], v[60:63]
  v_mfma_f32_16x16x32_bf16 v[60:63], a[116:119], a[44:47], v[60:63]
  v_mfma_f32_16x16x32_bf16 v[60:63], a[112:115], a[36:39], v[60:63]
  s_waitcnt vmcnt(16) lgkmcnt(8)
  v_mfma_f32_16x16x32_bf16 v[64:67], a[64:67], a[160:163], v[64:67]
  ds_read_b128 a[112:115], v10 offset:36096
  v_mfma_f32_16x16x32_bf16 v[64:67], a[68:71], a[168:171], v[64:67]
  ds_read_b128 a[116:119], v10 offset:44288
  s_add_u32 s33, s33, 0x1000
  buffer_load_dwordx4 a[0:3], v12, s[8:11], s33 offen offset:0
  v_mfma_f32_16x16x32_bf16 v[64:67], a[72:75], a[176:179], v[64:67]
  ds_read_b128 a[120:123], v10 offset:52480
  v_mfma_f32_16x16x32_bf16 v[64:67], a[76:79], a[184:187], v[64:67]
  ds_read_b128 a[124:127], v10 offset:60672
  s_add_u32 m0, s36, 0
  s_nop 0
  buffer_load_dwordx4 v2, s[16:19], s34 offen offset:0 lds
  v_mfma_f32_16x16x32_bf16 v[68:71], a[76:79], a[188:191], v[68:71]
  v_mfma_f32_16x16x32_bf16 v[68:71], a[72:75], a[180:183], v[68:71]
  buffer_load_dwordx4 v2, s[16:19], s34 offen offset:1024 lds
  v_mfma_f32_16x16x32_bf16 v[68:71], a[68:71], a[172:175], v[68:71]
  v_mfma_f32_16x16x32_bf16 v[68:71], a[64:67], a[164:167], v[68:71]
  s_waitcnt lgkmcnt(8)
  v_mfma_f32_16x16x32_bf16 v[72:75], a[80:83], a[160:163], v[72:75]
  ds_read_b128 a[64:67], v10 offset:32768
  v_mfma_f32_16x16x32_bf16 v[72:75], a[84:87], a[168:171], v[72:75]
  ds_read_b128 a[68:71], v10 offset:40960
  buffer_load_dwordx4 a[4:7], v12, s[8:11], s33 offen offset:256
  v_mfma_f32_16x16x32_bf16 v[72:75], a[88:91], a[176:179], v[72:75]
  ds_read_b128 a[72:75], v10 offset:49152
  v_mfma_f32_16x16x32_bf16 v[72:75], a[92:95], a[184:187], v[72:75]
  ds_read_b128 a[76:79], v10 offset:57344
  buffer_load_dwordx4 v2, s[16:19], s34 offen offset:2048 lds
  v_mfma_f32_16x16x32_bf16 v[76:79], a[92:95], a[188:191], v[76:79]
  v_mfma_f32_16x16x32_bf16 v[76:79], a[88:91], a[180:183], v[76:79]
  buffer_load_dwordx4 v2, s[16:19], s34 offen offset:3072 lds
  v_mfma_f32_16x16x32_bf16 v[76:79], a[84:87], a[172:175], v[76:79]
  v_mfma_f32_16x16x32_bf16 v[76:79], a[80:83], a[164:167], v[76:79]
  s_waitcnt lgkmcnt(8)
  v_mfma_f32_16x16x32_bf16 v[80:83], a[96:99], a[160:163], v[80:83]
  ds_read_b128 a[80:83], v10 offset:33024
  v_mfma_f32_16x16x32_bf16 v[80:83], a[100:103], a[168:171], v[80:83]
  ds_read_b128 a[84:87], v10 offset:41216
  buffer_load_dwordx4 a[8:11], v12, s[8:11], s33 offen offset:2048
  v_mfma_f32_16x16x32_bf16 v[80:83], a[104:107], a[176:179], v[80:83]
  ds_read_b128 a[88:91], v10 offset:49408
  v_mfma_f32_16x16x32_bf16 v[80:83], a[108:111], a[184:187], v[80:83]
  ds_read_b128 a[92:95], v10 offset:57600
  v_mfma_f32_16x16x32_bf16 v[84:87], a[108:111], a[188:191], v[84:87]
  s_add_u32 m0, s36, 4096
  s_nop 0
  buffer_load_dwordx4 v3, s[16:19], s34 offen offset:0 lds
  v_mfma_f32_16x16x32_bf16 v[84:87], a[104:107], a[180:183], v[84:87]
  v_mfma_f32_16x16x32_bf16 v[84:87], a[100:103], a[172:175], v[84:87]
  v_mfma_f32_16x16x32_bf16 v[84:87], a[96:99], a[164:167], v[84:87]
  s_waitcnt lgkmcnt(8)
  v_mfma_f32_16x16x32_bf16 v[88:91], a[112:115], a[160:163], v[88:91]
  ds_read_b128 a[96:99], v10 offset:33792
  v_mfma_f32_16x16x32_bf16 v[88:91], a[116:119], a[168:171], v[88:91]
  ds_read_b128 a[100:103], v10 offset:41984
  buffer_load_dwordx4 a[12:15], v12, s[8:11], s33 offen offset:2304
  v_mfma_f32_16x16x32_bf16 v[88:91], a[120:123], a[176:179], v[88:91]
  ds_read_b128 a[104:107], v10 offset:50176
  v_mfma_f32_16x16x32_bf16 v[88:91], a[124:127], a[184:187], v[88:91]
  ds_read_b128 a[108:111], v10 offset:58368
  buffer_load_dwordx4 v3, s[16:19], s34 offen offset:1024 lds
  v_mfma_f32_16x16x32_bf16 v[92:95], a[124:127], a[188:191], v[92:95]
  v_mfma_f32_16x16x32_bf16 v[92:95], a[120:123], a[180:183], v[92:95]
  buffer_load_dwordx4 v3, s[16:19], s34 offen offset:2048 lds
  v_mfma_f32_16x16x32_bf16 v[92:95], a[116:119], a[172:175], v[92:95]
  v_mfma_f32_16x16x32_bf16 v[92:95], a[112:115], a[164:167], v[92:95]
  s_waitcnt lgkmcnt(8)
  v_mfma_f32_16x16x32_bf16 v[32:35], a[64:67], a[160:163], v[32:35]
  ds_read_b128 a[112:115], v10 offset:34048
  v_mfma_f32_16x16x32_bf16 v[32:35], a[68:71], a[168:171], v[32:35]
  ds_read_b128 a[116:119], v10 offset:42240
  s_add_u32 s33, s33, 0x1000
  buffer_load_dwordx4 a[16:19], v12, s[8:11], s33 offen offset:0
  v_mfma_f32_16x16x32_bf16 v[32:35], a[72:75], a[176:179], v[32:35]
  ds_read_b128 a[120:123], v10 offset:50432
  v_mfma_f32_16x16x32_bf16 v[32:35], a[76:79], a[184:187], v[32:35]
  ds_read_b128 a[124:127], v10 offset:58624
  v_mfma_f32_16x16x32_bf16 v[36:39], a[76:79], a[188:191], v[36:39]
  buffer_load_dwordx4 v3, s[16:19], s34 offen offset:3072 lds
  s_add_u32 s34, s34, 32768
  v_mfma_f32_16x16x32_bf16 v[36:39], a[72:75], a[180:183], v[36:39]
  v_mfma_f32_16x16x32_bf16 v[36:39], a[68:71], a[172:175], v[36:39]
  v_mfma_f32_16x16x32_bf16 v[36:39], a[64:67], a[164:167], v[36:39]
  s_waitcnt vmcnt(32) lgkmcnt(0)
  s_barrier
  v_mfma_f32_16x16x32_bf16 v[40:43], a[80:83], a[160:163], v[40:43]
  ds_read_b128 a[64:67], v10 offset:2048
  v_mfma_f32_16x16x32_bf16 v[40:43], a[84:87], a[168:171], v[40:43]
  ds_read_b128 a[68:71], v10 offset:10240
  buffer_load_dwordx4 a[20:23], v12, s[8:11], s33 offen offset:256
  v_mfma_f32_16x16x32_bf16 v[40:43], a[88:91], a[176:179], v[40:43]
  ds_read_b128 a[72:75], v10 offset:18432
  v_mfma_f32_16x16x32_bf16 v[40:43], a[92:95], a[184:187], v[40:43]
  ds_read_b128 a[76:79], v10 offset:26624
  v_mfma_f32_16x16x32_bf16 v[44:47], a[92:95], a[188:191], v[44:47]
  v_mfma_f32_16x16x32_bf16 v[44:47], a[88:91], a[180:183], v[44:47]
  v_mfma_f32_16x16x32_bf16 v[44:47], a[84:87], a[172:175], v[44:47]
  v_mfma_f32_16x16x32_bf16 v[44:47], a[80:83], a[164:167], v[44:47]
  s_waitcnt lgkmcnt(8)
  v_mfma_f32_16x16x32_bf16 v[48:51], a[96:99], a[160:163], v[48:51]
  ds_read_b128 a[80:83], v10 offset:2304
  v_mfma_f32_16x16x32_bf16 v[48:51], a[100:103], a[168:171], v[48:51]
  ds_read_b128 a[84:87], v10 offset:10496
  buffer_load_dwordx4 a[24:27], v12, s[8:11], s33 offen offset:2048
  v_mfma_f32_16x16x32_bf16 v[48:51], a[104:107], a[176:179], v[48:51]
  ds_read_b128 a[88:91], v10 offset:18688
  v_mfma_f32_16x16x32_bf16 v[48:51], a[108:111], a[184:187], v[48:51]
  ds_read_b128 a[92:95], v10 offset:26880
  v_mfma_f32_16x16x32_bf16 v[52:55], a[108:111], a[188:191], v[52:55]
  v_mfma_f32_16x16x32_bf16 v[52:55], a[104:107], a[180:183], v[52:55]
  v_mfma_f32_16x16x32_bf16 v[52:55], a[100:103], a[172:175], v[52:55]
  v_mfma_f32_16x16x32_bf16 v[52:55], a[96:99], a[164:167], v[52:55]
  s_waitcnt lgkmcnt(8)
  v_mfma_f32_16x16x32_bf16 v[56:59], a[112:115], a[160:163], v[56:59]
  ds_read_b128 a[96:99], v10 offset:3072
  v_mfma_f32_16x16x32_bf16 v[56:59], a[116:119], a[168:171], v[56:59]
  ds_read_b128 a[100:103], v10 offset:11264
  buffer_load_dwordx4 a[28:31], v12, s[8:11], s33 offen offset:2304
  v_mfma_f32_16x16x32_bf16 v[56:59], a[120:123], a[176:179], v[56:59]
  ds_read_b128 a[104:107], v10 offset:19456
  v_mfma_f32_16x16x32_bf16 v[56:59], a[124:127], a[184:187], v[56:59]
  ds_read_b128 a[108:111], v10 offset:27648
  v_mfma_f32_16x16x32_bf16 v[60:63], a[124:127], a[188:191], v[60:63]
  v_mfma_f32_16x16x32_bf16 v[60:63], a[120:123], a[180:183], v[60:63]
  v_mfma_f32_16x16x32_bf16 v[60:63], a[116:119], a[172:175], v[60:63]
  v_mfma_f32_16x16x32_bf16 v[60:63], a[112:115], a[164:167], v[60:63]
  buffer_load_dword v9, v8, s[24:27], s89 offen sc1
  s_waitcnt vmcnt(16) lgkmcnt(8)
  v_mfma_f32_16x16x32_bf16 v[64:67], a[64:67], a[192:195], v[64:67]
  ds_read_b128 a[112:115], v10 offset:3328
  v_mfma_f32_16x16x32_bf16 v[64:67], a[68:71], a[200:203], v[64:67]
  ds_read_b128 a[116:119], v10 offset:11520
  s_add_u32 s33, s33, 0x1000
  buffer_load_dwordx4 a[32:35], v12, s[8:11], s33 offen offset:0
  v_mfma_f32_16x16x32_bf16 v[64:67], a[72:75], a[208:211], v[64:67]
  ds_read_b128 a[120:123], v10 offset:19712
  v_mfma_f32_16x16x32_bf16 v[64:67], a[76:79], a[216:219], v[64:67]
  ds_read_b128 a[124:127], v10 offset:27904
  s_add_u32 m0, s35, 32768
  s_nop 0
  buffer_load_dwordx4 v2, s[16:19], s34 offen offset:0 lds
  v_mfma_f32_16x16x32_bf16 v[68:71], a[76:79], a[220:223], v[68:71]
  v_mfma_f32_16x16x32_bf16 v[68:71], a[72:75], a[212:215], v[68:71]
  buffer_load_dwordx4 v2, s[16:19], s34 offen offset:1024 lds
  v_mfma_f32_16x16x32_bf16 v[68:71], a[68:71], a[204:207], v[68:71]
  v_mfma_f32_16x16x32_bf16 v[68:71], a[64:67], a[196:199], v[68:71]
  s_waitcnt lgkmcnt(8)
  v_mfma_f32_16x16x32_bf16 v[72:75], a[80:83], a[192:195], v[72:75]
  ds_read_b128 a[64:67], v10 offset:0
  v_mfma_f32_16x16x32_bf16 v[72:75], a[84:87], a[200:203], v[72:75]
  ds_read_b128 a[68:71], v10 offset:8192
  buffer_load_dwordx4 a[36:39], v12, s[8:11], s33 offen offset:256
  v_mfma_f32_16x16x32_bf16 v[72:75], a[88:91], a[208:211], v[72:75]
  ds_read_b128 a[72:75], v10 offset:16384
  v_mfma_f32_16x16x32_bf16 v[72:75], a[92:95], a[216:219], v[72:75]
  ds_read_b128 a[76:79], v10 offset:24576
  buffer_load_dwordx4 v2, s[16:19], s34 offen offset:2048 lds
  v_mfma_f32_16x16x32_bf16 v[76:79], a[92:95], a[220:223], v[76:79]
  v_mfma_f32_16x16x32_bf16 v[76:79], a[88:91], a[212:215], v[76:79]
  buffer_load_dwordx4 v2, s[16:19], s34 offen offset:3072 lds
  v_mfma_f32_16x16x32_bf16 v[76:79], a[84:87], a[204:207], v[76:79]
  v_mfma_f32_16x16x32_bf16 v[76:79], a[80:83], a[196:199], v[76:79]
  s_waitcnt lgkmcnt(8)
  v_mfma_f32_16x16x32_bf16 v[80:83], a[96:99], a[192:195], v[80:83]
  ds_read_b128 a[80:83], v10 offset:256
  v_mfma_f32_16x16x32_bf16 v[80:83], a[100:103], a[200:203], v[80:83]
  ds_read_b128 a[84:87], v10 offset:8448
  buffer_load_dwordx4 a[40:43], v12, s[8:11], s33 offen offset:2048
  v_mfma_f32_16x16x32_bf16 v[80:83], a[104:107], a[208:211], v[80:83]
  ds_read_b128 a[88:91], v10 offset:16640
  v_mfma_f32_16x16x32_bf16 v[80:83], a[108:111], a[216:219], v[80:83]
  ds_read_b128 a[92:95], v10 offset:24832
  v_mfma_f32_16x16x32_bf16 v[84:87], a[108:111], a[220:223], v[84:87]
  s_add_u32 m0, s35, 36864
  s_nop 0
  buffer_load_dwordx4 v3, s[16:19], s34 offen offset:0 lds
  v_mfma_f32_16x16x32_bf16 v[84:87], a[104:107], a[212:215], v[84:87]
  v_mfma_f32_16x16x32_bf16 v[84:87], a[100:103], a[204:207], v[84:87]
  v_mfma_f32_16x16x32_bf16 v[84:87], a[96:99], a[196:199], v[84:87]
  s_waitcnt lgkmcnt(8)
  v_mfma_f32_16x16x32_bf16 v[88:91], a[112:115], a[192:195], v[88:91]
  ds_read_b128 a[96:99], v10 offset:1024
  v_mfma_f32_16x16x32_bf16 v[88:91], a[116:119], a[200:203], v[88:91]
  ds_read_b128 a[100:103], v10 offset:9216
  buffer_load_dwordx4 a[44:47], v12, s[8:11], s33 offen offset:2304
  v_mfma_f32_16x16x32_bf16 v[88:91], a[120:123], a[208:211], v[88:91]
  ds_read_b128 a[104:107], v10 offset:17408
  v_mfma_f32_16x16x32_bf16 v[88:91], a[124:127], a[216:219], v[88:91]
  ds_read_b128 a[108:111], v10 offset:25600
  buffer_load_dwordx4 v3, s[16:19], s34 offen offset:1024 lds
  v_mfma_f32_16x16x32_bf16 v[92:95], a[124:127], a[220:223], v[92:95]
  v_mfma_f32_16x16x32_bf16 v[92:95], a[120:123], a[212:215], v[92:95]
  buffer_load_dwordx4 v3, s[16:19], s34 offen offset:2048 lds
  v_mfma_f32_16x16x32_bf16 v[92:95], a[116:119], a[204:207], v[92:95]
  v_mfma_f32_16x16x32_bf16 v[92:95], a[112:115], a[196:199], v[92:95]
  s_waitcnt lgkmcnt(8)
  v_mfma_f32_16x16x32_bf16 v[32:35], a[64:67], a[192:195], v[32:35]
  ds_read_b128 a[112:115], v10 offset:1280
  v_mfma_f32_16x16x32_bf16 v[32:35], a[68:71], a[200:203], v[32:35]
  ds_read_b128 a[116:119], v10 offset:9472
  s_add_u32 s33, s33, 0x1000
  buffer_load_dwordx4 a[48:51], v12, s[8:11], s33 offen offset:0
  v_mfma_f32_16x16x32_bf16 v[32:35], a[72:75], a[208:211], v[32:35]
  ds_read_b128 a[120:123], v10 offset:17664
  v_mfma_f32_16x16x32_bf16 v[32:35], a[76:79], a[216:219], v[32:35]
  ds_read_b128 a[124:127], v10 offset:25856
  v_mfma_f32_16x16x32_bf16 v[36:39], a[76:79], a[220:223], v[36:39]
  buffer_load_dwordx4 v3, s[16:19], s34 offen offset:3072 lds
  s_add_u32 s34, s34, 32768
  v_mfma_f32_16x16x32_bf16 v[36:39], a[72:75], a[212:215], v[36:39]
  v_mfma_f32_16x16x32_bf16 v[36:39], a[68:71], a[204:207], v[36:39]
  v_mfma_f32_16x16x32_bf16 v[36:39], a[64:67], a[196:199], v[36:39]
  s_waitcnt vmcnt(32) lgkmcnt(0)
  s_barrier
  v_mfma_f32_16x16x32_bf16 v[40:43], a[80:83], a[192:195], v[40:43]
  ds_read_b128 a[64:67], v11 offset:34816
  v_mfma_f32_16x16x32_bf16 v[40:43], a[84:87], a[200:203], v[40:43]
  ds_read_b128 a[68:71], v11 offset:43008
  buffer_load_dwordx4 a[52:55], v12, s[8:11], s33 offen offset:256
  v_mfma_f32_16x16x32_bf16 v[40:43], a[88:91], a[208:211], v[40:43]
  ds_read_b128 a[72:75], v11 offset:51200
  v_mfma_f32_16x16x32_bf16 v[40:43], a[92:95], a[216:219], v[40:43]
  ds_read_b128 a[76:79], v11 offset:59392
  v_mfma_f32_16x16x32_bf16 v[44:47], a[92:95], a[220:223], v[44:47]
  v_mfma_f32_16x16x32_bf16 v[44:47], a[88:91], a[212:215], v[44:47]
  v_mfma_f32_16x16x32_bf16 v[44:47], a[84:87], a[204:207], v[44:47]
  v_mfma_f32_16x16x32_bf16 v[44:47], a[80:83], a[196:199], v[44:47]
  s_waitcnt lgkmcnt(8)
  v_mfma_f32_16x16x32_bf16 v[48:51], a[96:99], a[192:195], v[48:51]
  ds_read_b128 a[80:83], v11 offset:35072
  v_mfma_f32_16x16x32_bf16 v[48:51], a[100:103], a[200:203], v[48:51]
  ds_read_b128 a[84:87], v11 offset:43264
  buffer_load_dwordx4 a[56:59], v12, s[8:11], s33 offen offset:2048
  v_mfma_f32_16x16x32_bf16 v[48:51], a[104:107], a[208:211], v[48:51]
  ds_read_b128 a[88:91], v11 offset:51456
  v_mfma_f32_16x16x32_bf16 v[48:51], a[108:111], a[216:219], v[48:51]
  ds_read_b128 a[92:95], v11 offset:59648
  v_mfma_f32_16x16x32_bf16 v[52:55], a[108:111], a[220:223], v[52:55]
  v_mfma_f32_16x16x32_bf16 v[52:55], a[104:107], a[212:215], v[52:55]
  v_mfma_f32_16x16x32_bf16 v[52:55], a[100:103], a[204:207], v[52:55]
  v_mfma_f32_16x16x32_bf16 v[52:55], a[96:99], a[196:199], v[52:55]
  s_waitcnt lgkmcnt(8)
  v_mfma_f32_16x16x32_bf16 v[56:59], a[112:115], a[192:195], v[56:59]
  ds_read_b128 a[96:99], v11 offset:35840
  v_mfma_f32_16x16x32_bf16 v[56:59], a[116:119], a[200:203], v[56:59]
  ds_read_b128 a[100:103], v11 offset:44032
  buffer_load_dwordx4 a[60:63], v12, s[8:11], s33 offen offset:2304
  v_mfma_f32_16x16x32_bf16 v[56:59], a[120:123], a[208:211], v[56:59]
  ds_read_b128 a[104:107], v11 offset:52224
  v_mfma_f32_16x16x32_bf16 v[56:59], a[124:127], a[216:219], v[56:59]
  ds_read_b128 a[108:111], v11 offset:60416
  v_mfma_f32_16x16x32_bf16 v[60:63], a[124:127], a[220:223], v[60:63]
  v_mfma_f32_16x16x32_bf16 v[60:63], a[120:123], a[212:215], v[60:63]
  v_mfma_f32_16x16x32_bf16 v[60:63], a[116:119], a[204:207], v[60:63]
  v_mfma_f32_16x16x32_bf16 v[60:63], a[112:115], a[196:199], v[60:63]
  s_waitcnt vmcnt(14)
  v_cmp_gt_u32 vcc, 8, v9
  s_nop 4
  s_cbranch_vccnz hc_chk
hc_ok:
  s_waitcnt vmcnt(16) lgkmcnt(8)
  v_mfma_f32_16x16x32_bf16 v[64:67], a[64:67], a[0:3], v[64:67]
  ds_read_b128 a[112:115], v11 offset:36096
  v_mfma_f32_16x16x32_bf16 v[64:67], a[68:71], a[8:11], v[64:67]
  ds_read_b128 a[116:119], v11 offset:44288
  s_add_u32 s33, s33, 0x1000
  buffer_load_dwordx4 a[160:163], v12, s[8:11], s33 offen offset:0
  v_mfma_f32_16x16x32_bf16 v[64:67], a[72:75], a[16:19], v[64:67]
  ds_read_b128 a[120:123], v11 offset:52480
  v_mfma_f32_16x16x32_bf16 v[64:67], a[76:79], a[24:27], v[64:67]
  ds_read_b128 a[124:127], v11 offset:60672
  s_add_u32 m0, s35, 0
  s_nop 0
  buffer_load_dwordx4 v2, s[16:19], s34 offen offset:0 lds
  v_mfma_f32_16x16x32_bf16 v[68:71], a[76:79], a[28:31], v[68:71]
  v_mfma_f32_16x16x32_bf16 v[68:71], a[72:75], a[20:23], v[68:71]
  buffer_load_dwordx4 v2, s[16:19], s34 offen offset:1024 lds
  v_mfma_f32_16x16x32_bf16 v[68:71], a[68:71], a[12:15], v[68:71]
  v_mfma_f32_16x16x32_bf16 v[68:71], a[64:67], a[4:7], v[68:71]
  s_waitcnt lgkmcnt(8)
  v_mfma_f32_16x16x32_bf16 v[72:75], a[80:83], a[0:3], v[72:75]
  ds_read_b128 a[64:67], v11 offset:32768
  v_mfma_f32_16x16x32_bf16 v[72:75], a[84:87], a[8:11], v[72:75]
  ds_read_b128 a[68:71], v11 offset:40960
  buffer_load_dwordx4 a[164:167], v12, s[8:11], s33 offen offset:256
  v_mfma_f32_16x16x32_bf16 v[72:75], a[88:91], a[16:19], v[72:75]
  ds_read_b128 a[72:75], v11 offset:49152
  v_mfma_f32_16x16x32_bf16 v[72:75], a[92:95], a[24:27], v[72:75]
  ds_read_b128 a[76:79], v11 offset:57344
  buffer_load_dwordx4 v2, s[16:19], s34 offen offset:2048 lds
  v_mfma_f32_16x16x32_bf16 v[76:79], a[92:95], a[28:31], v[76:79]
  v_mfma_f32_16x16x32_bf16 v[76:79], a[88:91], a[20:23], v[76:79]
  buffer_load_dwordx4 v2, s[16:19], s34 offen offset:3072 lds
  v_mfma_f32_16x16x32_bf16 v[76:79], a[84:87], a[12:15], v[76:79]
  v_mfma_f32_16x16x32_bf16 v[76:79], a[80:83], a[4:7], v[76:79]
  s_waitcnt lgkmcnt(8)
  v_mfma_f32_16x16x32_bf16 v[80:83], a[96:99], a[0:3], v[80:83]
  ds_read_b128 a[80:83], v11 offset:33024
  v_mfma_f32_16x16x32_bf16 v[80:83], a[100:103], a[8:11], v[80:83]
  ds_read_b128 a[84:87], v11 offset:41216
  buffer_load_dwordx4 a[168:171], v12, s[8:11], s33 offen offset:2048
  v_mfma_f32_16x16x32_bf16 v[80:83], a[104:107], a[16:19], v[80:83]
  ds_read_b128 a[88:91], v11 offset:49408
  v_mfma_f32_16x16x32_bf16 v[80:83], a[108:111], a[24:27], v[80:83]
  ds_read_b128 a[92:95], v11 offset:57600
  v_mfma_f32_16x16x32_bf16 v[84:87], a[108:111], a[28:31], v[84:87]
  s_add_u32 m0, s35, 4096
  s_nop 0
  buffer_load_dwordx4 v3, s[16:19], s34 offen offset:0 lds
  v_mfma_f32_16x16x32_bf16 v[84:87], a[104:107], a[20:23], v[84:87]
  v_mfma_f32_16x16x32_bf16 v[84:87], a[100:103], a[12:15], v[84:87]
  v_mfma_f32_16x16x32_bf16 v[84:87], a[96:99], a[4:7], v[84:87]
  s_waitcnt lgkmcnt(8)
  v_mfma_f32_16x16x32_bf16 v[88:91], a[112:115], a[0:3], v[88:91]
  ds_read_b128 a[96:99], v11 offset:33792
  v_mfma_f32_16x16x32_bf16 v[88:91], a[116:119], a[8:11], v[88:91]
  ds_read_b128 a[100:103], v11 offset:41984
  buffer_load_dwordx4 a[172:175], v12, s[8:11], s33 offen offset:2304
  v_mfma_f32_16x16x32_bf16 v[88:91], a[120:123], a[16:19], v[88:91]
  ds_read_b128 a[104:107], v11 offset:50176
  v_mfma_f32_16x16x32_bf16 v[88:91], a[124:127], a[24:27], v[88:91]
  ds_read_b128 a[108:111], v11 offset:58368
  buffer_load_dwordx4 v3, s[16:19], s34 offen offset:1024 lds
  v_mfma_f32_16x16x32_bf16 v[92:95], a[124:127], a[28:31], v[92:95]
  v_mfma_f32_16x16x32_bf16 v[92:95], a[120:123], a[20:23], v[92:95]
  buffer_load_dwordx4 v3, s[16:19], s34 offen offset:2048 lds
  v_mfma_f32_16x16x32_bf16 v[92:95], a[116:119], a[12:15], v[92:95]
  v_mfma_f32_16x16x32_bf16 v[92:95], a[112:115], a[4:7], v[92:95]
  s_waitcnt lgkmcnt(8)
  v_mfma_f32_16x16x32_bf16 v[32:35], a[64:67], a[0:3], v[32:35]
  ds_read_b128 a[112:115], v11 offset:34048
  v_mfma_f32_16x16x32_bf16 v[32:35], a[68:71], a[8:11], v[32:35]
  ds_read_b128 a[116:119], v11 offset:42240
  s_add_u32 s33, s33, 0x1000
  buffer_load_dwordx4 a[176:179], v12, s[8:11], s33 offen offset:0
  v_mfma_f32_16x16x32_bf16 v[32:35], a[72:75], a[16:19], v[32:35]
  ds_read_b128 a[120:123], v11 offset:50432
  v_mfma_f32_16x16x32_bf16 v[32:35], a[76:79], a[24:27], v[32:35]
  ds_read_b128 a[124:127], v11 offset:58624
  v_mfma_f32_16x16x32_bf16 v[36:39], a[76:79], a[28:31], v[36:39]
  buffer_load_dwordx4 v3, s[16:19], s34 offen offset:3072 lds
  s_add_u32 s34, s34, 32768
  v_mfma_f32_16x16x32_bf16 v[36:39], a[72:75], a[20:23], v[36:39]
  v_mfma_f32_16x16x32_bf16 v[36:39], a[68:71], a[12:15], v[36:39]
  v_mfma_f32_16x16x32_bf16 v[36:39], a[64:67], a[4:7], v[36:39]
  s_waitcnt vmcnt(32) lgkmcnt(0)
  s_barrier
  v_mfma_f32_16x16x32_bf16 v[40:43], a[80:83], a[0:3], v[40:43]
  ds_read_b128 a[64:67], v11 offset:2048
  v_mfma_f32_16x16x32_bf16 v[40:43], a[84:87], a[8:11], v[40:43]
  ds_read_b128 a[68:71], v11 offset:10240
  buffer_load_dwordx4 a[180:183], v12, s[8:11], s33 offen offset:256
  v_mfma_f32_16x16x32_bf16 v[40:43], a[88:91], a[16:19], v[40:43]
  ds_read_b128 a[72:75], v11 offset:18432
  v_mfma_f32_16x16x32_bf16 v[40:43], a[92:95], a[24:27], v[40:43]
  ds_read_b128 a[76:79], v11 offset:26624
  v_mfma_f32_16x16x32_bf16 v[44:47], a[92:95], a[28:31], v[44:47]
  v_mfma_f32_16x16x32_bf16 v[44:47], a[88:91], a[20:23], v[44:47]
  v_mfma_f32_16x16x32_bf16 v[44:47], a[84:87], a[12:15], v[44:47]
  v_mfma_f32_16x16x32_bf16 v[44:47], a[80:83], a[4:7], v[44:47]
  s_waitcnt lgkmcnt(8)
  v_mfma_f32_16x16x32_bf16 v[48:51], a[96:99], a[0:3], v[48:51]
  ds_read_b128 a[80:83], v11 offset:2304
  v_mfma_f32_16x16x32_bf16 v[48:51], a[100:103], a[8:11], v[48:51]
  ds_read_b128 a[84:87], v11 offset:10496
  buffer_load_dwordx4 a[184:187], v12, s[8:11], s33 offen offset:2048
  v_mfma_f32_16x16x32_bf16 v[48:51], a[104:107], a[16:19], v[48:51]
  ds_read_b128 a[88:91], v11 offset:18688
  v_mfma_f32_16x16x32_bf16 v[48:51], a[108:111], a[24:27], v[48:51]
  ds_read_b128 a[92:95], v11 offset:26880
  v_mfma_f32_16x16x32_bf16 v[52:55], a[108:111], a[28:31], v[52:55]
  v_mfma_f32_16x16x32_bf16 v[52:55], a[104:107], a[20:23], v[52:55]
  v_mfma_f32_16x16x32_bf16 v[52:55], a[100:103], a[12:15], v[52:55]
  v_mfma_f32_16x16x32_bf16 v[52:55], a[96:99], a[4:7], v[52:55]
  s_waitcnt lgkmcnt(8)
  v_mfma_f32_16x16x32_bf16 v[56:59], a[112:115], a[0:3], v[56:59]
  ds_read_b128 a[96:99], v11 offset:3072
  v_mfma_f32_16x16x32_bf16 v[56:59], a[116:119], a[8:11], v[56:59]
  ds_read_b128 a[100:103], v11 offset:11264
  buffer_load_dwordx4 a[188:191], v12, s[8:11], s33 offen offset:2304
  v_mfma_f32_16x16x32_bf16 v[56:59], a[120:123], a[16:19], v[56:59]
  ds_read_b128 a[104:107], v11 offset:19456
  v_mfma_f32_16x16x32_bf16 v[56:59], a[124:127], a[24:27], v[56:59]
  ds_read_b128 a[108:111], v11 offset:27648
  v_mfma_f32_16x16x32_bf16 v[60:63], a[124:127], a[28:31], v[60:63]
  v_mfma_f32_16x16x32_bf16 v[60:63], a[120:123], a[20:23], v[60:63]
  v_mfma_f32_16x16x32_bf16 v[60:63], a[116:119], a[12:15], v[60:63]
  v_mfma_f32_16x16x32_bf16 v[60:63], a[112:115], a[4:7], v[60:63]
  s_sub_u32 s38, s38, 1
  s_cmp_eq_u32 s38, 0
  s_cbranch_scc0 g4_loop
  s_waitcnt vmcnt(16) lgkmcnt(8)
  v_mfma_f32_16x16x32_bf16 v[64:67], a[64:67], a[32:35], v[64:67]
  ds_read_b128 a[112:115], v11 offset:3328
  v_mfma_f32_16x16x32_bf16 v[64:67], a[68:71], a[40:43], v[64:67]
  ds_read_b128 a[116:119], v11 offset:11520
  s_add_u32 s33, s33, 0x1000
  buffer_load_dwordx4 a[192:195], v12, s[8:11], s33 offen offset:0
  v_mfma_f32_16x16x32_bf16 v[64:67], a[72:75], a[48:51], v[64:67]
  ds_read_b128 a[120:123], v11 offset:19712
  v_mfma_f32_16x16x32_bf16 v[64:67], a[76:79], a[56:59], v[64:67]
  ds_read_b128 a[124:127], v11 offset:27904
  v_mfma_f32_16x16x32_bf16 v[68:71], a[76:79], a[60:63], v[68:71]
  buffer_load_dwordx4 a[196:199], v12, s[8:11], s33 offen offset:256
  v_mfma_f32_16x16x32_bf16 v[68:71], a[72:75], a[52:55], v[68:71]
  v_mfma_f32_16x16x32_bf16 v[68:71], a[68:71], a[44:47], v[68:71]
  v_mfma_f32_16x16x32_bf16 v[68:71], a[64:67], a[36:39], v[68:71]
  s_waitcnt vmcnt(21) lgkmcnt(0)
  s_barrier
  v_mfma_f32_16x16x32_bf16 v[72:75], a[80:83], a[32:35], v[72:75]
  ds_read_b128 a[64:67], v10 offset:34816
  v_mfma_f32_16x16x32_bf16 v[72:75], a[84:87], a[40:43], v[72:75]
  ds_read_b128 a[68:71], v10 offset:43008
  buffer_load_dwordx4 a[200:203], v12, s[8:11], s33 offen offset:2048
  v_mfma_f32_16x16x32_bf16 v[72:75], a[88:91], a[48:51], v[72:75]
  ds_read_b128 a[72:75], v10 offset:51200
  v_mfma_f32_16x16x32_bf16 v[72:75], a[92:95], a[56:59], v[72:75]
  ds_read_b128 a[76:79], v10 offset:59392
  v_mfma_f32_16x16x32_bf16 v[76:79], a[92:95], a[60:63], v[76:79]
  buffer_load_dwordx4 a[204:207], v12, s[8:11], s33 offen offset:2304
  v_mfma_f32_16x16x32_bf16 v[76:79], a[88:91], a[52:55], v[76:79]
  v_mfma_f32_16x16x32_bf16 v[76:79], a[84:87], a[44:47], v[76:79]
  v_mfma_f32_16x16x32_bf16 v[76:79], a[80:83], a[36:39], v[76:79]
  s_waitcnt lgkmcnt(8)
  v_mfma_f32_16x16x32_bf16 v[80:83], a[96:99], a[32:35], v[80:83]
  ds_read_b128 a[80:83], v10 offset:35072
  v_mfma_f32_16x16x32_bf16 v[80:83], a[100:103], a[40:43], v[80:83]
  ds_read_b128 a[84:87], v10 offset:43264
  s_add_u32 s33, s33, 0x1000
  buffer_load_dwordx4 a[208:211], v12, s[8:11], s33 offen offset:0
  v_mfma_f32_16x16x32_bf16 v[80:83], a[104:107], a[48:51], v[80:83]
  ds_read_b128 a[88:91], v10 offset:51456
  v_mfma_f32_16x16x32_bf16 v[80:83], a[108:111], a[56:59], v[80:83]
  ds_read_b128 a[92:95], v10 offset:59648
  v_mfma_f32_16x16x32_bf16 v[84:87], a[108:111], a[60:63], v[84:87]
  buffer_load_dwordx4 a[212:215], v12, s[8:11], s33 offen offset:256
  v_mfma_f32_16x16x32_bf16 v[84:87], a[104:107], a[52:55], v[84:87]
  v_mfma_f32_16x16x32_bf16 v[84:87], a[100:103], a[44:47], v[84:87]
  v_mfma_f32_16x16x32_bf16 v[84:87], a[96:99], a[36:39], v[84:87]
  s_waitcnt lgkmcnt(8)
  v_mfma_f32_16x16x32_bf16 v[88:91], a[112:115], a[32:35], v[88:91]
  ds_read_b128 a[96:99], v10 offset:35840
  v_mfma_f32_16x16x32_bf16 v[88:91], a[116:119], a[40:43], v[88:91]
  ds_read_b128 a[100:103], v10 offset:44032
  buffer_load_dwordx4 a[216:219], v12, s[8:11], s33 offen offset:2048
  v_mfma_f32_16x16x32_bf16 v[88:91], a[120:123], a[48:51], v[88:91]
  ds_read_b128 a[104:107], v10 offset:52224
  v_mfma_f32_16x16x32_bf16 v[88:91], a[124:127], a[56:59], v[88:91]
  ds_read_b128 a[108:111], v10 offset:60416
  v_mfma_f32_16x16x32_bf16 v[92:95], a[124:127], a[60:63], v[92:95]
  buffer_load_dwordx4 a[220:223], v12, s[8:11], s33 offen offset:2304
  v_mfma_f32_16x16x32_bf16 v[92:95], a[120:123], a[52:55], v[92:95]
  v_mfma_f32_16x16x32_bf16 v[92:95], a[116:119], a[44:47], v[92:95]
  v_mfma_f32_16x16x32_bf16 v[92:95], a[112:115], a[36:39], v[92:95]
  s_waitcnt vmcnt(8) lgkmcnt(8)
  v_mfma_f32_16x16x32_bf16 v[64:67], a[64:67], a[160:163], v[64:67]
  ds_read_b128 a[112:115], v10 offset:36096
  v_mfma_f32_16x16x32_bf16 v[64:67], a[68:71], a[168:171], v[64:67]
  ds_read_b128 a[116:119], v10 offset:44288
  v_mfma_f32_16x16x32_bf16 v[64:67], a[72:75], a[176:179], v[64:67]
  ds_read_b128 a[120:123], v10 offset:52480
  v_mfma_f32_16x16x32_bf16 v[64:67], a[76:79], a[184:187], v[64:67]
  ds_read_b128 a[124:127], v10 offset:60672
  v_mfma_f32_16x16x32_bf16 v[68:71], a[76:79], a[188:191], v[68:71]
  v_mfma_f32_16x16x32_bf16 v[68:71], a[72:75], a[180:183], v[68:71]
  v_mfma_f32_16x16x32_bf16 v[68:71], a[68:71], a[172:175], v[68:71]
  v_mfma_f32_16x16x32_bf16 v[68:71], a[64:67], a[164:167], v[68:71]
  s_waitcnt vmcnt(11) lgkmcnt(0)
  s_barrier
  v_mfma_f32_16x16x32_bf16 v[72:75], a[80:83], a[160:163], v[72:75]
  ds_read_b128 a[64:67], v10 offset:2048
  v_mfma_f32_16x16x32_bf16 v[72:75], a[84:87], a[168:171], v[72:75]
  ds_read_b128 a[68:71], v10 offset:10240
  v_mfma_f32_16x16x32_bf16 v[72:75], a[88:91], a[176:179], v[72:75]
  ds_read_b128 a[72:75], v10 offset:18432
  v_mfma_f32_16x16x32_bf16 v[72:75], a[92:95], a[184:187], v[72:75]
  ds_read_b128 a[76:79], v10 offset:26624
  v_mfma_f32_16x16x32_bf16 v[76:79], a[92:95], a[188:191], v[76:79]
  v_mfma_f32_16x16x32_bf16 v[76:79], a[88:91], a[180:183], v[76:79]
  v_mfma_f32_16x16x32_bf16 v[76:79], a[84:87], a[172:175], v[76:79]
  v_mfma_f32_16x16x32_bf16 v[76:79], a[80:83], a[164:167], v[76:79]
  s_waitcnt lgkmcnt(8)
  v_mfma_f32_16x16x32_bf16 v[80:83], a[96:99], a[160:163], v[80:83]
  ds_read_b128 a[80:83], v10 offset:2304
  v_mfma_f32_16x16x32_bf16 v[80:83], a[100:103], a[168:171], v[80:83]
  ds_read_b128 a[84:87], v10 offset:10496
  v_mfma_f32_16x16x32_bf16 v[80:83], a[104:107], a[176:179], v[80:83]
  ds_read_b128 a[88:91], v10 offset:18688
  v_mfma_f32_16x16x32_bf16 v[80:83], a[108:111], a[184:187], v[80:83]
  ds_read_b128 a[92:95], v10 offset:26880
  v_mfma_f32_16x16x32_bf16 v[84:87], a[108:111], a[188:191], v[84:87]
  v_mfma_f32_16x16x32_bf16 v[84:87], a[104:107], a[180:183], v[84:87]
  v_mfma_f32_16x16x32_bf16 v[84:87], a[100:103], a[172:175], v[84:87]
  v_mfma_f32_16x16x32_bf16 v[84:87], a[96:99], a[164:167], v[84:87]
  s_waitcnt lgkmcnt(8)
  v_mfma_f32_16x16x32_bf16 v[88:91], a[112:115], a[160:163], v[88:91]
  ds_read_b128 a[96:99], v10 offset:3072
  v_mfma_f32_16x16x32_bf16 v[88:91], a[116:119], a[168:171], v[88:91]
  ds_read_b128 a[100:103], v10 offset:11264
  v_mfma_f32_16x16x32_bf16 v[88:91], a[120:123], a[176:179], v[88:91]
  ds_read_b128 a[104:107], v10 offset:19456
  v_mfma_f32_16x16x32_bf16 v[88:91], a[124:127], a[184:187], v[88:91]
  ds_read_b128 a[108:111], v10 offset:27648
  v_mfma_f32_16x16x32_bf16 v[92:95], a[124:127], a[188:191], v[92:95]
  v_mfma_f32_16x16x32_bf16 v[92:95], a[120:123], a[180:183], v[92:95]
  v_mfma_f32_16x16x32_bf16 v[92:95], a[116:119], a[172:175], v[92:95]
  v_mfma_f32_16x16x32_bf16 v[92:95], a[112:115], a[164:167], v[92:95]
  s_waitcnt vmcnt(0) lgkmcnt(8)
  v_mfma_f32_16x16x32_bf16 v[64:67], a[64:67], a[192:195], v[64:67]
  ds_read_b128 a[112:115], v10 offset:3328
  v_mfma_f32_16x16x32_bf16 v[64:67], a[68:71], a[200:203], v[64:67]
  ds_read_b128 a[116:119], v10 offset:11520
  v_mfma_f32_16x16x32_bf16 v[64:67], a[72:75], a[208:211], v[64:67]
  ds_read_b128 a[120:123], v10 offset:19712
  v_mfma_f32_16x16x32_bf16 v[64:67], a[76:79], a[216:219], v[64:67]
  ds_read_b128 a[124:127], v10 offset:27904
  v_mfma_f32_16x16x32_bf16 v[68:71], a[76:79], a[220:223], v[68:71]
  v_mfma_f32_16x16x32_bf16 v[68:71], a[72:75], a[212:215], v[68:71]
  v_mfma_f32_16x16x32_bf16 v[68:71], a[68:71], a[204:207], v[68:71]
  v_mfma_f32_16x16x32_bf16 v[68:71], a[64:67], a[196:199], v[68:71]
  s_waitcnt lgkmcnt(8)
  v_mfma_f32_16x16x32_bf16 v[72:75], a[80:83], a[192:195], v[72:75]
  ds_read_b128 a[64:67], v11 offset:0
  v_mfma_f32_16x16x32_bf16 v[72:75], a[84:87], a[200:203], v[72:75]
  ds_read_b128 a[68:71], v11 offset:8192
  v_mfma_f32_16x16x32_bf16 v[72:75], a[88:91], a[208:211], v[72:75]
  ds_read_b128 a[72:75], v11 offset:16384
  v_mfma_f32_16x16x32_bf16 v[72:75], a[92:95], a[216:219], v[72:75]
  ds_read_b128 a[76:79], v11 offset:24576
  v_mfma_f32_16x16x32_bf16 v[76:79], a[92:95], a[220:223], v[76:79]
  v_mfma_f32_16x16x32_bf16 v[76:79], a[88:91], a[212:215], v[76:79]
  v_mfma_f32_16x16x32_bf16 v[76:79], a[84:87], a[204:207], v[76:79]
  v_mfma_f32_16x16x32_bf16 v[76:79], a[80:83], a[196:199], v[76:79]
  s_waitcnt lgkmcnt(8)
  v_mfma_f32_16x16x32_bf16 v[80:83], a[96:99], a[192:195], v[80:83]
  ds_read_b128 a[80:83], v10 offset:32768
  v_mfma_f32_16x16x32_bf16 v[80:83], a[100:103], a[200:203], v[80:83]
  ds_read_b128 a[84:87], v10 offset:40960
  v_mfma_f32_16x16x32_bf16 v[80:83], a[104:107], a[208:211], v[80:83]
  ds_read_b128 a[88:91], v10 offset:49152
  v_mfma_f32_16x16x32_bf16 v[80:83], a[108:111], a[216:219], v[80:83]
  ds_read_b128 a[92:95], v10 offset:57344
  v_mfma_f32_16x16x32_bf16 v[84:87], a[108:111], a[220:223], v[84:87]
  v_mfma_f32_16x16x32_bf16 v[84:87], a[104:107], a[212:215], v[84:87]
  v_mfma_f32_16x16x32_bf16 v[84:87], a[100:103], a[204:207], v[84:87]
  v_mfma_f32_16x16x32_bf16 v[84:87], a[96:99], a[196:199], v[84:87]
  s_waitcnt lgkmcnt(8)
  v_mfma_f32_16x16x32_bf16 v[88:91], a[112:115], a[192:195], v[88:91]
  ds_read_b128 a[96:99], v10 offset:0
  v_mfma_f32_16x16x32_bf16 v[88:91], a[116:119], a[200:203], v[88:91]
  ds_read_b128 a[100:103], v10 offset:8192
  v_mfma_f32_16x16x32_bf16 v[88:91], a[120:123], a[208:211], v[88:91]
  ds_read_b128 a[104:107], v10 offset:16384
  v_mfma_f32_16x16x32_bf16 v[88:91], a[124:127], a[216:219], v[88:91]
  ds_read_b128 a[108:111], v10 offset:24576
  v_mfma_f32_16x16x32_bf16 v[92:95], a[124:127], a[220:223], v[92:95]
  v_mfma_f32_16x16x32_bf16 v[92:95], a[120:123], a[212:215], v[92:95]
  v_mfma_f32_16x16x32_bf16 v[92:95], a[116:119], a[204:207], v[92:95]
  v_mfma_f32_16x16x32_bf16 v[92:95], a[112:115], a[196:199], v[92:95]
  v_cvt_pk_bf16_f32 v64, v64, v65
  v_cvt_pk_bf16_f32 v65, v66, v67
  v_cvt_pk_bf16_f32 v66, v68, v69
  v_cvt_pk_bf16_f32 v67, v70, v71
  buffer_store_dwordx4 v[64:67], v1, s[96:99], 0 offen offset:0 sc1
  v_cvt_pk_bf16_f32 v68, v72, v73
  v_cvt_pk_bf16_f32 v69, v74, v75
  v_cvt_pk_bf16_f32 v70, v76, v77
  v_cvt_pk_bf16_f32 v71, v78, v79
  buffer_store_dwordx4 v[68:71], v1, s[96:99], 0 offen offset:1024 sc1
  v_cvt_pk_bf16_f32 v72, v80, v81
  v_cvt_pk_bf16_f32 v73, v82, v83
  v_cvt_pk_bf16_f32 v74, v84, v85
  v_cvt_pk_bf16_f32 v75, v86, v87
  buffer_store_dwordx4 v[72:75], v1, s[96:99], 0 offen offset:2048 sc1
  v_cvt_pk_bf16_f32 v76, v88, v89
  v_cvt_pk_bf16_f32 v77, v90, v91
  v_cvt_pk_bf16_f32 v78, v92, v93
  v_cvt_pk_bf16_f32 v79, v94, v95
  buffer_store_dwordx4 v[76:79], v1, s[96:99], 0 offen offset:3072 sc1
  s_lshr_b32 s39, s3, 1
  s_lshl_b32 s39, s39, 8
  s_xor_b32 s41, s2, 4
  s_add_u32 s39, s39, s41
  s_lshl_b32 s39, s39, 2
  s_add_u32 s39, s39, s30
  s_lshl_b32 s39, s39, 13
  s_add_u32 s39, s39, 100663296
  s_add_u32 s96, s6, s39
  s_addc_u32 s97, s7, 0
  s_mov_b32 s98, 4096
  s_mov_b32 s99, 0x20000
  s_waitcnt lgkmcnt(8)
  v_mfma_f32_16x16x32_bf16 v[32:35], a[64:67], a[32:35], v[32:35]
  ds_read_b128 a[112:115], v11 offset:256
  s_mul_i32 s39, s49, 196608
  s_add_u32 s39, s39, 33554432
  v_mfma_f32_16x16x32_bf16 v[32:35], a[68:71], a[40:43], v[32:35]
  ds_read_b128 a[116:119], v11 offset:8448
  s_add_u32 s16, s6, s39
  s_addc_u32 s17, s7, 0
  v_mfma_f32_16x16x32_bf16 v[32:35], a[72:75], a[48:51], v[32:35]
  ds_read_b128 a[120:123], v11 offset:16640
  s_mov_b32 s18, 196608
  s_mov_b32 s19, 0x20000
  v_mfma_f32_16x16x32_bf16 v[32:35], a[76:79], a[56:59], v[32:35]
  ds_read_b128 a[124:127], v11 offset:24832
  s_mul_i32 s39, s30, 6144
  v_mfma_f32_16x16x32_bf16 v[36:39], a[76:79], a[60:63], v[36:39]
  v_add_u32 v2, s39, v1
  v_add_u32 v3, 0x1000, v2
  v_mfma_f32_16x16x32_bf16 v[36:39], a[72:75], a[52:55], v[36:39]
  s_add_u32 s35, s39, 4096
  s_add_u32 s36, s39, 53248
  v_mfma_f32_16x16x32_bf16 v[36:39], a[68:71], a[44:47], v[36:39]
  s_mov_b32 s37, 49152
  s_mov_b32 s33, 0
  v_mfma_f32_16x16x32_bf16 v[36:39], a[64:67], a[36:39], v[36:39]
  s_mov_b32 s34, 0
  s_waitcnt lgkmcnt(8)
  v_mfma_f32_16x16x32_bf16 v[32:35], a[80:83], a[160:163], v[32:35]
  ds_read_b128 a[64:67], v10 offset:33024
  s_add_u32 m0, s35, 0
  v_mfma_f32_16x16x32_bf16 v[32:35], a[84:87], a[168:171], v[32:35]
  ds_read_b128 a[68:71], v10 offset:41216
  v_mfma_f32_16x16x32_bf16 v[32:35], a[88:91], a[176:179], v[32:35]
  ds_read_b128 a[72:75], v10 offset:49408
  v_mfma_f32_16x16x32_bf16 v[32:35], a[92:95], a[184:187], v[32:35]
  ds_read_b128 a[76:79], v10 offset:57600
  v_mfma_f32_16x16x32_bf16 v[36:39], a[92:95], a[188:191], v[36:39]
  buffer_load_dwordx4 v2, s[16:19], s34 offen offset:0 lds
  v_mfma_f32_16x16x32_bf16 v[36:39], a[88:91], a[180:183], v[36:39]
  v_mfma_f32_16x16x32_bf16 v[36:39], a[84:87], a[172:175], v[36:39]
  v_mfma_f32_16x16x32_bf16 v[36:39], a[80:83], a[164:167], v[36:39]
  s_waitcnt lgkmcnt(8)
  v_mfma_f32_16x16x32_bf16 v[32:35], a[96:99], a[192:195], v[32:35]
  ds_read_b128 a[80:83], v10 offset:256
  buffer_load_dwordx4 v2, s[16:19], s34 offen offset:1024 lds
  v_mfma_f32_16x16x32_bf16 v[32:35], a[100:103], a[200:203], v[32:35]
  ds_read_b128 a[84:87], v10 offset:8448
  v_mfma_f32_16x16x32_bf16 v[32:35], a[104:107], a[208:211], v[32:35]
  ds_read_b128 a[88:91], v10 offset:16640
  v_mfma_f32_16x16x32_bf16 v[32:35], a[108:111], a[216:219], v[32:35]
  ds_read_b128 a[92:95], v10 offset:24832
  v_mfma_f32_16x16x32_bf16 v[36:39], a[108:111], a[220:223], v[36:39]
  v_mfma_f32_16x16x32_bf16 v[36:39], a[104:107], a[212:215], v[36:39]
  v_mfma_f32_16x16x32_bf16 v[36:39], a[100:103], a[204:207], v[36:39]
  v_mfma_f32_16x16x32_bf16 v[36:39], a[96:99], a[196:199], v[36:39]
  s_waitcnt lgkmcnt(8)
  v_mfma_f32_16x16x32_bf16 v[40:43], a[112:115], a[32:35], v[40:43]
  ds_read_b128 a[96:99], v11 offset:1024
  buffer_load_dwordx4 v2, s[16:19], s34 offen offset:2048 lds
  v_mfma_f32_16x16x32_bf16 v[40:43], a[116:119], a[40:43], v[40:43]
  ds_read_b128 a[100:103], v11 offset:9216
  v_mfma_f32_16x16x32_bf16 v[40:43], a[120:123], a[48:51], v[40:43]
  ds_read_b128 a[104:107], v11 offset:17408
  v_mfma_f32_16x16x32_bf16 v[40:43], a[124:127], a[56:59], v[40:43]
  ds_read_b128 a[108:111], v11 offset:25600
  v_mfma_f32_16x16x32_bf16 v[44:47], a[124:127], a[60:63], v[44:47]
  v_mfma_f32_16x16x32_bf16 v[44:47], a[120:123], a[52:55], v[44:47]
  v_mfma_f32_16x16x32_bf16 v[44:47], a[116:119], a[44:47], v[44:47]
  v_mfma_f32_16x16x32_bf16 v[44:47], a[112:115], a[36:39], v[44:47]
  s_waitcnt lgkmcnt(8)
  v_mfma_f32_16x16x32_bf16 v[40:43], a[64:67], a[160:163], v[40:43]
  ds_read_b128 a[112:115], v10 offset:33792
  buffer_load_dwordx4 v2, s[16:19], s34 offen offset:3072 lds
  v_mfma_f32_16x16x32_bf16 v[40:43], a[68:71], a[168:171], v[40:43]
  ds_read_b128 a[116:119], v10 offset:41984
  v_mfma_f32_16x16x32_bf16 v[40:43], a[72:75], a[176:179], v[40:43]
  ds_read_b128 a[120:123], v10 offset:50176
  v_mfma_f32_16x16x32_bf16 v[40:43], a[76:79], a[184:187], v[40:43]
  ds_read_b128 a[124:127], v10 offset:58368
  v_mfma_f32_16x16x32_bf16 v[44:47], a[76:79], a[188:191], v[44:47]
  v_mfma_f32_16x16x32_bf16 v[44:47], a[72:75], a[180:183], v[44:47]
  v_mfma_f32_16x16x32_bf16 v[44:47], a[68:71], a[172:175], v[44:47]
  v_mfma_f32_16x16x32_bf16 v[44:47], a[64:67], a[164:167], v[44:47]
  s_waitcnt lgkmcnt(8)
  v_mfma_f32_16x16x32_bf16 v[40:43], a[80:83], a[192:195], v[40:43]
  ds_read_b128 a[64:67], v10 offset:1024
  s_add_u32 m0, s35, 4096
  v_mfma_f32_16x16x32_bf16 v[40:43], a[84:87], a[200:203], v[40:43]
  ds_read_b128 a[68:71], v10 offset:9216
  v_mfma_f32_16x16x32_bf16 v[40:43], a[88:91], a[208:211], v[40:43]
  ds_read_b128 a[72:75], v10 offset:17408
  v_mfma_f32_16x16x32_bf16 v[40:43], a[92:95], a[216:219], v[40:43]
  ds_read_b128 a[76:79], v10 offset:25600
  v_mfma_f32_16x16x32_bf16 v[44:47], a[92:95], a[220:223], v[44:47]
  buffer_load_dwordx4 v3, s[16:19], s34 offen offset:0 lds
  v_mfma_f32_16x16x32_bf16 v[44:47], a[88:91], a[212:215], v[44:47]
  v_mfma_f32_16x16x32_bf16 v[44:47], a[84:87], a[204:207], v[44:47]
  v_mfma_f32_16x16x32_bf16 v[44:47], a[80:83], a[196:199], v[44:47]
  s_waitcnt lgkmcnt(8)
  v_mfma_f32_16x16x32_bf16 v[48:51], a[96:99], a[32:35], v[48:51]
  ds_read_b128 a[80:83], v11 offset:1280
  buffer_load_dwordx4 v3, s[16:19], s34 offen offset:1024 lds
  v_mfma_f32_16x16x32_bf16 v[48:51], a[100:103], a[40:43], v[48:51]
  ds_read_b128 a[84:87], v11 offset:9472
  v_mfma_f32_16x16x32_bf16 v[48:51], a[104:107], a[48:51], v[48:51]
  ds_read_b128 a[88:91], v11 offset:17664
  v_mfma_f32_16x16x32_bf16 v[48:51], a[108:111], a[56:59], v[48:51]
  ds_read_b128 a[92:95], v11 offset:25856
  v_mfma_f32_16x16x32_bf16 v[52:55], a[108:111], a[60:63], v[52:55]
  s_add_u32 s34, s34, 24576
  v_mfma_f32_16x16x32_bf16 v[52:55], a[104:107], a[52:55], v[52:55]
  v_mfma_f32_16x16x32_bf16 v[52:55], a[100:103], a[44:47], v[52:55]
  v_mfma_f32_16x16x32_bf16 v[52:55], a[96:99], a[36:39], v[52:55]
  s_waitcnt lgkmcnt(8)
  v_mfma_f32_16x16x32_bf16 v[48:51], a[112:115], a[160:163], v[48:51]
  ds_read_b128 a[96:99], v10 offset:34048
  v_mfma_f32_16x16x32_bf16 v[48:51], a[116:119], a[168:171], v[48:51]
  ds_read_b128 a[100:103], v10 offset:42240
  v_mfma_f32_16x16x32_bf16 v[48:51], a[120:123], a[176:179], v[48:51]
  ds_read_b128 a[104:107], v10 offset:50432
  v_mfma_f32_16x16x32_bf16 v[48:51], a[124:127], a[184:187], v[48:51]
  ds_read_b128 a[108:111], v10 offset:58624
  v_mfma_f32_16x16x32_bf16 v[52:55], a[124:127], a[188:191], v[52:55]
  v_mfma_f32_16x16x32_bf16 v[52:55], a[120:123], a[180:183], v[52:55]
  v_mfma_f32_16x16x32_bf16 v[52:55], a[116:119], a[172:175], v[52:55]
  v_mfma_f32_16x16x32_bf16 v[52:55], a[112:115], a[164:167], v[52:55]
  s_waitcnt lgkmcnt(8)
  v_mfma_f32_16x16x32_bf16 v[48:51], a[64:67], a[192:195], v[48:51]
  ds_read_b128 a[112:115], v10 offset:1280
  buffer_load_dwordx4 v[96:99], v1, s[96:99], 0 offen offset:0 sc1
  v_mfma_f32_16x16x32_bf16 v[48:51], a[68:71], a[200:203], v[48:51]
  ds_read_b128 a[116:119], v10 offset:9472
  v_mfma_f32_16x16x32_bf16 v[48:51], a[72:75], a[208:211], v[48:51]
  ds_read_b128 a[120:123], v10 offset:17664
  buffer_load_dwordx4 v[100:103], v1, s[96:99], 0 offen offset:1024 sc1
  v_mfma_f32_16x16x32_bf16 v[48:51], a[76:79], a[216:219], v[48:51]
  ds_read_b128 a[124:127], v10 offset:25856
  v_mfma_f32_16x16x32_bf16 v[52:55], a[76:79], a[220:223], v[52:55]
  buffer_load_dwordx4 v[104:107], v1, s[96:99], 0 offen offset:2048 sc1
  v_mfma_f32_16x16x32_bf16 v[52:55], a[72:75], a[212:215], v[52:55]
  v_mfma_f32_16x16x32_bf16 v[52:55], a[68:71], a[204:207], v[52:55]
  buffer_load_dwordx4 v[108:111], v1, s[96:99], 0 offen offset:3072 sc1
  v_mfma_f32_16x16x32_bf16 v[52:55], a[64:67], a[196:199], v[52:55]
  s_waitcnt lgkmcnt(8)
  v_mfma_f32_16x16x32_bf16 v[56:59], a[80:83], a[32:35], v[56:59]
  v_mfma_f32_16x16x32_bf16 v[56:59], a[84:87], a[40:43], v[56:59]
  v_mfma_f32_16x16x32_bf16 v[56:59], a[88:91], a[48:51], v[56:59]
  v_mfma_f32_16x16x32_bf16 v[56:59], a[92:95], a[56:59], v[56:59]
  v_mfma_f32_16x16x32_bf16 v[60:63], a[92:95], a[60:63], v[60:63]
  v_mfma_f32_16x16x32_bf16 v[60:63], a[88:91], a[52:55], v[60:63]
  v_mfma_f32_16x16x32_bf16 v[60:63], a[84:87], a[44:47], v[60:63]
  v_mfma_f32_16x16x32_bf16 v[60:63], a[80:83], a[36:39], v[60:63]
  s_waitcnt lgkmcnt(4)
  v_mfma_f32_16x16x32_bf16 v[56:59], a[96:99], a[160:163], v[56:59]
  v_mfma_f32_16x16x32_bf16 v[56:59], a[100:103], a[168:171], v[56:59]
  v_mfma_f32_16x16x32_bf16 v[56:59], a[104:107], a[176:179], v[56:59]
  v_mfma_f32_16x16x32_bf16 v[56:59], a[108:111], a[184:187], v[56:59]
  v_mfma_f32_16x16x32_bf16 v[60:63], a[108:111], a[188:191], v[60:63]
  v_mfma_f32_16x16x32_bf16 v[60:63], a[104:107], a[180:183], v[60:63]
  v_mfma_f32_16x16x32_bf16 v[60:63], a[100:103], a[172:175], v[60:63]
  v_mfma_f32_16x16x32_bf16 v[60:63], a[96:99], a[164:167], v[60:63]
  s_waitcnt lgkmcnt(0)
  v_mfma_f32_16x16x32_bf16 v[56:59], a[112:115], a[192:195], v[56:59]
  v_mfma_f32_16x16x32_bf16 v[56:59], a[116:119], a[200:203], v[56:59]
  v_mfma_f32_16x16x32_bf16 v[56:59], a[120:123], a[208:211], v[56:59]
  v_mfma_f32_16x16x32_bf16 v[56:59], a[124:127], a[216:219], v[56:59]
  v_mfma_f32_16x16x32_bf16 v[60:63], a[124:127], a[220:223], v[60:63]
  v_mfma_f32_16x16x32_bf16 v[60:63], a[120:123], a[212:215], v[60:63]
  v_mfma_f32_16x16x32_bf16 v[60:63], a[116:119], a[204:207], v[60:63]
  v_mfma_f32_16x16x32_bf16 v[60:63], a[112:115], a[196:199], v[60:63]
ex_chk:
  s_waitcnt vmcnt(0)
  v_max_u32 v64, v96, v97
  v_max3_u32 v64, v64, v98, v99
  v_max3_u32 v64, v64, v100, v101
  v_max3_u32 v64, v64, v102, v103
  v_max3_u32 v64, v64, v104, v105
  v_max3_u32 v64, v64, v106, v107
  v_max3_u32 v64, v64, v108, v109
  v_max3_u32 v64, v64, v110, v111
  v_cmp_eq_u32 vcc, -1, v64
  s_nop 4
  s_cbranch_vccz ex_ok
  s_sub_u32 s90, s90, 64
  s_cbranch_scc1 ex_ok
  s_sleep 1
  buffer_load_dwordx4 v[96:99], v1, s[96:99], 0 offen offset:0 sc1
  buffer_load_dwordx4 v[100:103], v1, s[96:99], 0 offen offset:1024 sc1
  buffer_load_dwordx4 v[104:107], v1, s[96:99], 0 offen offset:2048 sc1
  buffer_load_dwordx4 v[108:111], v1, s[96:99], 0 offen offset:3072 sc1
  s_branch ex_chk
ex_ok:
  v_lshlrev_b32 v64, 16, v96
  v_and_b32 v65, 0xffff0000, v96
  v_lshlrev_b32 v66, 16, v97
  v_and_b32 v67, 0xffff0000, v97
  v_lshlrev_b32 v68, 16, v98
  v_and_b32 v69, 0xffff0000, v98
  v_lshlrev_b32 v70, 16, v99
  v_and_b32 v71, 0xffff0000, v99
  v_lshlrev_b32 v72, 16, v100
  v_and_b32 v73, 0xffff0000, v100
  v_lshlrev_b32 v74, 16, v101
  v_and_b32 v75, 0xffff0000, v101
  v_lshlrev_b32 v76, 16, v102
  v_and_b32 v77, 0xffff0000, v102
  v_lshlrev_b32 v78, 16, v103
  v_and_b32 v79, 0xffff0000, v103
  v_lshlrev_b32 v80, 16, v104
  v_and_b32 v81, 0xffff0000, v104
  v_lshlrev_b32 v82, 16, v105
  v_and_b32 v83, 0xffff0000, v105
  v_lshlrev_b32 v84, 16, v106
  v_and_b32 v85, 0xffff0000, v106
  v_lshlrev_b32 v86, 16, v107
  v_and_b32 v87, 0xffff0000, v107
  v_lshlrev_b32 v88, 16, v108
  v_and_b32 v89, 0xffff0000, v108
  v_lshlrev_b32 v90, 16, v109
  v_and_b32 v91, 0xffff0000, v109
  v_lshlrev_b32 v92, 16, v110
  v_and_b32 v93, 0xffff0000, v110
  v_lshlrev_b32 v94, 16, v111
  v_and_b32 v95, 0xffff0000, v111
  v_pk_add_f32 v[32:33], v[32:33], v[64:65]
  v_pk_add_f32 v[34:35], v[34:35], v[66:67]
  v_pk_add_f32 v[36:37], v[36:37], v[68:69]
  v_pk_add_f32 v[38:39], v[38:39], v[70:71]
  v_pk_add_f32 v[40:41], v[40:41], v[72:73]
  v_pk_add_f32 v[42:43], v[42:43], v[74:75]
  v_pk_add_f32 v[44:45], v[44:45], v[76:77]
  v_pk_add_f32 v[46:47], v[46:47], v[78:79]
  v_pk_add_f32 v[48:49], v[48:49], v[80:81]
  v_pk_add_f32 v[50:51], v[50:51], v[82:83]
  v_pk_add_f32 v[52:53], v[52:53], v[84:85]
  v_pk_add_f32 v[54:55], v[54:55], v[86:87]
  v_pk_add_f32 v[56:57], v[56:57], v[88:89]
  v_pk_add_f32 v[58:59], v[58:59], v[90:91]
  v_pk_add_f32 v[60:61], v[60:61], v[92:93]
  v_pk_add_f32 v[62:63], v[62:63], v[94:95]
  s_cmp_eq_u32 s3, 3
  s_cbranch_scc1 g24_final
  v_and_b32 v9, 31, v0
  v_lshlrev_b32 v9, 2, v9
  v_lshl_add_u32 v9, v15, 13, v9
  s_add_u32 s3, s3, 1
  s_lshl_b32 s39, s3, 14
  s_lshl_b32 s40, s100, 7
  s_add_u32 s39, s39, s40
  v_pk_mul_f32 v[64:65], v[32:33], v[32:33]
  v_pk_add_f32 v[16:17], v[32:33], v[34:35]
  v_pk_fma_f32 v[64:65], v[34:35], v[34:35], v[64:65]
  v_pk_fma_f32 v[64:65], v[40:41], v[40:41], v[64:65]
  v_pk_add_f32 v[16:17], v[16:17], v[40:41]
  v_pk_fma_f32 v[64:65], v[42:43], v[42:43], v[64:65]
  v_pk_add_f32 v[16:17], v[16:17], v[42:43]
  v_pk_fma_f32 v[64:65], v[48:49], v[48:49], v[64:65]
  v_pk_add_f32 v[16:17], v[16:17], v[48:49]
  v_pk_fma_f32 v[64:65], v[50:51], v[50:51], v[64:65]
  v_pk_add_f32 v[16:17], v[16:17], v[50:51]
  v_pk_fma_f32 v[64:65], v[56:57], v[56:57], v[64:65]
  v_pk_add_f32 v[16:17], v[16:17], v[56:57]
  v_pk_fma_f32 v[64:65], v[58:59], v[58:59], v[64:65]
  v_pk_add_f32 v[16:17], v[16:17], v[58:59]
  v_add_f32 v4, v16, v17
  v_add_f32 v5, v64, v65
  v_pk_mul_f32 v[66:67], v[36:37], v[36:37]
  v_pk_add_f32 v[18:19], v[36:37], v[38:39]
  v_pk_fma_f32 v[66:67], v[38:39], v[38:39], v[66:67]
  v_pk_fma_f32 v[66:67], v[44:45], v[44:45], v[66:67]
  v_pk_add_f32 v[18:19], v[18:19], v[44:45]
  v_pk_fma_f32 v[66:67], v[46:47], v[46:47], v[66:67]
  v_pk_add_f32 v[18:19], v[18:19], v[46:47]
  v_pk_fma_f32 v[66:67], v[52:53], v[52:53], v[66:67]
  v_pk_add_f32 v[18:19], v[18:19], v[52:53]
  v_pk_fma_f32 v[66:67], v[54:55], v[54:55], v[66:67]
  v_pk_add_f32 v[18:19], v[18:19], v[54:55]
  v_pk_fma_f32 v[66:67], v[60:61], v[60:61], v[66:67]
  v_pk_add_f32 v[18:19], v[18:19], v[60:61]
  v_pk_fma_f32 v[66:67], v[62:63], v[62:63], v[66:67]
  v_pk_add_f32 v[18:19], v[18:19], v[62:63]
  v_add_f32 v6, v18, v19
  v_add_f32 v7, v66, v67
  v_permlane32_swap_b32 v4, v5
  s_nop 0
  v_permlane32_swap_b32 v6, v7
  v_add_f32 v4, v4, v5
  v_add_f32 v6, v6, v7
  s_nop 1
  v_permlane16_swap_b32 v4, v6
  v_add_f32 v6, v4, v6
  buffer_atomic_add_f32 v6, v9, s[24:27], s39 offen offset:0 sc1
  v_cvt_pk_bf16_f32 v16, v32, v33
  v_cvt_pk_bf16_f32 v17, v34, v35
  v_cvt_pk_bf16_f32 v18, v36, v37
  v_cvt_pk_bf16_f32 v19, v38, v39
  v_cvt_pk_bf16_f32 v20, v40, v41
  v_cvt_pk_bf16_f32 v21, v42, v43
  v_cvt_pk_bf16_f32 v22, v44, v45
  v_cvt_pk_bf16_f32 v23, v46, v47
  v_cvt_pk_bf16_f32 v24, v48, v49
  v_cvt_pk_bf16_f32 v25, v50, v51
  v_cvt_pk_bf16_f32 v26, v52, v53
  v_cvt_pk_bf16_f32 v27, v54, v55
  v_cvt_pk_bf16_f32 v28, v56, v57
  v_cvt_pk_bf16_f32 v29, v58, v59
  v_cvt_pk_bf16_f32 v30, v60, v61
  v_cvt_pk_bf16_f32 v31, v62, v63
  v_permlane32_swap_b32 v16, v18
  v_permlane32_swap_b32 v17, v19
  v_permlane32_swap_b32 v20, v22
  v_permlane32_swap_b32 v21, v23
  v_permlane32_swap_b32 v24, v26
  v_permlane32_swap_b32 v25, v27
  v_permlane32_swap_b32 v28, v30
  v_permlane32_swap_b32 v29, v31
  buffer_store_dwordx4 v[16:19], v13, s[20:23], 0 offen offset:0 sc1
  buffer_store_dwordx4 v[20:23], v13, s[20:23], 0 offen offset:1024 sc1
  buffer_store_dwordx4 v[24:27], v13, s[20:23], 0 offen offset:2048 sc1
  buffer_store_dwordx4 v[28:31], v13, s[20:23], 0 offen offset:3072 sc1
  s_lshl_b32 s42, s48, 10
  s_and_b32 s41, s49, 3
  s_lshl_b32 s41, s41, 8
  s_add_u32 s42, s42, s41
  s_add_u32 s42, s42, 32768
  s_add_u32 s42, s42, s28
  v_mov_b32 v32, 0
  v_mov_b32 v33, 0
  v_mov_b32 v34, 0
  v_mov_b32 v35, 0
  v_mov_b32 v36, 0
  v_mov_b32 v37, 0
  v_mov_b32 v38, 0
  v_mov_b32 v39, 0
  v_mov_b32 v40, 0
  v_mov_b32 v41, 0
  v_mov_b32 v42, 0
  v_mov_b32 v43, 0
  v_mov_b32 v44, 0
  v_mov_b32 v45, 0
  v_mov_b32 v46, 0
  v_mov_b32 v47, 0
  v_mov_b32 v48, 0
  v_mov_b32 v49, 0
  v_mov_b32 v50, 0
  v_mov_b32 v51, 0
  v_mov_b32 v52, 0
  v_mov_b32 v53, 0
  v_mov_b32 v54, 0
  v_mov_b32 v55, 0
  v_mov_b32 v56, 0
  v_mov_b32 v57, 0
  v_mov_b32 v58, 0
  v_mov_b32 v59, 0
  v_mov_b32 v60, 0
  v_mov_b32 v61, 0
  v_mov_b32 v62, 0
  v_mov_b32 v63, 0
  v_mov_b32 v64, 0
  v_mov_b32 v65, 0
  v_mov_b32 v66, 0
  v_mov_b32 v67, 0
  v_mov_b32 v68, 0
  v_mov_b32 v69, 0
  v_mov_b32 v70, 0
  v_mov_b32 v71, 0
  v_mov_b32 v72, 0
  v_mov_b32 v73, 0
  v_mov_b32 v74, 0
  v_mov_b32 v75, 0
  v_mov_b32 v76, 0
  v_mov_b32 v77, 0
  v_mov_b32 v78, 0
  v_mov_b32 v79, 0
  v_mov_b32 v80, 0
  v_mov_b32 v81, 0
  v_mov_b32 v82, 0
  v_mov_b32 v83, 0
  v_mov_b32 v84, 0
  v_mov_b32 v85, 0
  v_mov_b32 v86, 0
  v_mov_b32 v87, 0
  v_mov_b32 v88, 0
  v_mov_b32 v89, 0
  v_mov_b32 v90, 0
  v_mov_b32 v91, 0
  v_mov_b32 v92, 0
  v_mov_b32 v93, 0
  v_mov_b32 v94, 0
  v_mov_b32 v95, 0
  v_mov_b32 v96, 0
  v_mov_b32 v97, 0
  v_mov_b32 v98, 0
  v_mov_b32 v99, 0
  v_mov_b32 v100, 0
  v_mov_b32 v101, 0
  v_mov_b32 v102, 0
  v_mov_b32 v103, 0
  v_mov_b32 v104, 0
  v_mov_b32 v105, 0
  v_mov_b32 v106, 0
  v_mov_b32 v107, 0
  v_mov_b32 v108, 0
  v_mov_b32 v109, 0
  v_mov_b32 v110, 0
  v_mov_b32 v111, 0
  v_mov_b32 v112, 0
  v_mov_b32 v113, 0
  v_mov_b32 v114, 0
  v_mov_b32 v115, 0
  v_mov_b32 v116, 0
  v_mov_b32 v117, 0
  v_mov_b32 v118, 0
  v_mov_b32 v119, 0
  v_mov_b32 v120, 0
  v_mov_b32 v121, 0
  v_mov_b32 v122, 0
  v_mov_b32 v123, 0
  v_mov_b32 v124, 0
  v_mov_b32 v125, 0
  v_mov_b32 v126, 0
  v_mov_b32 v127, 0
  s_waitcnt vmcnt(0)
  s_barrier
  s_cmp_lg_u32 s30, 0
  s_cbranch_scc1 arr5
  v_mov_b32 v8, 0
  v_mov_b32 v9, 1
  s_mov_b64 exec, 1
  buffer_atomic_add v9, v8, s[24:27], s42 offen sc1
  s_mov_b64 exec, -1
arr5:
  s_branch ph_g1
g24_final:
  v_cvt_pk_bf16_f32 v16, v32, v33
  v_cvt_pk_bf16_f32 v17, v34, v35
  v_cvt_pk_bf16_f32 v18, v36, v37
  v_cvt_pk_bf16_f32 v19, v38, v39
  v_cvt_pk_bf16_f32 v20, v40, v41
  v_cvt_pk_bf16_f32 v21, v42, v43
  v_cvt_pk_bf16_f32 v22, v44, v45
  v_cvt_pk_bf16_f32 v23, v46, v47
  v_cvt_pk_bf16_f32 v24, v48, v49
  v_cvt_pk_bf16_f32 v25, v50, v51
  v_cvt_pk_bf16_f32 v26, v52, v53
  v_cvt_pk_bf16_f32 v27, v54, v55
  v_cvt_pk_bf16_f32 v28, v56, v57
  v_cvt_pk_bf16_f32 v29, v58, v59
  v_cvt_pk_bf16_f32 v30, v60, v61
  v_cvt_pk_bf16_f32 v31, v62, v63
  v_permlane32_swap_b32 v16, v18
  v_permlane32_swap_b32 v17, v19
  v_permlane32_swap_b32 v20, v22
  v_permlane32_swap_b32 v21, v23
  v_permlane32_swap_b32 v24, v26
  v_permlane32_swap_b32 v25, v27
  v_permlane32_swap_b32 v28, v30
  v_permlane32_swap_b32 v29, v31
  s_mov_b32 s20, s4
  s_mov_b32 s21, s5
  s_mov_b32 s22, 4194304
  s_mov_b32 s23, 0x20000
  s_lshl_b32 s39, s100, 16
  s_lshl_b32 s40, s101, 7
  s_add_u32 s39, s39, s40
  v_and_b32 v3, 15, v0
  v_lshl_add_u32 v3, v15, 4, v3
  v_mul_u32_u24 v3, 144, v3
  v_and_b32 v4, 16, v0
  s_mul_i32 s41, s30, 4608
  s_add_u32 s41, s41, 0x10000
  v_add3_u32 v3, v3, v4, s41
  ds_write_b128 v3, v[16:19] offset:0
  ds_write_b128 v3, v[20:23] offset:32
  ds_write_b128 v3, v[24:27] offset:64
  ds_write_b128 v3, v[28:31] offset:96
  v_lshrrev_b32 v4, 3, v0
  v_and_b32 v5, 7, v0
  v_lshlrev_b32 v5, 4, v5
  v_mul_u32_u24 v3, 144, v4
  v_add3_u32 v3, v3, v5, s41
  v_lshl_add_u32 v4, v4, 11, v5
  s_waitcnt lgkmcnt(0)
  ds_read_b128 v[32:35], v3 offset:0
  ds_read_b128 v[36:39], v3 offset:1152
  ds_read_b128 v[40:43], v3 offset:2304
  ds_read_b128 v[44:47], v3 offset:3456
  s_waitcnt lgkmcnt(3)
  buffer_store_dwordx4 v[32:35], v4, s[20:23], s39 offen sc1
  s_add_u32 s39, s39, 0x4000
  s_waitcnt lgkmcnt(2)
  buffer_store_dwordx4 v[36:39], v4, s[20:23], s39 offen sc1
  s_add_u32 s39, s39, 0x4000
  s_waitcnt lgkmcnt(1)
  buffer_store_dwordx4 v[40:43], v4, s[20:23], s39 offen sc1
  s_add_u32 s39, s39, 0x4000
  s_waitcnt lgkmcnt(0)
  buffer_store_dwordx4 v[44:47], v4, s[20:23], s39 offen sc1
  s_add_u32 s39, s39, 0x4000
main_end:
  s_endpgm
bg_a0:
  s_add_u32 m0, s41, 0
  s_nop 0
  buffer_load_dwordx4 v6, s[56:59], s91 offen  lds
  s_add_u32 m0, s41, 1024
  s_nop 0
  buffer_load_dwordx4 v7, s[56:59], s91 offen  lds
  s_add_u32 s91, s91, 0x4000
  s_add_u32 m0, s41, 2048
  s_nop 0
  buffer_load_dwordx4 v6, s[56:59], s91 offen  lds
  s_add_u32 m0, s41, 3072
  s_nop 0
  buffer_load_dwordx4 v7, s[56:59], s91 offen  lds
  s_add_u32 s91, s91, 0x4000
  s_branch bg_a0_r
bg_b0:
  ds_read_b64_tr_b16 a[224:225], v28 offset:0
  ds_read_b64_tr_b16 a[226:227], v28 offset:1024
  ds_read_b64_tr_b16 a[228:229], v29 offset:0
  ds_read_b64_tr_b16 a[230:231], v29 offset:1024
  ds_read_b64_tr_b16 a[232:233], v30 offset:0
  ds_read_b64_tr_b16 a[234:235], v30 offset:1024
  ds_read_b64_tr_b16 a[236:237], v31 offset:0
  ds_read_b64_tr_b16 a[238:239], v31 offset:1024
  s_branch bg_b0_r
bg_c0:
  buffer_store_dwordx4 a[224:227], v1, s[24:27], s89 offen offset:0 sc1
  buffer_store_dwordx4 a[228:231], v1, s[24:27], s89 offen offset:1024 sc1
  buffer_store_dwordx4 a[232:235], v1, s[24:27], s93 offen offset:0 sc1
  buffer_store_dwordx4 a[236:239], v1, s[24:27], s93 offen offset:1024 sc1
  s_branch bg_c0_r
bg_a1:
  s_add_u32 m0, s41, 4096
  s_nop 0
  buffer_load_dwordx4 v6, s[56:59], s91 offen  lds
  s_add_u32 m0, s41, 5120
  s_nop 0
  buffer_load_dwordx4 v7, s[56:59], s91 offen  lds
  s_add_u32 s91, s91, 0x4000
  s_add_u32 m0, s41, 6144
  s_nop 0
  buffer_load_dwordx4 v6, s[56:59], s91 offen  lds
  s_add_u32 m0, s41, 7168
  s_nop 0
  buffer_load_dwordx4 v7, s[56:59], s91 offen  lds
  s_add_u32 s91, s91, 0x4000
  s_branch bg_a1_r
bg_b1:
  ds_read_b64_tr_b16 a[224:225], v28 offset:4096
  ds_read_b64_tr_b16 a[226:227], v28 offset:5120
  ds_read_b64_tr_b16 a[228:229], v29 offset:4096
  ds_read_b64_tr_b16 a[230:231], v29 offset:5120
  ds_read_b64_tr_b16 a[232:233], v30 offset:4096
  ds_read_b64_tr_b16 a[234:235], v30 offset:5120
  ds_read_b64_tr_b16 a[236:237], v31 offset:4096
  ds_read_b64_tr_b16 a[238:239], v31 offset:5120
  s_branch bg_b1_r
bg_c1:
  buffer_store_dwordx4 a[224:227], v1, s[24:27], s90 offen offset:0 sc1
  buffer_store_dwordx4 a[228:231], v1, s[24:27], s90 offen offset:1024 sc1
  buffer_store_dwordx4 a[232:235], v1, s[24:27], s94 offen offset:0 sc1
  buffer_store_dwordx4 a[236:239], v1, s[24:27], s94 offen offset:1024 sc1
  s_branch bg_c1_r
bg_d:
  s_cmp_lg_u32 s30, 0
  s_cbranch_scc1 bg_d_r
  s_mov_b64 exec, 1
  buffer_atomic_add v9, v8, s[24:27], s43 offen sc1
  s_mov_b64 exec, -1
  s_branch bg_d_r
xb_chk:
  s_mov_b32 s44, 200000
xb_lp:
  s_sleep 1
  buffer_load_dword v17, v16, s[24:27], s45 offen sc1
  s_sub_u32 s44, s44, 1
  s_cbranch_scc1 xb_ok
  s_waitcnt vmcnt(0)
  v_cmp_gt_u32 vcc, 8, v17
  s_nop 4
  s_cbranch_vccnz xb_lp
  s_branch xb_ok
hb_chk:
  s_sleep 1
  buffer_load_dword v9, v8, s[24:27], s45 offen sc1
  s_sub_u32 s90, s90, 1
  s_cbranch_scc1 hb_ok
  s_waitcnt vmcnt(0)
  v_cmp_gt_u32 vcc, 8, v9
  s_nop 4
  s_cbranch_vccnz hb_chk
  s_branch hb_ok
hc_chk:
  s_sleep 1
  buffer_load_dword v9, v8, s[24:27], s89 offen sc1
  s_sub_u32 s90, s90, 1
  s_cbranch_scc1 hc_ok
  s_waitcnt vmcnt(0)
  v_cmp_gt_u32 vcc, 8, v9
  s_nop 4
  s_cbranch_vccnz hc_chk
  s_branch hc_ok
main_code_end:
.section .rodata,"a"
.p2align 6
.amdhsa_kernel interleave_layers__linear_attn_block__swiglu_ffn__prompt_kernel
  .amdhsa_next_free_vgpr 512
  .amdhsa_next_free_sgpr 102
  .amdhsa_accum_offset 256
  .amdhsa_group_segment_fixed_size 0
  .amdhsa_kernarg_size 80
  .amdhsa_user_sgpr_count 2
  .amdhsa_user_sgpr_kernarg_segment_ptr 1
  .amdhsa_system_sgpr_workgroup_id_x 1
.end_amdhsa_kernel
```
